```python
import torch

def _softmax(x, axis=-1):
    return torch.softmax(x, dim=axis)

def _gelu(x):
    return torch.nn.functional.gelu(x, approximate='tanh')

def _silu(x):
    return torch.nn.functional.silu(x)

def _sigmoid(x):
    return torch.sigmoid(x)

def _layernorm(x, axis=-1, eps=1e-05):
    m = x.mean(dim=axis, keepdim=True)
    v = x.var(dim=axis, keepdim=True, unbiased=False)
    return (x - m) / torch.sqrt(v + eps)

def _scatter_add(tgt, idx, src, axis=0):
    return tgt.clone().index_add_(axis, idx, src)

def _segment_sum(src, seg, n):
    out = torch.zeros((n,) + src.shape[1:], dtype=src.dtype)
    return out.index_add_(0, seg, src)

def _pad(x, pw):
    flat = tuple((v for pair in reversed(pw) for v in pair))
    return torch.nn.functional.pad(x, flat)
kernel_name = 'sequential_preLN__ssm_conv_h3__mixer_gmlp__prompt'

def setup_inputs():

    _w = lambda a: (lambda t: t.to(torch.bfloat16) if t.is_floating_point() else t)(torch.as_tensor(a))

    def _A_setup():
        B, S, D = (1, 2048, 448)
        ks = 4
        return {'q': _w((lambda *s: torch.randn(*s, dtype=torch.bfloat16) * 0.05)(B, S, D)), 'k': _w((lambda *s: torch.randn(*s, dtype=torch.bfloat16) * 0.4)(B, S, D)), 'v': _w((lambda *s: torch.randn(*s, dtype=torch.bfloat16) * 0.4)(B, S, D)), 'shift_k': _w((lambda *s: torch.randn(*s, dtype=torch.bfloat16) * 0.4)(D, ks) * 0.5), 'ssm_k': _w((lambda *s: torch.randn(*s, dtype=torch.bfloat16) * 0.4)(D, S) * (1.0 / S ** 0.5)), 'ssm_D': _w((lambda *s: torch.randn(*s, dtype=torch.bfloat16) * 0.4)(D))}
    _A_in = _A_setup()

    def _B_setup():
        B, S, D, F = (1, 2048, 448, 1792)
        Fh = F // 2
        return {'x': _w((lambda *s: torch.randn(*s, dtype=torch.bfloat16) * 0.05)(B, S, D)), 'w_in': _w((lambda *s: torch.randn(*s, dtype=torch.bfloat16) * 0.4)(D, 2 * Fh)), 'w_sp': _w(0.01 * (lambda *s: torch.randn(*s, dtype=torch.bfloat16) * 0.4)(S, S)), 'b_sp': _w(1.0 + 0.01 * (lambda *s: torch.randn(*s, dtype=torch.bfloat16) * 0.05)(S)), 'w_out': _w((lambda *s: torch.randn(*s, dtype=torch.bfloat16) * 0.05)(Fh, D))}
    _B_in = _B_setup()
    return {'A_q': _A_in['q'], 'A_k': _A_in['k'], 'A_v': _A_in['v'], 'A_shift_k': _A_in['shift_k'], 'A_ssm_k': _A_in['ssm_k'], 'A_ssm_D': _A_in['ssm_D'], 'B_x': _B_in['x'], 'B_w_in': _B_in['w_in'], 'B_w_sp': _B_in['w_sp'], 'B_b_sp': _B_in['b_sp'], 'B_w_out': _B_in['w_out']}

def reference(A_q, A_k, A_v, A_shift_k, A_ssm_k, A_ssm_D, B_x, B_w_in, B_w_sp, B_b_sp, B_w_out):

    def _A_ref(q, k, v, shift_k, ssm_k, ssm_D):
        B, S, D = q.shape
        ks = shift_k.shape[-1]
        k_pad = _pad(k, ((0, 0), (ks - 1, 0), (0, 0)))
        k_shift = torch.zeros_like(k)
        for t in range(ks):
            k_shift = k_shift + k_pad[:, t:t + S, :] * shift_k[:, ks - 1 - t][None, None, :]
        kv = k_shift * v
        L = 2 * S
        kv_pad = _pad(kv, ((0, 0), (0, S), (0, 0)))
        kf_pad = _pad(ssm_k, ((0, 0), (0, S)))
        kv_f = (lambda x, axes=(-2, -1): torch.fft.rfft2(x.float(), dim=axes))(kv_pad[:, None, :, :], axes=(1, 2))
        kf_f = (lambda x, axes=(-2, -1): torch.fft.rfft2(x.float(), dim=axes))(kf_pad[:, None, :], axes=(1, 2))
        kf_f = (lambda x, *d: x.permute(*d))(kf_f, 1, 2, 0)
        y_f = kv_f * kf_f[None, :, :, :]
        y = (lambda x, s, axes=(-2, -1): torch.fft.irfft2(x, s=s, dim=axes).to(torch.bfloat16))(y_f, (1, L), axes=(1, 2))[:, 0, :S, :]
        y = y + kv * ssm_D[None, None, :]
        return q * y

    def _B_ref(x, w_in, w_sp, b_sp, w_out):
        B, S, D = x.shape
        F = w_in.shape[-1]
        Fh = F // 2
        z = _gelu(torch.einsum('bsd,df->bsf', x, w_in))
        z1 = z[..., :Fh].clone()
        z2 = _layernorm(z[..., Fh:], axis=-1)
        g = torch.einsum('ts,bsf->btf', w_sp, z2) + b_sp[None, :, None]
        return torch.einsum('bsf,fd->bsd', z1 * g, w_out)
    x = A_q
    h = x + _A_ref(_layernorm(x, axis=-1), A_k, A_v, A_shift_k, A_ssm_k, A_ssm_D)
    h2 = h + _B_ref(_layernorm(h, axis=-1), B_w_in, B_w_sp, B_b_sp, B_w_out)
    return h2
```

```asm
; @launch kernel=prep_kernel grid=(259,1,1) block=(256,1,1) lds=0
; @launch kernel=conv_kernel grid=(448,1,1) block=(256,1,1) lds=42752
; @launch kernel=lnprep_kernel grid=(64,1,1) block=(256,1,1) lds=35840
; @launch kernel=gemm1_kernel grid=(224,1,1) block=(512,1,1) lds=131072
; @launch kernel=norm_kernel grid=(224,1,1) block=(256,1,1) lds=2048
; @launch kernel=gemm2_kernel grid=(224,1,1) block=(512,1,1) lds=147456
; @launch kernel=gemm3_kernel grid=(224,1,1) block=(512,1,1) lds=98304
.amdgcn_target "amdgcn-amd-amdhsa--gfx950"
.text
.globl prep_kernel
.p2align 8
.type prep_kernel,@function
prep_kernel:
    s_load_dwordx2 s[4:5], s[0:1], 8
    s_load_dwordx2 s[6:7], s[0:1], 16
    s_load_dwordx2 s[8:9], s[0:1], 24
    s_load_dwordx2 s[10:11], s[0:1], 56
    s_load_dwordx2 s[12:13], s[0:1], 80
    s_load_dwordx2 s[14:15], s[0:1], 104
    v_lshrrev_b32 v1, 6, v0
    v_and_b32 v2, 63, v0
    s_nop 0
    v_readfirstlane_b32 s3, v1
    s_lshl_b32 s16, s2, 2
    s_nop 1
    s_add_u32 s16, s16, s3
    s_waitcnt lgkmcnt(0)
    s_cmp_lt_u32 s16, 448
    s_cbranch_scc1 prep_kv
    s_cmp_lt_u32 s16, 840
    s_cbranch_scc1 prep_win
    s_cmp_lt_u32 s16, 1036
    s_cbranch_scc1 prep_wout
    s_endpgm
prep_kv:
    s_mul_hi_u32 s17, s16, 0x24924925
    s_mul_i32 s18, s17, 7
    s_sub_u32 s18, s16, s18
    s_mov_b32 s20, s4
    s_mov_b32 s21, s5
    s_mov_b32 s22, 0x1c0000
    s_mov_b32 s23, 0x00020000
    s_mov_b32 s24, s6
    s_mov_b32 s25, s7
    s_mov_b32 s26, 0x1c0000
    s_mov_b32 s27, 0x00020000
    s_mov_b32 s28, s8
    s_mov_b32 s29, s9
    s_mov_b32 s30, 0xe00
    s_mov_b32 s31, 0x00020000
    s_mov_b32 s32, s14
    s_mov_b32 s33, s15
    s_mov_b32 s34, 0x1c0000
    s_mov_b32 s35, 0x00020000
    s_lshl_b32 s18, s18, 6
    v_add_u32 v3, s18, v2
    s_mul_i32 s19, s17, 28672
    s_sub_u32 s19, s19, 2688
    v_lshlrev_b32 v4, 1, v3
    v_add_u32 v4, s19, v4
    v_lshlrev_b32 v5, 3, v3
    buffer_load_dwordx2 v[10:11], v5, s[28:31], 0 offen
    v_add_u32 v6, 0, v4
    buffer_load_ushort v40, v6, s[20:23], 0 offen
    v_add_u32 v6, 896, v4
    buffer_load_ushort v41, v6, s[20:23], 0 offen
    v_add_u32 v6, 1792, v4
    buffer_load_ushort v42, v6, s[20:23], 0 offen
    v_add_u32 v6, 2688, v4
    buffer_load_ushort v43, v6, s[20:23], 0 offen
    v_add_u32 v6, 3584, v4
    buffer_load_ushort v44, v6, s[20:23], 0 offen
    v_add_u32 v6, 4480, v4
    buffer_load_ushort v45, v6, s[20:23], 0 offen
    v_add_u32 v6, 5376, v4
    buffer_load_ushort v46, v6, s[20:23], 0 offen
    v_add_u32 v6, 6272, v4
    buffer_load_ushort v47, v6, s[20:23], 0 offen
    v_add_u32 v6, 7168, v4
    buffer_load_ushort v48, v6, s[20:23], 0 offen
    v_add_u32 v6, 8064, v4
    buffer_load_ushort v49, v6, s[20:23], 0 offen
    v_add_u32 v6, 8960, v4
    buffer_load_ushort v50, v6, s[20:23], 0 offen
    v_add_u32 v6, 9856, v4
    buffer_load_ushort v51, v6, s[20:23], 0 offen
    v_add_u32 v6, 10752, v4
    buffer_load_ushort v52, v6, s[20:23], 0 offen
    v_add_u32 v6, 11648, v4
    buffer_load_ushort v53, v6, s[20:23], 0 offen
    v_add_u32 v6, 12544, v4
    buffer_load_ushort v54, v6, s[20:23], 0 offen
    v_add_u32 v6, 13440, v4
    buffer_load_ushort v55, v6, s[20:23], 0 offen
    v_add_u32 v6, 14336, v4
    buffer_load_ushort v56, v6, s[20:23], 0 offen
    v_add_u32 v6, 15232, v4
    buffer_load_ushort v57, v6, s[20:23], 0 offen
    v_add_u32 v6, 16128, v4
    buffer_load_ushort v58, v6, s[20:23], 0 offen
    v_add_u32 v6, 17024, v4
    buffer_load_ushort v59, v6, s[20:23], 0 offen
    v_add_u32 v6, 17920, v4
    buffer_load_ushort v60, v6, s[20:23], 0 offen
    v_add_u32 v6, 18816, v4
    buffer_load_ushort v61, v6, s[20:23], 0 offen
    v_add_u32 v6, 19712, v4
    buffer_load_ushort v62, v6, s[20:23], 0 offen
    v_add_u32 v6, 20608, v4
    buffer_load_ushort v63, v6, s[20:23], 0 offen
    v_add_u32 v6, 21504, v4
    buffer_load_ushort v64, v6, s[20:23], 0 offen
    v_add_u32 v6, 22400, v4
    buffer_load_ushort v65, v6, s[20:23], 0 offen
    v_add_u32 v6, 23296, v4
    buffer_load_ushort v66, v6, s[20:23], 0 offen
    v_add_u32 v6, 24192, v4
    buffer_load_ushort v67, v6, s[20:23], 0 offen
    v_add_u32 v6, 25088, v4
    buffer_load_ushort v68, v6, s[20:23], 0 offen
    v_add_u32 v6, 25984, v4
    buffer_load_ushort v69, v6, s[20:23], 0 offen
    v_add_u32 v6, 26880, v4
    buffer_load_ushort v70, v6, s[20:23], 0 offen
    v_add_u32 v6, 27776, v4
    buffer_load_ushort v71, v6, s[20:23], 0 offen
    v_add_u32 v6, 28672, v4
    buffer_load_ushort v72, v6, s[20:23], 0 offen
    v_add_u32 v6, 29568, v4
    buffer_load_ushort v73, v6, s[20:23], 0 offen
    v_add_u32 v6, 30464, v4
    buffer_load_ushort v74, v6, s[20:23], 0 offen
    v_add_u32 v6, 2688, v4
    buffer_load_ushort v80, v6, s[24:27], 0 offen
    v_add_u32 v6, 3584, v4
    buffer_load_ushort v81, v6, s[24:27], 0 offen
    v_add_u32 v6, 4480, v4
    buffer_load_ushort v82, v6, s[24:27], 0 offen
    v_add_u32 v6, 5376, v4
    buffer_load_ushort v83, v6, s[24:27], 0 offen
    v_add_u32 v6, 6272, v4
    buffer_load_ushort v84, v6, s[24:27], 0 offen
    v_add_u32 v6, 7168, v4
    buffer_load_ushort v85, v6, s[24:27], 0 offen
    v_add_u32 v6, 8064, v4
    buffer_load_ushort v86, v6, s[24:27], 0 offen
    v_add_u32 v6, 8960, v4
    buffer_load_ushort v87, v6, s[24:27], 0 offen
    v_add_u32 v6, 9856, v4
    buffer_load_ushort v88, v6, s[24:27], 0 offen
    v_add_u32 v6, 10752, v4
    buffer_load_ushort v89, v6, s[24:27], 0 offen
    v_add_u32 v6, 11648, v4
    buffer_load_ushort v90, v6, s[24:27], 0 offen
    v_add_u32 v6, 12544, v4
    buffer_load_ushort v91, v6, s[24:27], 0 offen
    v_add_u32 v6, 13440, v4
    buffer_load_ushort v92, v6, s[24:27], 0 offen
    v_add_u32 v6, 14336, v4
    buffer_load_ushort v93, v6, s[24:27], 0 offen
    v_add_u32 v6, 15232, v4
    buffer_load_ushort v94, v6, s[24:27], 0 offen
    v_add_u32 v6, 16128, v4
    buffer_load_ushort v95, v6, s[24:27], 0 offen
    v_add_u32 v6, 17024, v4
    buffer_load_ushort v96, v6, s[24:27], 0 offen
    v_add_u32 v6, 17920, v4
    buffer_load_ushort v97, v6, s[24:27], 0 offen
    v_add_u32 v6, 18816, v4
    buffer_load_ushort v98, v6, s[24:27], 0 offen
    v_add_u32 v6, 19712, v4
    buffer_load_ushort v99, v6, s[24:27], 0 offen
    v_add_u32 v6, 20608, v4
    buffer_load_ushort v100, v6, s[24:27], 0 offen
    v_add_u32 v6, 21504, v4
    buffer_load_ushort v101, v6, s[24:27], 0 offen
    v_add_u32 v6, 22400, v4
    buffer_load_ushort v102, v6, s[24:27], 0 offen
    v_add_u32 v6, 23296, v4
    buffer_load_ushort v103, v6, s[24:27], 0 offen
    v_add_u32 v6, 24192, v4
    buffer_load_ushort v104, v6, s[24:27], 0 offen
    v_add_u32 v6, 25088, v4
    buffer_load_ushort v105, v6, s[24:27], 0 offen
    v_add_u32 v6, 25984, v4
    buffer_load_ushort v106, v6, s[24:27], 0 offen
    v_add_u32 v6, 26880, v4
    buffer_load_ushort v107, v6, s[24:27], 0 offen
    v_add_u32 v6, 27776, v4
    buffer_load_ushort v108, v6, s[24:27], 0 offen
    v_add_u32 v6, 28672, v4
    buffer_load_ushort v109, v6, s[24:27], 0 offen
    v_add_u32 v6, 29568, v4
    buffer_load_ushort v110, v6, s[24:27], 0 offen
    v_add_u32 v6, 30464, v4
    buffer_load_ushort v111, v6, s[24:27], 0 offen
    s_waitcnt vmcnt(0)
    v_lshlrev_b32 v12, 16, v10
    v_and_b32 v13, 0xffff0000, v10
    v_lshlrev_b32 v14, 16, v11
    v_and_b32 v15, 0xffff0000, v11
    v_lshlrev_b32 v40, 16, v40
    v_lshlrev_b32 v41, 16, v41
    v_lshlrev_b32 v42, 16, v42
    v_lshlrev_b32 v43, 16, v43
    v_lshlrev_b32 v44, 16, v44
    v_lshlrev_b32 v45, 16, v45
    v_lshlrev_b32 v46, 16, v46
    v_lshlrev_b32 v47, 16, v47
    v_lshlrev_b32 v48, 16, v48
    v_lshlrev_b32 v49, 16, v49
    v_lshlrev_b32 v50, 16, v50
    v_lshlrev_b32 v51, 16, v51
    v_lshlrev_b32 v52, 16, v52
    v_lshlrev_b32 v53, 16, v53
    v_lshlrev_b32 v54, 16, v54
    v_lshlrev_b32 v55, 16, v55
    v_lshlrev_b32 v56, 16, v56
    v_lshlrev_b32 v57, 16, v57
    v_lshlrev_b32 v58, 16, v58
    v_lshlrev_b32 v59, 16, v59
    v_lshlrev_b32 v60, 16, v60
    v_lshlrev_b32 v61, 16, v61
    v_lshlrev_b32 v62, 16, v62
    v_lshlrev_b32 v63, 16, v63
    v_lshlrev_b32 v64, 16, v64
    v_lshlrev_b32 v65, 16, v65
    v_lshlrev_b32 v66, 16, v66
    v_lshlrev_b32 v67, 16, v67
    v_lshlrev_b32 v68, 16, v68
    v_lshlrev_b32 v69, 16, v69
    v_lshlrev_b32 v70, 16, v70
    v_lshlrev_b32 v71, 16, v71
    v_lshlrev_b32 v72, 16, v72
    v_lshlrev_b32 v73, 16, v73
    v_lshlrev_b32 v74, 16, v74
    v_lshlrev_b32 v80, 16, v80
    v_mul_f32 v7, v12, v43
    v_fmac_f32 v7, v13, v42
    v_fmac_f32 v7, v14, v41
    v_fmac_f32 v7, v15, v40
    v_mul_f32 v80, v7, v80
    v_lshlrev_b32 v81, 16, v81
    v_mul_f32 v7, v12, v44
    v_fmac_f32 v7, v13, v43
    v_fmac_f32 v7, v14, v42
    v_fmac_f32 v7, v15, v41
    v_mul_f32 v81, v7, v81
    v_lshlrev_b32 v82, 16, v82
    v_mul_f32 v7, v12, v45
    v_fmac_f32 v7, v13, v44
    v_fmac_f32 v7, v14, v43
    v_fmac_f32 v7, v15, v42
    v_mul_f32 v82, v7, v82
    v_lshlrev_b32 v83, 16, v83
    v_mul_f32 v7, v12, v46
    v_fmac_f32 v7, v13, v45
    v_fmac_f32 v7, v14, v44
    v_fmac_f32 v7, v15, v43
    v_mul_f32 v83, v7, v83
    v_lshlrev_b32 v84, 16, v84
    v_mul_f32 v7, v12, v47
    v_fmac_f32 v7, v13, v46
    v_fmac_f32 v7, v14, v45
    v_fmac_f32 v7, v15, v44
    v_mul_f32 v84, v7, v84
    v_lshlrev_b32 v85, 16, v85
    v_mul_f32 v7, v12, v48
    v_fmac_f32 v7, v13, v47
    v_fmac_f32 v7, v14, v46
    v_fmac_f32 v7, v15, v45
    v_mul_f32 v85, v7, v85
    v_lshlrev_b32 v86, 16, v86
    v_mul_f32 v7, v12, v49
    v_fmac_f32 v7, v13, v48
    v_fmac_f32 v7, v14, v47
    v_fmac_f32 v7, v15, v46
    v_mul_f32 v86, v7, v86
    v_lshlrev_b32 v87, 16, v87
    v_mul_f32 v7, v12, v50
    v_fmac_f32 v7, v13, v49
    v_fmac_f32 v7, v14, v48
    v_fmac_f32 v7, v15, v47
    v_mul_f32 v87, v7, v87
    v_lshlrev_b32 v88, 16, v88
    v_mul_f32 v7, v12, v51
    v_fmac_f32 v7, v13, v50
    v_fmac_f32 v7, v14, v49
    v_fmac_f32 v7, v15, v48
    v_mul_f32 v88, v7, v88
    v_lshlrev_b32 v89, 16, v89
    v_mul_f32 v7, v12, v52
    v_fmac_f32 v7, v13, v51
    v_fmac_f32 v7, v14, v50
    v_fmac_f32 v7, v15, v49
    v_mul_f32 v89, v7, v89
    v_lshlrev_b32 v90, 16, v90
    v_mul_f32 v7, v12, v53
    v_fmac_f32 v7, v13, v52
    v_fmac_f32 v7, v14, v51
    v_fmac_f32 v7, v15, v50
    v_mul_f32 v90, v7, v90
    v_lshlrev_b32 v91, 16, v91
    v_mul_f32 v7, v12, v54
    v_fmac_f32 v7, v13, v53
    v_fmac_f32 v7, v14, v52
    v_fmac_f32 v7, v15, v51
    v_mul_f32 v91, v7, v91
    v_lshlrev_b32 v92, 16, v92
    v_mul_f32 v7, v12, v55
    v_fmac_f32 v7, v13, v54
    v_fmac_f32 v7, v14, v53
    v_fmac_f32 v7, v15, v52
    v_mul_f32 v92, v7, v92
    v_lshlrev_b32 v93, 16, v93
    v_mul_f32 v7, v12, v56
    v_fmac_f32 v7, v13, v55
    v_fmac_f32 v7, v14, v54
    v_fmac_f32 v7, v15, v53
    v_mul_f32 v93, v7, v93
    v_lshlrev_b32 v94, 16, v94
    v_mul_f32 v7, v12, v57
    v_fmac_f32 v7, v13, v56
    v_fmac_f32 v7, v14, v55
    v_fmac_f32 v7, v15, v54
    v_mul_f32 v94, v7, v94
    v_lshlrev_b32 v95, 16, v95
    v_mul_f32 v7, v12, v58
    v_fmac_f32 v7, v13, v57
    v_fmac_f32 v7, v14, v56
    v_fmac_f32 v7, v15, v55
    v_mul_f32 v95, v7, v95
    v_lshlrev_b32 v96, 16, v96
    v_mul_f32 v7, v12, v59
    v_fmac_f32 v7, v13, v58
    v_fmac_f32 v7, v14, v57
    v_fmac_f32 v7, v15, v56
    v_mul_f32 v96, v7, v96
    v_lshlrev_b32 v97, 16, v97
    v_mul_f32 v7, v12, v60
    v_fmac_f32 v7, v13, v59
    v_fmac_f32 v7, v14, v58
    v_fmac_f32 v7, v15, v57
    v_mul_f32 v97, v7, v97
    v_lshlrev_b32 v98, 16, v98
    v_mul_f32 v7, v12, v61
    v_fmac_f32 v7, v13, v60
    v_fmac_f32 v7, v14, v59
    v_fmac_f32 v7, v15, v58
    v_mul_f32 v98, v7, v98
    v_lshlrev_b32 v99, 16, v99
    v_mul_f32 v7, v12, v62
    v_fmac_f32 v7, v13, v61
    v_fmac_f32 v7, v14, v60
    v_fmac_f32 v7, v15, v59
    v_mul_f32 v99, v7, v99
    v_lshlrev_b32 v100, 16, v100
    v_mul_f32 v7, v12, v63
    v_fmac_f32 v7, v13, v62
    v_fmac_f32 v7, v14, v61
    v_fmac_f32 v7, v15, v60
    v_mul_f32 v100, v7, v100
    v_lshlrev_b32 v101, 16, v101
    v_mul_f32 v7, v12, v64
    v_fmac_f32 v7, v13, v63
    v_fmac_f32 v7, v14, v62
    v_fmac_f32 v7, v15, v61
    v_mul_f32 v101, v7, v101
    v_lshlrev_b32 v102, 16, v102
    v_mul_f32 v7, v12, v65
    v_fmac_f32 v7, v13, v64
    v_fmac_f32 v7, v14, v63
    v_fmac_f32 v7, v15, v62
    v_mul_f32 v102, v7, v102
    v_lshlrev_b32 v103, 16, v103
    v_mul_f32 v7, v12, v66
    v_fmac_f32 v7, v13, v65
    v_fmac_f32 v7, v14, v64
    v_fmac_f32 v7, v15, v63
    v_mul_f32 v103, v7, v103
    v_lshlrev_b32 v104, 16, v104
    v_mul_f32 v7, v12, v67
    v_fmac_f32 v7, v13, v66
    v_fmac_f32 v7, v14, v65
    v_fmac_f32 v7, v15, v64
    v_mul_f32 v104, v7, v104
    v_lshlrev_b32 v105, 16, v105
    v_mul_f32 v7, v12, v68
    v_fmac_f32 v7, v13, v67
    v_fmac_f32 v7, v14, v66
    v_fmac_f32 v7, v15, v65
    v_mul_f32 v105, v7, v105
    v_lshlrev_b32 v106, 16, v106
    v_mul_f32 v7, v12, v69
    v_fmac_f32 v7, v13, v68
    v_fmac_f32 v7, v14, v67
    v_fmac_f32 v7, v15, v66
    v_mul_f32 v106, v7, v106
    v_lshlrev_b32 v107, 16, v107
    v_mul_f32 v7, v12, v70
    v_fmac_f32 v7, v13, v69
    v_fmac_f32 v7, v14, v68
    v_fmac_f32 v7, v15, v67
    v_mul_f32 v107, v7, v107
    v_lshlrev_b32 v108, 16, v108
    v_mul_f32 v7, v12, v71
    v_fmac_f32 v7, v13, v70
    v_fmac_f32 v7, v14, v69
    v_fmac_f32 v7, v15, v68
    v_mul_f32 v108, v7, v108
    v_lshlrev_b32 v109, 16, v109
    v_mul_f32 v7, v12, v72
    v_fmac_f32 v7, v13, v71
    v_fmac_f32 v7, v14, v70
    v_fmac_f32 v7, v15, v69
    v_mul_f32 v109, v7, v109
    v_lshlrev_b32 v110, 16, v110
    v_mul_f32 v7, v12, v73
    v_fmac_f32 v7, v13, v72
    v_fmac_f32 v7, v14, v71
    v_fmac_f32 v7, v15, v70
    v_mul_f32 v110, v7, v110
    v_lshlrev_b32 v111, 16, v111
    v_mul_f32 v7, v12, v74
    v_fmac_f32 v7, v13, v73
    v_fmac_f32 v7, v14, v72
    v_fmac_f32 v7, v15, v71
    v_mul_f32 v111, v7, v111
    v_cvt_pk_bf16_f32 v16, v80, v81
    v_cvt_pk_bf16_f32 v17, v82, v83
    v_cvt_pk_bf16_f32 v18, v84, v85
    v_cvt_pk_bf16_f32 v19, v86, v87
    v_cvt_pk_bf16_f32 v20, v88, v89
    v_cvt_pk_bf16_f32 v21, v90, v91
    v_cvt_pk_bf16_f32 v22, v92, v93
    v_cvt_pk_bf16_f32 v23, v94, v95
    v_cvt_pk_bf16_f32 v24, v96, v97
    v_cvt_pk_bf16_f32 v25, v98, v99
    v_cvt_pk_bf16_f32 v26, v100, v101
    v_cvt_pk_bf16_f32 v27, v102, v103
    v_cvt_pk_bf16_f32 v28, v104, v105
    v_cvt_pk_bf16_f32 v29, v106, v107
    v_cvt_pk_bf16_f32 v30, v108, v109
    v_cvt_pk_bf16_f32 v31, v110, v111
    s_lshl_b32 s19, s17, 6
    v_lshlrev_b32 v5, 12, v3
    v_add_u32 v5, s19, v5
    buffer_store_dwordx4 v[16:19], v5, s[32:35], 0 offen offset:0
    buffer_store_dwordx4 v[20:23], v5, s[32:35], 0 offen offset:16
    buffer_store_dwordx4 v[24:27], v5, s[32:35], 0 offen offset:32
    buffer_store_dwordx4 v[28:31], v5, s[32:35], 0 offen offset:48
    s_endpgm
prep_win:
    s_sub_u32 s16, s16, 448
    s_mul_hi_u32 s17, s16, 0x924924a
    s_mul_i32 s18, s17, 28
    s_sub_u32 s18, s16, s18
    s_mov_b32 s20, s10
    s_mov_b32 s21, s11
    s_mov_b32 s22, 0x188000
    s_mov_b32 s23, 0x00020000
    s_add_u32 s32, s14, 0x400000
    s_addc_u32 s33, s15, 0
    s_mov_b32 s34, 0x188000
    s_mov_b32 s35, 0x00020000
    s_lshl_b32 s18, s18, 6
    v_add_u32 v3, s18, v2
    s_mul_i32 s19, s17, 114688
    v_lshlrev_b32 v4, 1, v3
    v_add_u32 v4, s19, v4
    v_add_u32 v6, 0, v4
    buffer_load_ushort v40, v6, s[20:23], 0 offen
    v_add_u32 v6, 3584, v4
    buffer_load_ushort v41, v6, s[20:23], 0 offen
    v_add_u32 v6, 7168, v4
    buffer_load_ushort v42, v6, s[20:23], 0 offen
    v_add_u32 v6, 10752, v4
    buffer_load_ushort v43, v6, s[20:23], 0 offen
    v_add_u32 v6, 14336, v4
    buffer_load_ushort v44, v6, s[20:23], 0 offen
    v_add_u32 v6, 17920, v4
    buffer_load_ushort v45, v6, s[20:23], 0 offen
    v_add_u32 v6, 21504, v4
    buffer_load_ushort v46, v6, s[20:23], 0 offen
    v_add_u32 v6, 25088, v4
    buffer_load_ushort v47, v6, s[20:23], 0 offen
    v_add_u32 v6, 28672, v4
    buffer_load_ushort v48, v6, s[20:23], 0 offen
    v_add_u32 v6, 32256, v4
    buffer_load_ushort v49, v6, s[20:23], 0 offen
    v_add_u32 v6, 35840, v4
    buffer_load_ushort v50, v6, s[20:23], 0 offen
    v_add_u32 v6, 39424, v4
    buffer_load_ushort v51, v6, s[20:23], 0 offen
    v_add_u32 v6, 43008, v4
    buffer_load_ushort v52, v6, s[20:23], 0 offen
    v_add_u32 v6, 46592, v4
    buffer_load_ushort v53, v6, s[20:23], 0 offen
    v_add_u32 v6, 50176, v4
    buffer_load_ushort v54, v6, s[20:23], 0 offen
    v_add_u32 v6, 53760, v4
    buffer_load_ushort v55, v6, s[20:23], 0 offen
    v_add_u32 v6, 57344, v4
    buffer_load_ushort v56, v6, s[20:23], 0 offen
    v_add_u32 v6, 60928, v4
    buffer_load_ushort v57, v6, s[20:23], 0 offen
    v_add_u32 v6, 64512, v4
    buffer_load_ushort v58, v6, s[20:23], 0 offen
    v_add_u32 v6, 68096, v4
    buffer_load_ushort v59, v6, s[20:23], 0 offen
    v_add_u32 v6, 71680, v4
    buffer_load_ushort v60, v6, s[20:23], 0 offen
    v_add_u32 v6, 75264, v4
    buffer_load_ushort v61, v6, s[20:23], 0 offen
    v_add_u32 v6, 78848, v4
    buffer_load_ushort v62, v6, s[20:23], 0 offen
    v_add_u32 v6, 82432, v4
    buffer_load_ushort v63, v6, s[20:23], 0 offen
    v_add_u32 v6, 86016, v4
    buffer_load_ushort v64, v6, s[20:23], 0 offen
    v_add_u32 v6, 89600, v4
    buffer_load_ushort v65, v6, s[20:23], 0 offen
    v_add_u32 v6, 93184, v4
    buffer_load_ushort v66, v6, s[20:23], 0 offen
    v_add_u32 v6, 96768, v4
    buffer_load_ushort v67, v6, s[20:23], 0 offen
    v_add_u32 v6, 100352, v4
    buffer_load_ushort v68, v6, s[20:23], 0 offen
    v_add_u32 v6, 103936, v4
    buffer_load_ushort v69, v6, s[20:23], 0 offen
    v_add_u32 v6, 107520, v4
    buffer_load_ushort v70, v6, s[20:23], 0 offen
    v_add_u32 v6, 111104, v4
    buffer_load_ushort v71, v6, s[20:23], 0 offen
    s_waitcnt vmcnt(0)
    v_lshl_or_b32 v16, v41, 16, v40
    v_lshl_or_b32 v17, v43, 16, v42
    v_lshl_or_b32 v18, v45, 16, v44
    v_lshl_or_b32 v19, v47, 16, v46
    v_lshl_or_b32 v20, v49, 16, v48
    v_lshl_or_b32 v21, v51, 16, v50
    v_lshl_or_b32 v22, v53, 16, v52
    v_lshl_or_b32 v23, v55, 16, v54
    v_lshl_or_b32 v24, v57, 16, v56
    v_lshl_or_b32 v25, v59, 16, v58
    v_lshl_or_b32 v26, v61, 16, v60
    v_lshl_or_b32 v27, v63, 16, v62
    v_lshl_or_b32 v28, v65, 16, v64
    v_lshl_or_b32 v29, v67, 16, v66
    v_lshl_or_b32 v30, v69, 16, v68
    v_lshl_or_b32 v31, v71, 16, v70
    s_lshl_b32 s19, s17, 6
    s_mov_b32 s21, 896
    v_mul_lo_u32 v5, v3, s21
    v_add_u32 v5, s19, v5
    buffer_store_dwordx4 v[16:19], v5, s[32:35], 0 offen offset:0
    buffer_store_dwordx4 v[20:23], v5, s[32:35], 0 offen offset:16
    buffer_store_dwordx4 v[24:27], v5, s[32:35], 0 offen offset:32
    buffer_store_dwordx4 v[28:31], v5, s[32:35], 0 offen offset:48
    s_endpgm
prep_wout:
    s_sub_u32 s16, s16, 840
    s_mul_hi_u32 s17, s16, 0x24924925
    s_mul_i32 s18, s17, 7
    s_sub_u32 s18, s16, s18
    s_mov_b32 s20, s12
    s_mov_b32 s21, s13
    s_mov_b32 s22, 0xc4000
    s_mov_b32 s23, 0x00020000
    s_add_u32 s32, s14, 0x600000
    s_addc_u32 s33, s15, 0
    s_mov_b32 s34, 0xc4000
    s_mov_b32 s35, 0x00020000
    s_lshl_b32 s18, s18, 6
    v_add_u32 v3, s18, v2
    s_mul_i32 s19, s17, 28672
    v_lshlrev_b32 v4, 1, v3
    v_add_u32 v4, s19, v4
    v_add_u32 v6, 0, v4
    buffer_load_ushort v40, v6, s[20:23], 0 offen
    v_add_u32 v6, 896, v4
    buffer_load_ushort v41, v6, s[20:23], 0 offen
    v_add_u32 v6, 1792, v4
    buffer_load_ushort v42, v6, s[20:23], 0 offen
    v_add_u32 v6, 2688, v4
    buffer_load_ushort v43, v6, s[20:23], 0 offen
    v_add_u32 v6, 3584, v4
    buffer_load_ushort v44, v6, s[20:23], 0 offen
    v_add_u32 v6, 4480, v4
    buffer_load_ushort v45, v6, s[20:23], 0 offen
    v_add_u32 v6, 5376, v4
    buffer_load_ushort v46, v6, s[20:23], 0 offen
    v_add_u32 v6, 6272, v4
    buffer_load_ushort v47, v6, s[20:23], 0 offen
    v_add_u32 v6, 7168, v4
    buffer_load_ushort v48, v6, s[20:23], 0 offen
    v_add_u32 v6, 8064, v4
    buffer_load_ushort v49, v6, s[20:23], 0 offen
    v_add_u32 v6, 8960, v4
    buffer_load_ushort v50, v6, s[20:23], 0 offen
    v_add_u32 v6, 9856, v4
    buffer_load_ushort v51, v6, s[20:23], 0 offen
    v_add_u32 v6, 10752, v4
    buffer_load_ushort v52, v6, s[20:23], 0 offen
    v_add_u32 v6, 11648, v4
    buffer_load_ushort v53, v6, s[20:23], 0 offen
    v_add_u32 v6, 12544, v4
    buffer_load_ushort v54, v6, s[20:23], 0 offen
    v_add_u32 v6, 13440, v4
    buffer_load_ushort v55, v6, s[20:23], 0 offen
    v_add_u32 v6, 14336, v4
    buffer_load_ushort v56, v6, s[20:23], 0 offen
    v_add_u32 v6, 15232, v4
    buffer_load_ushort v57, v6, s[20:23], 0 offen
    v_add_u32 v6, 16128, v4
    buffer_load_ushort v58, v6, s[20:23], 0 offen
    v_add_u32 v6, 17024, v4
    buffer_load_ushort v59, v6, s[20:23], 0 offen
    v_add_u32 v6, 17920, v4
    buffer_load_ushort v60, v6, s[20:23], 0 offen
    v_add_u32 v6, 18816, v4
    buffer_load_ushort v61, v6, s[20:23], 0 offen
    v_add_u32 v6, 19712, v4
    buffer_load_ushort v62, v6, s[20:23], 0 offen
    v_add_u32 v6, 20608, v4
    buffer_load_ushort v63, v6, s[20:23], 0 offen
    v_add_u32 v6, 21504, v4
    buffer_load_ushort v64, v6, s[20:23], 0 offen
    v_add_u32 v6, 22400, v4
    buffer_load_ushort v65, v6, s[20:23], 0 offen
    v_add_u32 v6, 23296, v4
    buffer_load_ushort v66, v6, s[20:23], 0 offen
    v_add_u32 v6, 24192, v4
    buffer_load_ushort v67, v6, s[20:23], 0 offen
    v_add_u32 v6, 25088, v4
    buffer_load_ushort v68, v6, s[20:23], 0 offen
    v_add_u32 v6, 25984, v4
    buffer_load_ushort v69, v6, s[20:23], 0 offen
    v_add_u32 v6, 26880, v4
    buffer_load_ushort v70, v6, s[20:23], 0 offen
    v_add_u32 v6, 27776, v4
    buffer_load_ushort v71, v6, s[20:23], 0 offen
    s_waitcnt vmcnt(0)
    v_lshl_or_b32 v16, v41, 16, v40
    v_lshl_or_b32 v17, v43, 16, v42
    v_lshl_or_b32 v18, v45, 16, v44
    v_lshl_or_b32 v19, v47, 16, v46
    v_lshl_or_b32 v20, v49, 16, v48
    v_lshl_or_b32 v21, v51, 16, v50
    v_lshl_or_b32 v22, v53, 16, v52
    v_lshl_or_b32 v23, v55, 16, v54
    v_lshl_or_b32 v24, v57, 16, v56
    v_lshl_or_b32 v25, v59, 16, v58
    v_lshl_or_b32 v26, v61, 16, v60
    v_lshl_or_b32 v27, v63, 16, v62
    v_lshl_or_b32 v28, v65, 16, v64
    v_lshl_or_b32 v29, v67, 16, v66
    v_lshl_or_b32 v30, v69, 16, v68
    v_lshl_or_b32 v31, v71, 16, v70
    s_lshl_b32 s19, s17, 6
    s_mov_b32 s21, 1792
    v_mul_lo_u32 v5, v3, s21
    v_add_u32 v5, s19, v5
    buffer_store_dwordx4 v[16:19], v5, s[32:35], 0 offen offset:0
    buffer_store_dwordx4 v[20:23], v5, s[32:35], 0 offen offset:16
    buffer_store_dwordx4 v[24:27], v5, s[32:35], 0 offen offset:32
    buffer_store_dwordx4 v[28:31], v5, s[32:35], 0 offen offset:48
    s_endpgm
    s_endpgm
.globl conv_kernel
.p2align 8
.type conv_kernel,@function
conv_kernel:
    s_cmp_ge_u32 s2, 448
    s_cbranch_scc1 conv_done
    s_load_dwordx2 s[4:5], s[0:1], 32
    s_load_dwordx2 s[6:7], s[0:1], 40
    s_load_dwordx2 s[36:37], s[0:1], 104
    s_waitcnt lgkmcnt(0)
    s_mov_b32 s8, s4
    s_mov_b32 s9, s5
    s_mov_b32 s10, 0x1c0000
    s_mov_b32 s11, 0x00020000
    s_mov_b32 s20, s6
    s_mov_b32 s21, s7
    s_mov_b32 s22, 0x380
    s_mov_b32 s23, 0x00020000
    s_mov_b32 s12, s36
    s_mov_b32 s13, s37
    s_mov_b32 s14, 0x1c0000
    s_mov_b32 s15, 0x00020000
    s_add_u32 s16, s36, 0x200000
    s_addc_u32 s17, s37, 0
    s_mov_b32 s18, 0x1c0000
    s_mov_b32 s19, 0x00020000
    s_lshl_b32 s24, s2, 12
    v_lshlrev_b32 v1, 4, v0
    v_sub_u32 v2, 4064, v1
    v_add_u32 v2, s24, v2
    buffer_load_dwordx4 v[16:19], v2, s[8:11], 0 offen
    buffer_load_dwordx4 v[20:23], v2, s[8:11], 0 offen offset:16
    v_add_u32 v3, s24, v1
    buffer_load_dwordx4 v[24:27], v3, s[12:15], 0 offen
    s_lshl_b32 s25, s2, 1
    v_mov_b32 v4, s25
    buffer_load_ushort v124, v4, s[20:23], 0 offen
    v_mov_b32 v56, 0
    v_mov_b32 v57, 0
    v_mov_b32 v58, 0
    v_mov_b32 v59, 0
    s_waitcnt vmcnt(0)
    v_cmp_eq_u32 vcc, 255, v0
    s_nop 1
    v_cndmask_b32 v16, v16, 0, vcc
    v_cndmask_b32 v17, v17, 0, vcc
    v_cndmask_b32 v18, v18, 0, vcc
    v_cndmask_b32 v19, v19, 0, vcc
    v_alignbit_b32 v32, v23, v23, 16
    v_alignbit_b32 v33, v22, v22, 16
    v_alignbit_b32 v34, v21, v21, 16
    v_alignbit_b32 v35, v20, v20, 16
    v_alignbit_b32 v36, v19, v19, 16
    v_alignbit_b32 v37, v18, v18, 16
    v_alignbit_b32 v38, v17, v17, 16
    v_alignbit_b32 v39, v16, v16, 16
    v_alignbit_b32 v40, v33, v32, 16
    v_alignbit_b32 v41, v34, v33, 16
    v_alignbit_b32 v42, v35, v34, 16
    v_alignbit_b32 v43, v36, v35, 16
    v_alignbit_b32 v44, v37, v36, 16
    v_alignbit_b32 v45, v38, v37, 16
    v_alignbit_b32 v46, v39, v38, 16
    v_mov_b32 v48, v33
    v_mov_b32 v52, v35
    v_mov_b32 v60, v41
    v_mov_b32 v96, v43
    v_mov_b32 v49, v34
    v_mov_b32 v53, v36
    v_mov_b32 v61, v42
    v_mov_b32 v97, v44
    v_mov_b32 v50, v35
    v_mov_b32 v54, v37
    v_mov_b32 v62, v43
    v_mov_b32 v98, v45
    v_mov_b32 v51, v36
    v_mov_b32 v55, v38
    v_mov_b32 v63, v44
    v_mov_b32 v99, v46
    ds_write_b128 v1, v[32:35] offset:0
    ds_write_b128 v1, v[40:43] offset:4384
    ds_write_b128 v1, v[48:51] offset:8768
    ds_write_b128 v1, v[60:63] offset:13152
    ds_write_b128 v1, v[34:37] offset:17536
    ds_write_b128 v1, v[42:45] offset:21920
    ds_write_b128 v1, v[52:55] offset:26304
    ds_write_b128 v1, v[96:99] offset:30688
    v_lshrrev_b32 v5, 2, v0
    v_mul_u32_u24 v5, 4384, v5
    v_and_b32 v6, 3, v0
    v_lshl_add_u32 v5, v6, 4, v5
    v_add_u32 v5, 4096, v5
    v_cmp_gt_u32 vcc, 32, v0
    s_and_saveexec_b64 s[26:27], vcc
    ds_write_b128 v5, v[56:59]
    s_mov_b64 exec, s[26:27]
    v_cmp_gt_u32 vcc, 160, v0
    s_and_saveexec_b64 s[26:27], vcc
    ds_write_b128 v1, v[56:59] offset:35072
    s_mov_b64 exec, s[26:27]
    v_lshrrev_b32 v5, 2, v0
    v_mul_u32_u24 v5, 80, v5
    v_lshl_add_u32 v5, v6, 4, v5
    ds_write_b128 v5, v[24:27] offset:37632
    s_waitcnt lgkmcnt(0)
    s_barrier
    v_lshrrev_b32 v7, 6, v0
    s_nop 0
    v_readfirstlane_b32 s28, v7
    v_and_b32 v8, 31, v0
    v_bfe_u32 v9, v0, 5, 1
    v_sub_u32 v10, 7, v8
    v_and_b32 v10, 7, v10
    v_mul_u32_u24 v11, 4384, v10
    v_lshlrev_b32 v12, 3, v9
    v_sub_u32 v12, v12, v8
    v_sub_u32 v12, v12, v10
    v_add_u32 v12, 2047, v12
    v_lshl_add_u32 v11, v12, 1, v11
    s_lshl_b32 s29, s28, 6
    s_add_u32 s29, s29, 3840
    v_subrev_u32 v11, s29, v11
    v_mul_u32_u24 v13, 80, v8
    v_lshl_add_u32 v13, v9, 4, v13
    s_mul_i32 s30, s28, 80
    s_add_u32 s30, s30, 4800
    s_sub_u32 s30, s30, 37632
    v_subrev_u32 v13, s30, v13
    v_mov_b32 v64, 0
    v_mov_b32 v65, 0
    v_mov_b32 v66, 0
    v_mov_b32 v67, 0
    v_mov_b32 v68, 0
    v_mov_b32 v69, 0
    v_mov_b32 v70, 0
    v_mov_b32 v71, 0
    v_mov_b32 v72, 0
    v_mov_b32 v73, 0
    v_mov_b32 v74, 0
    v_mov_b32 v75, 0
    v_mov_b32 v76, 0
    v_mov_b32 v77, 0
    v_mov_b32 v78, 0
    v_mov_b32 v79, 0
    v_mov_b32 v80, 0
    v_mov_b32 v81, 0
    v_mov_b32 v82, 0
    v_mov_b32 v83, 0
    v_mov_b32 v84, 0
    v_mov_b32 v85, 0
    v_mov_b32 v86, 0
    v_mov_b32 v87, 0
    v_mov_b32 v88, 0
    v_mov_b32 v89, 0
    v_mov_b32 v90, 0
    v_mov_b32 v91, 0
    v_mov_b32 v92, 0
    v_mov_b32 v93, 0
    v_mov_b32 v94, 0
    v_mov_b32 v95, 0
    ds_read_b128 v[16:19], v11 offset:3840
    ds_read_b128 v[24:27], v13 offset:7360
    ds_read_b128 v[32:35], v13 offset:4800
    ds_read_b128 v[20:23], v11 offset:3872
    ds_read_b128 v[28:31], v13 offset:7392
    ds_read_b128 v[36:39], v13 offset:4832
    ds_read_b128 v[40:43], v11 offset:3584
    ds_read_b128 v[48:51], v13 offset:7040
    ds_read_b128 v[56:59], v13 offset:4480
    ds_read_b128 v[44:47], v11 offset:3616
    ds_read_b128 v[52:55], v13 offset:7072
    ds_read_b128 v[60:63], v13 offset:4512
    s_waitcnt lgkmcnt(6)
    v_mfma_f32_32x32x16_bf16 v[80:95], v[16:19], v[24:27], v[80:95]
    v_mfma_f32_32x32x16_bf16 v[64:79], v[16:19], v[32:35], v[64:79]
    v_mfma_f32_32x32x16_bf16 v[80:95], v[20:23], v[28:31], v[80:95]
    v_mfma_f32_32x32x16_bf16 v[64:79], v[20:23], v[36:39], v[64:79]
    ds_read_b128 v[16:19], v11 offset:3328
    ds_read_b128 v[24:27], v13 offset:6720
    ds_read_b128 v[32:35], v13 offset:4160
    ds_read_b128 v[20:23], v11 offset:3360
    ds_read_b128 v[28:31], v13 offset:6752
    ds_read_b128 v[36:39], v13 offset:4192
    s_waitcnt lgkmcnt(6)
    v_mfma_f32_32x32x16_bf16 v[80:95], v[40:43], v[48:51], v[80:95]
    v_mfma_f32_32x32x16_bf16 v[64:79], v[40:43], v[56:59], v[64:79]
    v_mfma_f32_32x32x16_bf16 v[80:95], v[44:47], v[52:55], v[80:95]
    v_mfma_f32_32x32x16_bf16 v[64:79], v[44:47], v[60:63], v[64:79]
    ds_read_b128 v[40:43], v11 offset:3072
    ds_read_b128 v[48:51], v13 offset:6400
    ds_read_b128 v[56:59], v13 offset:3840
    ds_read_b128 v[44:47], v11 offset:3104
    ds_read_b128 v[52:55], v13 offset:6432
    ds_read_b128 v[60:63], v13 offset:3872
    s_waitcnt lgkmcnt(6)
    v_mfma_f32_32x32x16_bf16 v[80:95], v[16:19], v[24:27], v[80:95]
    v_mfma_f32_32x32x16_bf16 v[64:79], v[16:19], v[32:35], v[64:79]
    v_mfma_f32_32x32x16_bf16 v[80:95], v[20:23], v[28:31], v[80:95]
    v_mfma_f32_32x32x16_bf16 v[64:79], v[20:23], v[36:39], v[64:79]
    ds_read_b128 v[16:19], v11 offset:2816
    ds_read_b128 v[24:27], v13 offset:6080
    ds_read_b128 v[32:35], v13 offset:3520
    ds_read_b128 v[20:23], v11 offset:2848
    ds_read_b128 v[28:31], v13 offset:6112
    ds_read_b128 v[36:39], v13 offset:3552
    s_waitcnt lgkmcnt(6)
    v_mfma_f32_32x32x16_bf16 v[80:95], v[40:43], v[48:51], v[80:95]
    v_mfma_f32_32x32x16_bf16 v[64:79], v[40:43], v[56:59], v[64:79]
    v_mfma_f32_32x32x16_bf16 v[80:95], v[44:47], v[52:55], v[80:95]
    v_mfma_f32_32x32x16_bf16 v[64:79], v[44:47], v[60:63], v[64:79]
    ds_read_b128 v[40:43], v11 offset:2560
    ds_read_b128 v[48:51], v13 offset:5760
    ds_read_b128 v[56:59], v13 offset:3200
    ds_read_b128 v[44:47], v11 offset:2592
    ds_read_b128 v[52:55], v13 offset:5792
    ds_read_b128 v[60:63], v13 offset:3232
    s_waitcnt lgkmcnt(6)
    v_mfma_f32_32x32x16_bf16 v[80:95], v[16:19], v[24:27], v[80:95]
    v_mfma_f32_32x32x16_bf16 v[64:79], v[16:19], v[32:35], v[64:79]
    v_mfma_f32_32x32x16_bf16 v[80:95], v[20:23], v[28:31], v[80:95]
    v_mfma_f32_32x32x16_bf16 v[64:79], v[20:23], v[36:39], v[64:79]
    ds_read_b128 v[16:19], v11 offset:2304
    ds_read_b128 v[24:27], v13 offset:5440
    ds_read_b128 v[32:35], v13 offset:2880
    ds_read_b128 v[20:23], v11 offset:2336
    ds_read_b128 v[28:31], v13 offset:5472
    ds_read_b128 v[36:39], v13 offset:2912
    s_waitcnt lgkmcnt(6)
    v_mfma_f32_32x32x16_bf16 v[80:95], v[40:43], v[48:51], v[80:95]
    v_mfma_f32_32x32x16_bf16 v[64:79], v[40:43], v[56:59], v[64:79]
    v_mfma_f32_32x32x16_bf16 v[80:95], v[44:47], v[52:55], v[80:95]
    v_mfma_f32_32x32x16_bf16 v[64:79], v[44:47], v[60:63], v[64:79]
    ds_read_b128 v[40:43], v11 offset:2048
    ds_read_b128 v[48:51], v13 offset:5120
    ds_read_b128 v[56:59], v13 offset:2560
    ds_read_b128 v[44:47], v11 offset:2080
    ds_read_b128 v[52:55], v13 offset:5152
    ds_read_b128 v[60:63], v13 offset:2592
    s_waitcnt lgkmcnt(6)
    v_mfma_f32_32x32x16_bf16 v[80:95], v[16:19], v[24:27], v[80:95]
    v_mfma_f32_32x32x16_bf16 v[64:79], v[16:19], v[32:35], v[64:79]
    v_mfma_f32_32x32x16_bf16 v[80:95], v[20:23], v[28:31], v[80:95]
    v_mfma_f32_32x32x16_bf16 v[64:79], v[20:23], v[36:39], v[64:79]
    ds_read_b128 v[16:19], v11 offset:1792
    ds_read_b128 v[24:27], v13 offset:4800
    ds_read_b128 v[20:23], v11 offset:1824
    ds_read_b128 v[28:31], v13 offset:4832
    s_waitcnt lgkmcnt(4)
    v_mfma_f32_32x32x16_bf16 v[80:95], v[40:43], v[48:51], v[80:95]
    v_mfma_f32_32x32x16_bf16 v[64:79], v[40:43], v[56:59], v[64:79]
    v_mfma_f32_32x32x16_bf16 v[80:95], v[44:47], v[52:55], v[80:95]
    v_mfma_f32_32x32x16_bf16 v[64:79], v[44:47], v[60:63], v[64:79]
    ds_read_b128 v[40:43], v11 offset:1536
    ds_read_b128 v[48:51], v13 offset:4480
    ds_read_b128 v[44:47], v11 offset:1568
    ds_read_b128 v[52:55], v13 offset:4512
    s_waitcnt lgkmcnt(4)
    v_mfma_f32_32x32x16_bf16 v[80:95], v[16:19], v[24:27], v[80:95]
    v_mfma_f32_32x32x16_bf16 v[80:95], v[20:23], v[28:31], v[80:95]
    ds_read_b128 v[16:19], v11 offset:1280
    ds_read_b128 v[24:27], v13 offset:4160
    ds_read_b128 v[20:23], v11 offset:1312
    ds_read_b128 v[28:31], v13 offset:4192
    s_waitcnt lgkmcnt(4)
    v_mfma_f32_32x32x16_bf16 v[80:95], v[40:43], v[48:51], v[80:95]
    v_mfma_f32_32x32x16_bf16 v[80:95], v[44:47], v[52:55], v[80:95]
    ds_read_b128 v[40:43], v11 offset:1024
    ds_read_b128 v[48:51], v13 offset:3840
    ds_read_b128 v[44:47], v11 offset:1056
    ds_read_b128 v[52:55], v13 offset:3872
    s_waitcnt lgkmcnt(4)
    v_mfma_f32_32x32x16_bf16 v[80:95], v[16:19], v[24:27], v[80:95]
    v_mfma_f32_32x32x16_bf16 v[80:95], v[20:23], v[28:31], v[80:95]
    ds_read_b128 v[16:19], v11 offset:768
    ds_read_b128 v[24:27], v13 offset:3520
    ds_read_b128 v[20:23], v11 offset:800
    ds_read_b128 v[28:31], v13 offset:3552
    s_waitcnt lgkmcnt(4)
    v_mfma_f32_32x32x16_bf16 v[80:95], v[40:43], v[48:51], v[80:95]
    v_mfma_f32_32x32x16_bf16 v[80:95], v[44:47], v[52:55], v[80:95]
    ds_read_b128 v[40:43], v11 offset:512
    ds_read_b128 v[48:51], v13 offset:3200
    ds_read_b128 v[44:47], v11 offset:544
    ds_read_b128 v[52:55], v13 offset:3232
    s_waitcnt lgkmcnt(4)
    v_mfma_f32_32x32x16_bf16 v[80:95], v[16:19], v[24:27], v[80:95]
    v_mfma_f32_32x32x16_bf16 v[80:95], v[20:23], v[28:31], v[80:95]
    ds_read_b128 v[16:19], v11 offset:256
    ds_read_b128 v[24:27], v13 offset:2880
    ds_read_b128 v[20:23], v11 offset:288
    ds_read_b128 v[28:31], v13 offset:2912
    s_waitcnt lgkmcnt(4)
    v_mfma_f32_32x32x16_bf16 v[80:95], v[40:43], v[48:51], v[80:95]
    v_mfma_f32_32x32x16_bf16 v[80:95], v[44:47], v[52:55], v[80:95]
    ds_read_b128 v[40:43], v11 offset:0
    ds_read_b128 v[48:51], v13 offset:2560
    ds_read_b128 v[44:47], v11 offset:32
    ds_read_b128 v[52:55], v13 offset:2592
    s_waitcnt lgkmcnt(4)
    v_mfma_f32_32x32x16_bf16 v[80:95], v[16:19], v[24:27], v[80:95]
    v_mfma_f32_32x32x16_bf16 v[80:95], v[20:23], v[28:31], v[80:95]
    s_waitcnt lgkmcnt(0)
    v_mfma_f32_32x32x16_bf16 v[80:95], v[40:43], v[48:51], v[80:95]
    v_mfma_f32_32x32x16_bf16 v[80:95], v[44:47], v[52:55], v[80:95]
    s_nop 15
    s_nop 7
    s_barrier
    v_and_b32 v14, 63, v0
    v_lshlrev_b32 v14, 2, v14
    s_lshl_b32 s31, s28, 13
    v_add_u32 v15, s31, v14
    ds_write_b32 v15, v64 offset:0
    ds_write_b32 v15, v65 offset:256
    ds_write_b32 v15, v66 offset:512
    ds_write_b32 v15, v67 offset:768
    ds_write_b32 v15, v68 offset:1024
    ds_write_b32 v15, v69 offset:1280
    ds_write_b32 v15, v70 offset:1536
    ds_write_b32 v15, v71 offset:1792
    ds_write_b32 v15, v72 offset:2048
    ds_write_b32 v15, v73 offset:2304
    ds_write_b32 v15, v74 offset:2560
    ds_write_b32 v15, v75 offset:2816
    ds_write_b32 v15, v76 offset:3072
    ds_write_b32 v15, v77 offset:3328
    ds_write_b32 v15, v78 offset:3584
    ds_write_b32 v15, v79 offset:3840
    ds_write_b32 v15, v80 offset:4096
    ds_write_b32 v15, v81 offset:4352
    ds_write_b32 v15, v82 offset:4608
    ds_write_b32 v15, v83 offset:4864
    ds_write_b32 v15, v84 offset:5120
    ds_write_b32 v15, v85 offset:5376
    ds_write_b32 v15, v86 offset:5632
    ds_write_b32 v15, v87 offset:5888
    ds_write_b32 v15, v88 offset:6144
    ds_write_b32 v15, v89 offset:6400
    ds_write_b32 v15, v90 offset:6656
    ds_write_b32 v15, v91 offset:6912
    ds_write_b32 v15, v92 offset:7168
    ds_write_b32 v15, v93 offset:7424
    ds_write_b32 v15, v94 offset:7680
    ds_write_b32 v15, v95 offset:7936
    s_waitcnt lgkmcnt(0)
    s_barrier
    s_lshl_b32 s31, s28, 11
    v_add_u32 v15, s31, v14
    ds_read_b32 v16, v15 offset:0
    ds_read_b32 v17, v15 offset:256
    ds_read_b32 v18, v15 offset:512
    ds_read_b32 v19, v15 offset:768
    ds_read_b32 v20, v15 offset:1024
    ds_read_b32 v21, v15 offset:1280
    ds_read_b32 v22, v15 offset:1536
    ds_read_b32 v23, v15 offset:1792
    ds_read_b32 v24, v15 offset:8192
    ds_read_b32 v25, v15 offset:8448
    ds_read_b32 v26, v15 offset:8704
    ds_read_b32 v27, v15 offset:8960
    ds_read_b32 v28, v15 offset:9216
    ds_read_b32 v29, v15 offset:9472
    ds_read_b32 v30, v15 offset:9728
    ds_read_b32 v31, v15 offset:9984
    ds_read_b32 v32, v15 offset:16384
    ds_read_b32 v33, v15 offset:16640
    ds_read_b32 v34, v15 offset:16896
    ds_read_b32 v35, v15 offset:17152
    ds_read_b32 v36, v15 offset:17408
    ds_read_b32 v37, v15 offset:17664
    ds_read_b32 v38, v15 offset:17920
    ds_read_b32 v39, v15 offset:18176
    ds_read_b32 v40, v15 offset:24576
    ds_read_b32 v41, v15 offset:24832
    ds_read_b32 v42, v15 offset:25088
    ds_read_b32 v43, v15 offset:25344
    ds_read_b32 v44, v15 offset:25600
    ds_read_b32 v45, v15 offset:25856
    ds_read_b32 v46, v15 offset:26112
    ds_read_b32 v47, v15 offset:26368
    s_lshr_b32 s32, s28, 1
    s_and_b32 s33, s28, 1
    s_mul_i32 s34, s32, 2560
    s_lshl_b32 s35, s33, 5
    s_add_u32 s34, s34, s35
    v_mul_u32_u24 v5, 80, v8
    v_lshl_add_u32 v5, v9, 3, v5
    v_add_u32 v5, s34, v5
    ds_read_b64 v[48:49], v5 offset:37632
    ds_read_b64 v[50:51], v5 offset:37648
    v_lshlrev_b32 v125, 16, v124
    s_waitcnt lgkmcnt(0)
    v_add_f32 v16, v16, v24
    v_add_f32 v32, v32, v40
    v_add_f32 v16, v16, v32
    v_add_f32 v17, v17, v25
    v_add_f32 v33, v33, v41
    v_add_f32 v17, v17, v33
    v_add_f32 v18, v18, v26
    v_add_f32 v34, v34, v42
    v_add_f32 v18, v18, v34
    v_add_f32 v19, v19, v27
    v_add_f32 v35, v35, v43
    v_add_f32 v19, v19, v35
    v_add_f32 v20, v20, v28
    v_add_f32 v36, v36, v44
    v_add_f32 v20, v20, v36
    v_add_f32 v21, v21, v29
    v_add_f32 v37, v37, v45
    v_add_f32 v21, v21, v37
    v_add_f32 v22, v22, v30
    v_add_f32 v38, v38, v46
    v_add_f32 v22, v22, v38
    v_add_f32 v23, v23, v31
    v_add_f32 v39, v39, v47
    v_add_f32 v23, v23, v39
    v_lshlrev_b32 v52, 16, v48
    v_and_b32 v53, 0xffff0000, v48
    v_fmac_f32 v16, v52, v125
    v_fmac_f32 v17, v53, v125
    v_lshlrev_b32 v52, 16, v49
    v_and_b32 v53, 0xffff0000, v49
    v_fmac_f32 v18, v52, v125
    v_fmac_f32 v19, v53, v125
    v_cvt_pk_bf16_f32 v56, v16, v17
    v_cvt_pk_bf16_f32 v57, v18, v19
    v_lshlrev_b32 v52, 16, v50
    v_and_b32 v53, 0xffff0000, v50
    v_fmac_f32 v20, v52, v125
    v_fmac_f32 v21, v53, v125
    v_lshlrev_b32 v52, 16, v51
    v_and_b32 v53, 0xffff0000, v51
    v_fmac_f32 v22, v52, v125
    v_fmac_f32 v23, v53, v125
    v_cvt_pk_bf16_f32 v58, v20, v21
    v_cvt_pk_bf16_f32 v59, v22, v23
    s_lshl_b32 s34, s32, 11
    s_add_u32 s34, s34, s24
    s_add_u32 s34, s34, s35
    v_lshlrev_b32 v5, 6, v8
    v_lshl_add_u32 v5, v9, 3, v5
    v_add_u32 v5, s34, v5
    buffer_store_dwordx2 v[56:57], v5, s[16:19], 0 offen
    buffer_store_dwordx2 v[58:59], v5, s[16:19], 0 offen offset:16
conv_done:
    s_endpgm
.globl lnprep_kernel
.p2align 8
.type lnprep_kernel,@function
lnprep_kernel:
    s_cmp_ge_u32 s2, 64
    s_cbranch_scc1 lnprep_done
    s_load_dwordx2 s[4:5], s[0:1], 0
    s_load_dwordx2 s[36:37], s[0:1], 104
    s_lshl_b32 s32, s2, 5
    s_mov_b32 s42, 0x3b124925
    s_waitcnt lgkmcnt(0)
    s_mov_b32 s8, s4
    s_mov_b32 s9, s5
    s_mov_b32 s10, 0x1c0000
    s_mov_b32 s11, 0x00020000
    s_add_u32 s12, s36, 0x200000
    s_addc_u32 s13, s37, 0
    s_mov_b32 s14, 0x1c0000
    s_mov_b32 s15, 0x00020000
    s_add_u32 s16, s36, 0x800000
    s_addc_u32 s17, s37, 0
    s_mov_b32 s18, 0x1c0000
    s_mov_b32 s19, 0x00020000
    s_add_u32 s20, s36, 0x1c00000
    s_addc_u32 s21, s37, 0
    s_mov_b32 s22, 0x1c0000
    s_mov_b32 s23, 0x00020000
    v_lshrrev_b32 v1, 2, v0
    v_and_b32 v2, 3, v0
    v_lshlrev_b32 v3, 12, v1
    v_lshl_add_u32 v3, v2, 4, v3
    s_lshl_b32 s33, s32, 1
    v_add_u32 v3, s33, v3
    v_mul_u32_u24 v4, 80, v1
    v_lshl_add_u32 v4, v2, 4, v4
    v_add_u32 v5, 0x0, v3
    buffer_load_dwordx4 v[96:99], v5, s[12:15], 0 offen
    v_add_u32 v5, 0x40000, v3
    buffer_load_dwordx4 v[100:103], v5, s[12:15], 0 offen
    v_add_u32 v5, 0x80000, v3
    buffer_load_dwordx4 v[104:107], v5, s[12:15], 0 offen
    v_add_u32 v5, 0xc0000, v3
    buffer_load_dwordx4 v[108:111], v5, s[12:15], 0 offen
    v_add_u32 v5, 0x100000, v3
    buffer_load_dwordx4 v[112:115], v5, s[12:15], 0 offen
    v_add_u32 v5, 0x140000, v3
    buffer_load_dwordx4 v[116:119], v5, s[12:15], 0 offen
    v_add_u32 v5, 0x180000, v3
    buffer_load_dwordx4 v[120:123], v5, s[12:15], 0 offen
    v_lshrrev_b32 v6, 3, v0
    v_and_b32 v7, 7, v0
    v_add_u32 v8, s32, v6
    v_mul_u32_u24 v8, 896, v8
    v_mul_u32_u24 v9, 112, v7
    v_add_u32 v8, v8, v9
    buffer_load_dwordx4 v[64:67], v8, s[8:11], 0 offen offset:0
    buffer_load_dwordx4 v[68:71], v8, s[8:11], 0 offen offset:16
    buffer_load_dwordx4 v[72:75], v8, s[8:11], 0 offen offset:32
    buffer_load_dwordx4 v[76:79], v8, s[8:11], 0 offen offset:48
    buffer_load_dwordx4 v[80:83], v8, s[8:11], 0 offen offset:64
    buffer_load_dwordx4 v[84:87], v8, s[8:11], 0 offen offset:80
    buffer_load_dwordx4 v[88:91], v8, s[8:11], 0 offen offset:96
    s_waitcnt vmcnt(7)
    ds_write_b128 v4, v[96:99] offset:0
    ds_write_b128 v4, v[100:103] offset:5120
    ds_write_b128 v4, v[104:107] offset:10240
    ds_write_b128 v4, v[108:111] offset:15360
    ds_write_b128 v4, v[112:115] offset:20480
    ds_write_b128 v4, v[116:119] offset:25600
    ds_write_b128 v4, v[120:123] offset:30720
    s_waitcnt vmcnt(0) lgkmcnt(0)
    s_barrier
    v_lshlrev_b32 v96, 16, v64
    v_and_b32 v97, 0xffff0000, v64
    v_lshlrev_b32 v98, 16, v65
    v_and_b32 v99, 0xffff0000, v65
    v_lshlrev_b32 v100, 16, v66
    v_and_b32 v101, 0xffff0000, v66
    v_lshlrev_b32 v102, 16, v67
    v_and_b32 v103, 0xffff0000, v67
    v_lshlrev_b32 v104, 16, v68
    v_and_b32 v105, 0xffff0000, v68
    v_lshlrev_b32 v106, 16, v69
    v_and_b32 v107, 0xffff0000, v69
    v_lshlrev_b32 v108, 16, v70
    v_and_b32 v109, 0xffff0000, v70
    v_lshlrev_b32 v110, 16, v71
    v_and_b32 v111, 0xffff0000, v71
    v_lshlrev_b32 v112, 16, v72
    v_and_b32 v113, 0xffff0000, v72
    v_lshlrev_b32 v114, 16, v73
    v_and_b32 v115, 0xffff0000, v73
    v_lshlrev_b32 v116, 16, v74
    v_and_b32 v117, 0xffff0000, v74
    v_lshlrev_b32 v118, 16, v75
    v_and_b32 v119, 0xffff0000, v75
    v_lshlrev_b32 v120, 16, v76
    v_and_b32 v121, 0xffff0000, v76
    v_lshlrev_b32 v122, 16, v77
    v_and_b32 v123, 0xffff0000, v77
    v_lshlrev_b32 v124, 16, v78
    v_and_b32 v125, 0xffff0000, v78
    v_lshlrev_b32 v126, 16, v79
    v_and_b32 v127, 0xffff0000, v79
    v_lshlrev_b32 v128, 16, v80
    v_and_b32 v129, 0xffff0000, v80
    v_lshlrev_b32 v130, 16, v81
    v_and_b32 v131, 0xffff0000, v81
    v_lshlrev_b32 v132, 16, v82
    v_and_b32 v133, 0xffff0000, v82
    v_lshlrev_b32 v134, 16, v83
    v_and_b32 v135, 0xffff0000, v83
    v_lshlrev_b32 v136, 16, v84
    v_and_b32 v137, 0xffff0000, v84
    v_lshlrev_b32 v138, 16, v85
    v_and_b32 v139, 0xffff0000, v85
    v_lshlrev_b32 v140, 16, v86
    v_and_b32 v141, 0xffff0000, v86
    v_lshlrev_b32 v142, 16, v87
    v_and_b32 v143, 0xffff0000, v87
    v_lshlrev_b32 v144, 16, v88
    v_and_b32 v145, 0xffff0000, v88
    v_lshlrev_b32 v146, 16, v89
    v_and_b32 v147, 0xffff0000, v89
    v_lshlrev_b32 v148, 16, v90
    v_and_b32 v149, 0xffff0000, v90
    v_lshlrev_b32 v150, 16, v91
    v_and_b32 v151, 0xffff0000, v91
    v_mov_b32 v12, 0
    v_add_f32 v12, v12, v96
    v_add_f32 v12, v12, v97
    v_add_f32 v12, v12, v98
    v_add_f32 v12, v12, v99
    v_add_f32 v12, v12, v100
    v_add_f32 v12, v12, v101
    v_add_f32 v12, v12, v102
    v_add_f32 v12, v12, v103
    v_add_f32 v12, v12, v104
    v_add_f32 v12, v12, v105
    v_add_f32 v12, v12, v106
    v_add_f32 v12, v12, v107
    v_add_f32 v12, v12, v108
    v_add_f32 v12, v12, v109
    v_add_f32 v12, v12, v110
    v_add_f32 v12, v12, v111
    v_add_f32 v12, v12, v112
    v_add_f32 v12, v12, v113
    v_add_f32 v12, v12, v114
    v_add_f32 v12, v12, v115
    v_add_f32 v12, v12, v116
    v_add_f32 v12, v12, v117
    v_add_f32 v12, v12, v118
    v_add_f32 v12, v12, v119
    v_add_f32 v12, v12, v120
    v_add_f32 v12, v12, v121
    v_add_f32 v12, v12, v122
    v_add_f32 v12, v12, v123
    v_add_f32 v12, v12, v124
    v_add_f32 v12, v12, v125
    v_add_f32 v12, v12, v126
    v_add_f32 v12, v12, v127
    v_add_f32 v12, v12, v128
    v_add_f32 v12, v12, v129
    v_add_f32 v12, v12, v130
    v_add_f32 v12, v12, v131
    v_add_f32 v12, v12, v132
    v_add_f32 v12, v12, v133
    v_add_f32 v12, v12, v134
    v_add_f32 v12, v12, v135
    v_add_f32 v12, v12, v136
    v_add_f32 v12, v12, v137
    v_add_f32 v12, v12, v138
    v_add_f32 v12, v12, v139
    v_add_f32 v12, v12, v140
    v_add_f32 v12, v12, v141
    v_add_f32 v12, v12, v142
    v_add_f32 v12, v12, v143
    v_add_f32 v12, v12, v144
    v_add_f32 v12, v12, v145
    v_add_f32 v12, v12, v146
    v_add_f32 v12, v12, v147
    v_add_f32 v12, v12, v148
    v_add_f32 v12, v12, v149
    v_add_f32 v12, v12, v150
    v_add_f32 v12, v12, v151
    s_nop 1
    v_add_f32_dpp v12, v12, v12 quad_perm:[1,0,3,2] row_mask:0xf bank_mask:0xf
    s_nop 1
    v_add_f32_dpp v12, v12, v12 quad_perm:[2,3,0,1] row_mask:0xf bank_mask:0xf
    s_nop 1
    v_add_f32_dpp v12, v12, v12 row_half_mirror row_mask:0xf bank_mask:0xf
    s_nop 1
    v_mul_f32 v12, s42, v12
    v_mov_b32 v13, 0
    v_sub_f32 v14, v96, v12
    v_fmac_f32 v13, v14, v14
    v_sub_f32 v14, v97, v12
    v_fmac_f32 v13, v14, v14
    v_sub_f32 v14, v98, v12
    v_fmac_f32 v13, v14, v14
    v_sub_f32 v14, v99, v12
    v_fmac_f32 v13, v14, v14
    v_sub_f32 v14, v100, v12
    v_fmac_f32 v13, v14, v14
    v_sub_f32 v14, v101, v12
    v_fmac_f32 v13, v14, v14
    v_sub_f32 v14, v102, v12
    v_fmac_f32 v13, v14, v14
    v_sub_f32 v14, v103, v12
    v_fmac_f32 v13, v14, v14
    v_sub_f32 v14, v104, v12
    v_fmac_f32 v13, v14, v14
    v_sub_f32 v14, v105, v12
    v_fmac_f32 v13, v14, v14
    v_sub_f32 v14, v106, v12
    v_fmac_f32 v13, v14, v14
    v_sub_f32 v14, v107, v12
    v_fmac_f32 v13, v14, v14
    v_sub_f32 v14, v108, v12
    v_fmac_f32 v13, v14, v14
    v_sub_f32 v14, v109, v12
    v_fmac_f32 v13, v14, v14
    v_sub_f32 v14, v110, v12
    v_fmac_f32 v13, v14, v14
    v_sub_f32 v14, v111, v12
    v_fmac_f32 v13, v14, v14
    v_sub_f32 v14, v112, v12
    v_fmac_f32 v13, v14, v14
    v_sub_f32 v14, v113, v12
    v_fmac_f32 v13, v14, v14
    v_sub_f32 v14, v114, v12
    v_fmac_f32 v13, v14, v14
    v_sub_f32 v14, v115, v12
    v_fmac_f32 v13, v14, v14
    v_sub_f32 v14, v116, v12
    v_fmac_f32 v13, v14, v14
    v_sub_f32 v14, v117, v12
    v_fmac_f32 v13, v14, v14
    v_sub_f32 v14, v118, v12
    v_fmac_f32 v13, v14, v14
    v_sub_f32 v14, v119, v12
    v_fmac_f32 v13, v14, v14
    v_sub_f32 v14, v120, v12
    v_fmac_f32 v13, v14, v14
    v_sub_f32 v14, v121, v12
    v_fmac_f32 v13, v14, v14
    v_sub_f32 v14, v122, v12
    v_fmac_f32 v13, v14, v14
    v_sub_f32 v14, v123, v12
    v_fmac_f32 v13, v14, v14
    v_sub_f32 v14, v124, v12
    v_fmac_f32 v13, v14, v14
    v_sub_f32 v14, v125, v12
    v_fmac_f32 v13, v14, v14
    v_sub_f32 v14, v126, v12
    v_fmac_f32 v13, v14, v14
    v_sub_f32 v14, v127, v12
    v_fmac_f32 v13, v14, v14
    v_sub_f32 v14, v128, v12
    v_fmac_f32 v13, v14, v14
    v_sub_f32 v14, v129, v12
    v_fmac_f32 v13, v14, v14
    v_sub_f32 v14, v130, v12
    v_fmac_f32 v13, v14, v14
    v_sub_f32 v14, v131, v12
    v_fmac_f32 v13, v14, v14
    v_sub_f32 v14, v132, v12
    v_fmac_f32 v13, v14, v14
    v_sub_f32 v14, v133, v12
    v_fmac_f32 v13, v14, v14
    v_sub_f32 v14, v134, v12
    v_fmac_f32 v13, v14, v14
    v_sub_f32 v14, v135, v12
    v_fmac_f32 v13, v14, v14
    v_sub_f32 v14, v136, v12
    v_fmac_f32 v13, v14, v14
    v_sub_f32 v14, v137, v12
    v_fmac_f32 v13, v14, v14
    v_sub_f32 v14, v138, v12
    v_fmac_f32 v13, v14, v14
    v_sub_f32 v14, v139, v12
    v_fmac_f32 v13, v14, v14
    v_sub_f32 v14, v140, v12
    v_fmac_f32 v13, v14, v14
    v_sub_f32 v14, v141, v12
    v_fmac_f32 v13, v14, v14
    v_sub_f32 v14, v142, v12
    v_fmac_f32 v13, v14, v14
    v_sub_f32 v14, v143, v12
    v_fmac_f32 v13, v14, v14
    v_sub_f32 v14, v144, v12
    v_fmac_f32 v13, v14, v14
    v_sub_f32 v14, v145, v12
    v_fmac_f32 v13, v14, v14
    v_sub_f32 v14, v146, v12
    v_fmac_f32 v13, v14, v14
    v_sub_f32 v14, v147, v12
    v_fmac_f32 v13, v14, v14
    v_sub_f32 v14, v148, v12
    v_fmac_f32 v13, v14, v14
    v_sub_f32 v14, v149, v12
    v_fmac_f32 v13, v14, v14
    v_sub_f32 v14, v150, v12
    v_fmac_f32 v13, v14, v14
    v_sub_f32 v14, v151, v12
    v_fmac_f32 v13, v14, v14
    s_nop 1
    v_add_f32_dpp v13, v13, v13 quad_perm:[1,0,3,2] row_mask:0xf bank_mask:0xf
    s_nop 1
    v_add_f32_dpp v13, v13, v13 quad_perm:[2,3,0,1] row_mask:0xf bank_mask:0xf
    s_nop 1
    v_add_f32_dpp v13, v13, v13 row_half_mirror row_mask:0xf bank_mask:0xf
    s_nop 1
    v_mov_b32 v14, 0x3727c5ac
    v_fma_f32 v13, v13, s42, v14
    v_rsq_f32 v13, v13
    s_nop 0
    v_mul_u32_u24 v15, 4480, v7
    v_lshl_add_u32 v15, v6, 1, v15
    ds_read_u16 v16, v15 offset:0
    ds_read_u16 v17, v15 offset:80
    ds_read_u16 v18, v15 offset:160
    ds_read_u16 v19, v15 offset:240
    ds_read_u16 v20, v15 offset:320
    ds_read_u16 v21, v15 offset:400
    ds_read_u16 v22, v15 offset:480
    ds_read_u16 v23, v15 offset:560
    ds_read_u16 v24, v15 offset:640
    ds_read_u16 v25, v15 offset:720
    ds_read_u16 v26, v15 offset:800
    ds_read_u16 v27, v15 offset:880
    ds_read_u16 v28, v15 offset:960
    ds_read_u16 v29, v15 offset:1040
    ds_read_u16 v30, v15 offset:1120
    ds_read_u16 v31, v15 offset:1200
    ds_read_u16 v32, v15 offset:1280
    ds_read_u16 v33, v15 offset:1360
    ds_read_u16 v34, v15 offset:1440
    ds_read_u16 v35, v15 offset:1520
    ds_read_u16 v36, v15 offset:1600
    ds_read_u16 v37, v15 offset:1680
    ds_read_u16 v38, v15 offset:1760
    ds_read_u16 v39, v15 offset:1840
    ds_read_u16 v40, v15 offset:1920
    ds_read_u16 v41, v15 offset:2000
    ds_read_u16 v42, v15 offset:2080
    ds_read_u16 v43, v15 offset:2160
    ds_read_u16 v64, v15 offset:2240
    ds_read_u16 v65, v15 offset:2320
    ds_read_u16 v66, v15 offset:2400
    ds_read_u16 v67, v15 offset:2480
    ds_read_u16 v68, v15 offset:2560
    ds_read_u16 v69, v15 offset:2640
    ds_read_u16 v70, v15 offset:2720
    ds_read_u16 v71, v15 offset:2800
    ds_read_u16 v72, v15 offset:2880
    ds_read_u16 v73, v15 offset:2960
    ds_read_u16 v74, v15 offset:3040
    ds_read_u16 v75, v15 offset:3120
    ds_read_u16 v76, v15 offset:3200
    ds_read_u16 v77, v15 offset:3280
    ds_read_u16 v78, v15 offset:3360
    ds_read_u16 v79, v15 offset:3440
    ds_read_u16 v80, v15 offset:3520
    ds_read_u16 v81, v15 offset:3600
    ds_read_u16 v82, v15 offset:3680
    ds_read_u16 v83, v15 offset:3760
    ds_read_u16 v84, v15 offset:3840
    ds_read_u16 v85, v15 offset:3920
    ds_read_u16 v86, v15 offset:4000
    ds_read_u16 v87, v15 offset:4080
    ds_read_u16 v88, v15 offset:4160
    ds_read_u16 v89, v15 offset:4240
    ds_read_u16 v90, v15 offset:4320
    ds_read_u16 v91, v15 offset:4400
    s_waitcnt lgkmcnt(0)
    v_lshlrev_b32 v16, 16, v16
    v_sub_f32 v14, v96, v12
    v_mul_f32 v14, v14, v13
    v_fmac_f32 v96, v14, v16
    v_lshlrev_b32 v17, 16, v17
    v_sub_f32 v14, v97, v12
    v_mul_f32 v14, v14, v13
    v_fmac_f32 v97, v14, v17
    v_lshlrev_b32 v18, 16, v18
    v_sub_f32 v14, v98, v12
    v_mul_f32 v14, v14, v13
    v_fmac_f32 v98, v14, v18
    v_lshlrev_b32 v19, 16, v19
    v_sub_f32 v14, v99, v12
    v_mul_f32 v14, v14, v13
    v_fmac_f32 v99, v14, v19
    v_lshlrev_b32 v20, 16, v20
    v_sub_f32 v14, v100, v12
    v_mul_f32 v14, v14, v13
    v_fmac_f32 v100, v14, v20
    v_lshlrev_b32 v21, 16, v21
    v_sub_f32 v14, v101, v12
    v_mul_f32 v14, v14, v13
    v_fmac_f32 v101, v14, v21
    v_lshlrev_b32 v22, 16, v22
    v_sub_f32 v14, v102, v12
    v_mul_f32 v14, v14, v13
    v_fmac_f32 v102, v14, v22
    v_lshlrev_b32 v23, 16, v23
    v_sub_f32 v14, v103, v12
    v_mul_f32 v14, v14, v13
    v_fmac_f32 v103, v14, v23
    v_lshlrev_b32 v24, 16, v24
    v_sub_f32 v14, v104, v12
    v_mul_f32 v14, v14, v13
    v_fmac_f32 v104, v14, v24
    v_lshlrev_b32 v25, 16, v25
    v_sub_f32 v14, v105, v12
    v_mul_f32 v14, v14, v13
    v_fmac_f32 v105, v14, v25
    v_lshlrev_b32 v26, 16, v26
    v_sub_f32 v14, v106, v12
    v_mul_f32 v14, v14, v13
    v_fmac_f32 v106, v14, v26
    v_lshlrev_b32 v27, 16, v27
    v_sub_f32 v14, v107, v12
    v_mul_f32 v14, v14, v13
    v_fmac_f32 v107, v14, v27
    v_lshlrev_b32 v28, 16, v28
    v_sub_f32 v14, v108, v12
    v_mul_f32 v14, v14, v13
    v_fmac_f32 v108, v14, v28
    v_lshlrev_b32 v29, 16, v29
    v_sub_f32 v14, v109, v12
    v_mul_f32 v14, v14, v13
    v_fmac_f32 v109, v14, v29
    v_lshlrev_b32 v30, 16, v30
    v_sub_f32 v14, v110, v12
    v_mul_f32 v14, v14, v13
    v_fmac_f32 v110, v14, v30
    v_lshlrev_b32 v31, 16, v31
    v_sub_f32 v14, v111, v12
    v_mul_f32 v14, v14, v13
    v_fmac_f32 v111, v14, v31
    v_lshlrev_b32 v32, 16, v32
    v_sub_f32 v14, v112, v12
    v_mul_f32 v14, v14, v13
    v_fmac_f32 v112, v14, v32
    v_lshlrev_b32 v33, 16, v33
    v_sub_f32 v14, v113, v12
    v_mul_f32 v14, v14, v13
    v_fmac_f32 v113, v14, v33
    v_lshlrev_b32 v34, 16, v34
    v_sub_f32 v14, v114, v12
    v_mul_f32 v14, v14, v13
    v_fmac_f32 v114, v14, v34
    v_lshlrev_b32 v35, 16, v35
    v_sub_f32 v14, v115, v12
    v_mul_f32 v14, v14, v13
    v_fmac_f32 v115, v14, v35
    v_lshlrev_b32 v36, 16, v36
    v_sub_f32 v14, v116, v12
    v_mul_f32 v14, v14, v13
    v_fmac_f32 v116, v14, v36
    v_lshlrev_b32 v37, 16, v37
    v_sub_f32 v14, v117, v12
    v_mul_f32 v14, v14, v13
    v_fmac_f32 v117, v14, v37
    v_lshlrev_b32 v38, 16, v38
    v_sub_f32 v14, v118, v12
    v_mul_f32 v14, v14, v13
    v_fmac_f32 v118, v14, v38
    v_lshlrev_b32 v39, 16, v39
    v_sub_f32 v14, v119, v12
    v_mul_f32 v14, v14, v13
    v_fmac_f32 v119, v14, v39
    v_lshlrev_b32 v40, 16, v40
    v_sub_f32 v14, v120, v12
    v_mul_f32 v14, v14, v13
    v_fmac_f32 v120, v14, v40
    v_lshlrev_b32 v41, 16, v41
    v_sub_f32 v14, v121, v12
    v_mul_f32 v14, v14, v13
    v_fmac_f32 v121, v14, v41
    v_lshlrev_b32 v42, 16, v42
    v_sub_f32 v14, v122, v12
    v_mul_f32 v14, v14, v13
    v_fmac_f32 v122, v14, v42
    v_lshlrev_b32 v43, 16, v43
    v_sub_f32 v14, v123, v12
    v_mul_f32 v14, v14, v13
    v_fmac_f32 v123, v14, v43
    v_lshlrev_b32 v64, 16, v64
    v_sub_f32 v14, v124, v12
    v_mul_f32 v14, v14, v13
    v_fmac_f32 v124, v14, v64
    v_lshlrev_b32 v65, 16, v65
    v_sub_f32 v14, v125, v12
    v_mul_f32 v14, v14, v13
    v_fmac_f32 v125, v14, v65
    v_lshlrev_b32 v66, 16, v66
    v_sub_f32 v14, v126, v12
    v_mul_f32 v14, v14, v13
    v_fmac_f32 v126, v14, v66
    v_lshlrev_b32 v67, 16, v67
    v_sub_f32 v14, v127, v12
    v_mul_f32 v14, v14, v13
    v_fmac_f32 v127, v14, v67
    v_lshlrev_b32 v68, 16, v68
    v_sub_f32 v14, v128, v12
    v_mul_f32 v14, v14, v13
    v_fmac_f32 v128, v14, v68
    v_lshlrev_b32 v69, 16, v69
    v_sub_f32 v14, v129, v12
    v_mul_f32 v14, v14, v13
    v_fmac_f32 v129, v14, v69
    v_lshlrev_b32 v70, 16, v70
    v_sub_f32 v14, v130, v12
    v_mul_f32 v14, v14, v13
    v_fmac_f32 v130, v14, v70
    v_lshlrev_b32 v71, 16, v71
    v_sub_f32 v14, v131, v12
    v_mul_f32 v14, v14, v13
    v_fmac_f32 v131, v14, v71
    v_lshlrev_b32 v72, 16, v72
    v_sub_f32 v14, v132, v12
    v_mul_f32 v14, v14, v13
    v_fmac_f32 v132, v14, v72
    v_lshlrev_b32 v73, 16, v73
    v_sub_f32 v14, v133, v12
    v_mul_f32 v14, v14, v13
    v_fmac_f32 v133, v14, v73
    v_lshlrev_b32 v74, 16, v74
    v_sub_f32 v14, v134, v12
    v_mul_f32 v14, v14, v13
    v_fmac_f32 v134, v14, v74
    v_lshlrev_b32 v75, 16, v75
    v_sub_f32 v14, v135, v12
    v_mul_f32 v14, v14, v13
    v_fmac_f32 v135, v14, v75
    v_lshlrev_b32 v76, 16, v76
    v_sub_f32 v14, v136, v12
    v_mul_f32 v14, v14, v13
    v_fmac_f32 v136, v14, v76
    v_lshlrev_b32 v77, 16, v77
    v_sub_f32 v14, v137, v12
    v_mul_f32 v14, v14, v13
    v_fmac_f32 v137, v14, v77
    v_lshlrev_b32 v78, 16, v78
    v_sub_f32 v14, v138, v12
    v_mul_f32 v14, v14, v13
    v_fmac_f32 v138, v14, v78
    v_lshlrev_b32 v79, 16, v79
    v_sub_f32 v14, v139, v12
    v_mul_f32 v14, v14, v13
    v_fmac_f32 v139, v14, v79
    v_lshlrev_b32 v80, 16, v80
    v_sub_f32 v14, v140, v12
    v_mul_f32 v14, v14, v13
    v_fmac_f32 v140, v14, v80
    v_lshlrev_b32 v81, 16, v81
    v_sub_f32 v14, v141, v12
    v_mul_f32 v14, v14, v13
    v_fmac_f32 v141, v14, v81
    v_lshlrev_b32 v82, 16, v82
    v_sub_f32 v14, v142, v12
    v_mul_f32 v14, v14, v13
    v_fmac_f32 v142, v14, v82
    v_lshlrev_b32 v83, 16, v83
    v_sub_f32 v14, v143, v12
    v_mul_f32 v14, v14, v13
    v_fmac_f32 v143, v14, v83
    v_lshlrev_b32 v84, 16, v84
    v_sub_f32 v14, v144, v12
    v_mul_f32 v14, v14, v13
    v_fmac_f32 v144, v14, v84
    v_lshlrev_b32 v85, 16, v85
    v_sub_f32 v14, v145, v12
    v_mul_f32 v14, v14, v13
    v_fmac_f32 v145, v14, v85
    v_lshlrev_b32 v86, 16, v86
    v_sub_f32 v14, v146, v12
    v_mul_f32 v14, v14, v13
    v_fmac_f32 v146, v14, v86
    v_lshlrev_b32 v87, 16, v87
    v_sub_f32 v14, v147, v12
    v_mul_f32 v14, v14, v13
    v_fmac_f32 v147, v14, v87
    v_lshlrev_b32 v88, 16, v88
    v_sub_f32 v14, v148, v12
    v_mul_f32 v14, v14, v13
    v_fmac_f32 v148, v14, v88
    v_lshlrev_b32 v89, 16, v89
    v_sub_f32 v14, v149, v12
    v_mul_f32 v14, v14, v13
    v_fmac_f32 v149, v14, v89
    v_lshlrev_b32 v90, 16, v90
    v_sub_f32 v14, v150, v12
    v_mul_f32 v14, v14, v13
    v_fmac_f32 v150, v14, v90
    v_lshlrev_b32 v91, 16, v91
    v_sub_f32 v14, v151, v12
    v_mul_f32 v14, v14, v13
    v_fmac_f32 v151, v14, v91
    v_cvt_pk_bf16_f32 v64, v96, v97
    v_cvt_pk_bf16_f32 v65, v98, v99
    v_cvt_pk_bf16_f32 v66, v100, v101
    v_cvt_pk_bf16_f32 v67, v102, v103
    v_cvt_pk_bf16_f32 v68, v104, v105
    v_cvt_pk_bf16_f32 v69, v106, v107
    v_cvt_pk_bf16_f32 v70, v108, v109
    v_cvt_pk_bf16_f32 v71, v110, v111
    v_cvt_pk_bf16_f32 v72, v112, v113
    v_cvt_pk_bf16_f32 v73, v114, v115
    v_cvt_pk_bf16_f32 v74, v116, v117
    v_cvt_pk_bf16_f32 v75, v118, v119
    v_cvt_pk_bf16_f32 v76, v120, v121
    v_cvt_pk_bf16_f32 v77, v122, v123
    v_cvt_pk_bf16_f32 v78, v124, v125
    v_cvt_pk_bf16_f32 v79, v126, v127
    v_cvt_pk_bf16_f32 v80, v128, v129
    v_cvt_pk_bf16_f32 v81, v130, v131
    v_cvt_pk_bf16_f32 v82, v132, v133
    v_cvt_pk_bf16_f32 v83, v134, v135
    v_cvt_pk_bf16_f32 v84, v136, v137
    v_cvt_pk_bf16_f32 v85, v138, v139
    v_cvt_pk_bf16_f32 v86, v140, v141
    v_cvt_pk_bf16_f32 v87, v142, v143
    v_cvt_pk_bf16_f32 v88, v144, v145
    v_cvt_pk_bf16_f32 v89, v146, v147
    v_cvt_pk_bf16_f32 v90, v148, v149
    v_cvt_pk_bf16_f32 v91, v150, v151
    v_lshlrev_b32 v96, 16, v64
    v_and_b32 v97, 0xffff0000, v64
    v_lshlrev_b32 v98, 16, v65
    v_and_b32 v99, 0xffff0000, v65
    v_lshlrev_b32 v100, 16, v66
    v_and_b32 v101, 0xffff0000, v66
    v_lshlrev_b32 v102, 16, v67
    v_and_b32 v103, 0xffff0000, v67
    v_lshlrev_b32 v104, 16, v68
    v_and_b32 v105, 0xffff0000, v68
    v_lshlrev_b32 v106, 16, v69
    v_and_b32 v107, 0xffff0000, v69
    v_lshlrev_b32 v108, 16, v70
    v_and_b32 v109, 0xffff0000, v70
    v_lshlrev_b32 v110, 16, v71
    v_and_b32 v111, 0xffff0000, v71
    v_lshlrev_b32 v112, 16, v72
    v_and_b32 v113, 0xffff0000, v72
    v_lshlrev_b32 v114, 16, v73
    v_and_b32 v115, 0xffff0000, v73
    v_lshlrev_b32 v116, 16, v74
    v_and_b32 v117, 0xffff0000, v74
    v_lshlrev_b32 v118, 16, v75
    v_and_b32 v119, 0xffff0000, v75
    v_lshlrev_b32 v120, 16, v76
    v_and_b32 v121, 0xffff0000, v76
    v_lshlrev_b32 v122, 16, v77
    v_and_b32 v123, 0xffff0000, v77
    v_lshlrev_b32 v124, 16, v78
    v_and_b32 v125, 0xffff0000, v78
    v_lshlrev_b32 v126, 16, v79
    v_and_b32 v127, 0xffff0000, v79
    v_lshlrev_b32 v128, 16, v80
    v_and_b32 v129, 0xffff0000, v80
    v_lshlrev_b32 v130, 16, v81
    v_and_b32 v131, 0xffff0000, v81
    v_lshlrev_b32 v132, 16, v82
    v_and_b32 v133, 0xffff0000, v82
    v_lshlrev_b32 v134, 16, v83
    v_and_b32 v135, 0xffff0000, v83
    v_lshlrev_b32 v136, 16, v84
    v_and_b32 v137, 0xffff0000, v84
    v_lshlrev_b32 v138, 16, v85
    v_and_b32 v139, 0xffff0000, v85
    v_lshlrev_b32 v140, 16, v86
    v_and_b32 v141, 0xffff0000, v86
    v_lshlrev_b32 v142, 16, v87
    v_and_b32 v143, 0xffff0000, v87
    v_lshlrev_b32 v144, 16, v88
    v_and_b32 v145, 0xffff0000, v88
    v_lshlrev_b32 v146, 16, v89
    v_and_b32 v147, 0xffff0000, v89
    v_lshlrev_b32 v148, 16, v90
    v_and_b32 v149, 0xffff0000, v90
    v_lshlrev_b32 v150, 16, v91
    v_and_b32 v151, 0xffff0000, v91
    v_mov_b32 v12, 0
    v_add_f32 v12, v12, v96
    v_add_f32 v12, v12, v97
    v_add_f32 v12, v12, v98
    v_add_f32 v12, v12, v99
    v_add_f32 v12, v12, v100
    v_add_f32 v12, v12, v101
    v_add_f32 v12, v12, v102
    v_add_f32 v12, v12, v103
    v_add_f32 v12, v12, v104
    v_add_f32 v12, v12, v105
    v_add_f32 v12, v12, v106
    v_add_f32 v12, v12, v107
    v_add_f32 v12, v12, v108
    v_add_f32 v12, v12, v109
    v_add_f32 v12, v12, v110
    v_add_f32 v12, v12, v111
    v_add_f32 v12, v12, v112
    v_add_f32 v12, v12, v113
    v_add_f32 v12, v12, v114
    v_add_f32 v12, v12, v115
    v_add_f32 v12, v12, v116
    v_add_f32 v12, v12, v117
    v_add_f32 v12, v12, v118
    v_add_f32 v12, v12, v119
    v_add_f32 v12, v12, v120
    v_add_f32 v12, v12, v121
    v_add_f32 v12, v12, v122
    v_add_f32 v12, v12, v123
    v_add_f32 v12, v12, v124
    v_add_f32 v12, v12, v125
    v_add_f32 v12, v12, v126
    v_add_f32 v12, v12, v127
    v_add_f32 v12, v12, v128
    v_add_f32 v12, v12, v129
    v_add_f32 v12, v12, v130
    v_add_f32 v12, v12, v131
    v_add_f32 v12, v12, v132
    v_add_f32 v12, v12, v133
    v_add_f32 v12, v12, v134
    v_add_f32 v12, v12, v135
    v_add_f32 v12, v12, v136
    v_add_f32 v12, v12, v137
    v_add_f32 v12, v12, v138
    v_add_f32 v12, v12, v139
    v_add_f32 v12, v12, v140
    v_add_f32 v12, v12, v141
    v_add_f32 v12, v12, v142
    v_add_f32 v12, v12, v143
    v_add_f32 v12, v12, v144
    v_add_f32 v12, v12, v145
    v_add_f32 v12, v12, v146
    v_add_f32 v12, v12, v147
    v_add_f32 v12, v12, v148
    v_add_f32 v12, v12, v149
    v_add_f32 v12, v12, v150
    v_add_f32 v12, v12, v151
    s_nop 1
    v_add_f32_dpp v12, v12, v12 quad_perm:[1,0,3,2] row_mask:0xf bank_mask:0xf
    s_nop 1
    v_add_f32_dpp v12, v12, v12 quad_perm:[2,3,0,1] row_mask:0xf bank_mask:0xf
    s_nop 1
    v_add_f32_dpp v12, v12, v12 row_half_mirror row_mask:0xf bank_mask:0xf
    s_nop 1
    v_mul_f32 v12, s42, v12
    v_mov_b32 v13, 0
    v_sub_f32 v14, v96, v12
    v_fmac_f32 v13, v14, v14
    v_sub_f32 v14, v97, v12
    v_fmac_f32 v13, v14, v14
    v_sub_f32 v14, v98, v12
    v_fmac_f32 v13, v14, v14
    v_sub_f32 v14, v99, v12
    v_fmac_f32 v13, v14, v14
    v_sub_f32 v14, v100, v12
    v_fmac_f32 v13, v14, v14
    v_sub_f32 v14, v101, v12
    v_fmac_f32 v13, v14, v14
    v_sub_f32 v14, v102, v12
    v_fmac_f32 v13, v14, v14
    v_sub_f32 v14, v103, v12
    v_fmac_f32 v13, v14, v14
    v_sub_f32 v14, v104, v12
    v_fmac_f32 v13, v14, v14
    v_sub_f32 v14, v105, v12
    v_fmac_f32 v13, v14, v14
    v_sub_f32 v14, v106, v12
    v_fmac_f32 v13, v14, v14
    v_sub_f32 v14, v107, v12
    v_fmac_f32 v13, v14, v14
    v_sub_f32 v14, v108, v12
    v_fmac_f32 v13, v14, v14
    v_sub_f32 v14, v109, v12
    v_fmac_f32 v13, v14, v14
    v_sub_f32 v14, v110, v12
    v_fmac_f32 v13, v14, v14
    v_sub_f32 v14, v111, v12
    v_fmac_f32 v13, v14, v14
    v_sub_f32 v14, v112, v12
    v_fmac_f32 v13, v14, v14
    v_sub_f32 v14, v113, v12
    v_fmac_f32 v13, v14, v14
    v_sub_f32 v14, v114, v12
    v_fmac_f32 v13, v14, v14
    v_sub_f32 v14, v115, v12
    v_fmac_f32 v13, v14, v14
    v_sub_f32 v14, v116, v12
    v_fmac_f32 v13, v14, v14
    v_sub_f32 v14, v117, v12
    v_fmac_f32 v13, v14, v14
    v_sub_f32 v14, v118, v12
    v_fmac_f32 v13, v14, v14
    v_sub_f32 v14, v119, v12
    v_fmac_f32 v13, v14, v14
    v_sub_f32 v14, v120, v12
    v_fmac_f32 v13, v14, v14
    v_sub_f32 v14, v121, v12
    v_fmac_f32 v13, v14, v14
    v_sub_f32 v14, v122, v12
    v_fmac_f32 v13, v14, v14
    v_sub_f32 v14, v123, v12
    v_fmac_f32 v13, v14, v14
    v_sub_f32 v14, v124, v12
    v_fmac_f32 v13, v14, v14
    v_sub_f32 v14, v125, v12
    v_fmac_f32 v13, v14, v14
    v_sub_f32 v14, v126, v12
    v_fmac_f32 v13, v14, v14
    v_sub_f32 v14, v127, v12
    v_fmac_f32 v13, v14, v14
    v_sub_f32 v14, v128, v12
    v_fmac_f32 v13, v14, v14
    v_sub_f32 v14, v129, v12
    v_fmac_f32 v13, v14, v14
    v_sub_f32 v14, v130, v12
    v_fmac_f32 v13, v14, v14
    v_sub_f32 v14, v131, v12
    v_fmac_f32 v13, v14, v14
    v_sub_f32 v14, v132, v12
    v_fmac_f32 v13, v14, v14
    v_sub_f32 v14, v133, v12
    v_fmac_f32 v13, v14, v14
    v_sub_f32 v14, v134, v12
    v_fmac_f32 v13, v14, v14
    v_sub_f32 v14, v135, v12
    v_fmac_f32 v13, v14, v14
    v_sub_f32 v14, v136, v12
    v_fmac_f32 v13, v14, v14
    v_sub_f32 v14, v137, v12
    v_fmac_f32 v13, v14, v14
    v_sub_f32 v14, v138, v12
    v_fmac_f32 v13, v14, v14
    v_sub_f32 v14, v139, v12
    v_fmac_f32 v13, v14, v14
    v_sub_f32 v14, v140, v12
    v_fmac_f32 v13, v14, v14
    v_sub_f32 v14, v141, v12
    v_fmac_f32 v13, v14, v14
    v_sub_f32 v14, v142, v12
    v_fmac_f32 v13, v14, v14
    v_sub_f32 v14, v143, v12
    v_fmac_f32 v13, v14, v14
    v_sub_f32 v14, v144, v12
    v_fmac_f32 v13, v14, v14
    v_sub_f32 v14, v145, v12
    v_fmac_f32 v13, v14, v14
    v_sub_f32 v14, v146, v12
    v_fmac_f32 v13, v14, v14
    v_sub_f32 v14, v147, v12
    v_fmac_f32 v13, v14, v14
    v_sub_f32 v14, v148, v12
    v_fmac_f32 v13, v14, v14
    v_sub_f32 v14, v149, v12
    v_fmac_f32 v13, v14, v14
    v_sub_f32 v14, v150, v12
    v_fmac_f32 v13, v14, v14
    v_sub_f32 v14, v151, v12
    v_fmac_f32 v13, v14, v14
    s_nop 1
    v_add_f32_dpp v13, v13, v13 quad_perm:[1,0,3,2] row_mask:0xf bank_mask:0xf
    s_nop 1
    v_add_f32_dpp v13, v13, v13 quad_perm:[2,3,0,1] row_mask:0xf bank_mask:0xf
    s_nop 1
    v_add_f32_dpp v13, v13, v13 row_half_mirror row_mask:0xf bank_mask:0xf
    s_nop 1
    v_mov_b32 v14, 0x3727c5ac
    v_fma_f32 v13, v13, s42, v14
    v_rsq_f32 v13, v13
    s_nop 0
    buffer_store_dwordx4 v[64:67], v8, s[16:19], 0 offen offset:0
    buffer_store_dwordx4 v[68:71], v8, s[16:19], 0 offen offset:16
    buffer_store_dwordx4 v[72:75], v8, s[16:19], 0 offen offset:32
    buffer_store_dwordx4 v[76:79], v8, s[16:19], 0 offen offset:48
    buffer_store_dwordx4 v[80:83], v8, s[16:19], 0 offen offset:64
    buffer_store_dwordx4 v[84:87], v8, s[16:19], 0 offen offset:80
    buffer_store_dwordx4 v[88:91], v8, s[16:19], 0 offen offset:96
    v_sub_f32 v96, v96, v12
    v_sub_f32 v97, v97, v12
    v_mul_f32 v96, v96, v13
    v_mul_f32 v97, v97, v13
    v_cvt_pk_bf16_f32 v16, v96, v97
    v_sub_f32 v98, v98, v12
    v_sub_f32 v99, v99, v12
    v_mul_f32 v98, v98, v13
    v_mul_f32 v99, v99, v13
    v_cvt_pk_bf16_f32 v17, v98, v99
    v_sub_f32 v100, v100, v12
    v_sub_f32 v101, v101, v12
    v_mul_f32 v100, v100, v13
    v_mul_f32 v101, v101, v13
    v_cvt_pk_bf16_f32 v18, v100, v101
    v_sub_f32 v102, v102, v12
    v_sub_f32 v103, v103, v12
    v_mul_f32 v102, v102, v13
    v_mul_f32 v103, v103, v13
    v_cvt_pk_bf16_f32 v19, v102, v103
    v_sub_f32 v104, v104, v12
    v_sub_f32 v105, v105, v12
    v_mul_f32 v104, v104, v13
    v_mul_f32 v105, v105, v13
    v_cvt_pk_bf16_f32 v20, v104, v105
    v_sub_f32 v106, v106, v12
    v_sub_f32 v107, v107, v12
    v_mul_f32 v106, v106, v13
    v_mul_f32 v107, v107, v13
    v_cvt_pk_bf16_f32 v21, v106, v107
    v_sub_f32 v108, v108, v12
    v_sub_f32 v109, v109, v12
    v_mul_f32 v108, v108, v13
    v_mul_f32 v109, v109, v13
    v_cvt_pk_bf16_f32 v22, v108, v109
    v_sub_f32 v110, v110, v12
    v_sub_f32 v111, v111, v12
    v_mul_f32 v110, v110, v13
    v_mul_f32 v111, v111, v13
    v_cvt_pk_bf16_f32 v23, v110, v111
    v_sub_f32 v112, v112, v12
    v_sub_f32 v113, v113, v12
    v_mul_f32 v112, v112, v13
    v_mul_f32 v113, v113, v13
    v_cvt_pk_bf16_f32 v24, v112, v113
    v_sub_f32 v114, v114, v12
    v_sub_f32 v115, v115, v12
    v_mul_f32 v114, v114, v13
    v_mul_f32 v115, v115, v13
    v_cvt_pk_bf16_f32 v25, v114, v115
    v_sub_f32 v116, v116, v12
    v_sub_f32 v117, v117, v12
    v_mul_f32 v116, v116, v13
    v_mul_f32 v117, v117, v13
    v_cvt_pk_bf16_f32 v26, v116, v117
    v_sub_f32 v118, v118, v12
    v_sub_f32 v119, v119, v12
    v_mul_f32 v118, v118, v13
    v_mul_f32 v119, v119, v13
    v_cvt_pk_bf16_f32 v27, v118, v119
    v_sub_f32 v120, v120, v12
    v_sub_f32 v121, v121, v12
    v_mul_f32 v120, v120, v13
    v_mul_f32 v121, v121, v13
    v_cvt_pk_bf16_f32 v28, v120, v121
    v_sub_f32 v122, v122, v12
    v_sub_f32 v123, v123, v12
    v_mul_f32 v122, v122, v13
    v_mul_f32 v123, v123, v13
    v_cvt_pk_bf16_f32 v29, v122, v123
    v_sub_f32 v124, v124, v12
    v_sub_f32 v125, v125, v12
    v_mul_f32 v124, v124, v13
    v_mul_f32 v125, v125, v13
    v_cvt_pk_bf16_f32 v30, v124, v125
    v_sub_f32 v126, v126, v12
    v_sub_f32 v127, v127, v12
    v_mul_f32 v126, v126, v13
    v_mul_f32 v127, v127, v13
    v_cvt_pk_bf16_f32 v31, v126, v127
    v_sub_f32 v128, v128, v12
    v_sub_f32 v129, v129, v12
    v_mul_f32 v128, v128, v13
    v_mul_f32 v129, v129, v13
    v_cvt_pk_bf16_f32 v32, v128, v129
    v_sub_f32 v130, v130, v12
    v_sub_f32 v131, v131, v12
    v_mul_f32 v130, v130, v13
    v_mul_f32 v131, v131, v13
    v_cvt_pk_bf16_f32 v33, v130, v131
    v_sub_f32 v132, v132, v12
    v_sub_f32 v133, v133, v12
    v_mul_f32 v132, v132, v13
    v_mul_f32 v133, v133, v13
    v_cvt_pk_bf16_f32 v34, v132, v133
    v_sub_f32 v134, v134, v12
    v_sub_f32 v135, v135, v12
    v_mul_f32 v134, v134, v13
    v_mul_f32 v135, v135, v13
    v_cvt_pk_bf16_f32 v35, v134, v135
    v_sub_f32 v136, v136, v12
    v_sub_f32 v137, v137, v12
    v_mul_f32 v136, v136, v13
    v_mul_f32 v137, v137, v13
    v_cvt_pk_bf16_f32 v36, v136, v137
    v_sub_f32 v138, v138, v12
    v_sub_f32 v139, v139, v12
    v_mul_f32 v138, v138, v13
    v_mul_f32 v139, v139, v13
    v_cvt_pk_bf16_f32 v37, v138, v139
    v_sub_f32 v140, v140, v12
    v_sub_f32 v141, v141, v12
    v_mul_f32 v140, v140, v13
    v_mul_f32 v141, v141, v13
    v_cvt_pk_bf16_f32 v38, v140, v141
    v_sub_f32 v142, v142, v12
    v_sub_f32 v143, v143, v12
    v_mul_f32 v142, v142, v13
    v_mul_f32 v143, v143, v13
    v_cvt_pk_bf16_f32 v39, v142, v143
    v_sub_f32 v144, v144, v12
    v_sub_f32 v145, v145, v12
    v_mul_f32 v144, v144, v13
    v_mul_f32 v145, v145, v13
    v_cvt_pk_bf16_f32 v40, v144, v145
    v_sub_f32 v146, v146, v12
    v_sub_f32 v147, v147, v12
    v_mul_f32 v146, v146, v13
    v_mul_f32 v147, v147, v13
    v_cvt_pk_bf16_f32 v41, v146, v147
    v_sub_f32 v148, v148, v12
    v_sub_f32 v149, v149, v12
    v_mul_f32 v148, v148, v13
    v_mul_f32 v149, v149, v13
    v_cvt_pk_bf16_f32 v42, v148, v149
    v_sub_f32 v150, v150, v12
    v_sub_f32 v151, v151, v12
    v_mul_f32 v150, v150, v13
    v_mul_f32 v151, v151, v13
    v_cvt_pk_bf16_f32 v43, v150, v151
    buffer_store_dwordx4 v[16:19], v8, s[20:23], 0 offen offset:0
    buffer_store_dwordx4 v[20:23], v8, s[20:23], 0 offen offset:16
    buffer_store_dwordx4 v[24:27], v8, s[20:23], 0 offen offset:32
    buffer_store_dwordx4 v[28:31], v8, s[20:23], 0 offen offset:48
    buffer_store_dwordx4 v[32:35], v8, s[20:23], 0 offen offset:64
    buffer_store_dwordx4 v[36:39], v8, s[20:23], 0 offen offset:80
    buffer_store_dwordx4 v[40:43], v8, s[20:23], 0 offen offset:96
lnprep_done:
    s_endpgm
.globl gemm1_kernel
.p2align 8
.type gemm1_kernel,@function
gemm1_kernel:
    s_cmp_ge_u32 s2, 224
    s_cbranch_scc1 gemm1_done
    s_load_dwordx2 s[36:37], s[0:1], 104
    s_load_dwordx2 s[4:5], s[0:1], 64
    s_load_dwordx2 s[6:7], s[0:1], 72
    s_load_dwordx2 s[38:39], s[0:1], 88
    s_mul_hi_u32 s30, s2, 0x12492493
    s_mul_i32 s31, s30, 14
    s_sub_u32 s31, s2, s31
    s_and_b32 s46, s2, 7
    s_lshr_b32 s47, s2, 3
    s_lshr_b32 s31, s46, 2
    s_mul_i32 s31, s31, 7
    s_lshr_b32 s30, s47, 2
    s_add_u32 s31, s31, s30
    s_and_b32 s30, s46, 3
    s_lshl_b32 s30, s30, 2
    s_and_b32 s47, s47, 3
    s_add_u32 s30, s30, s47
    s_mov_b32 s40, 0x3d372713
    s_mov_b32 s41, 0xc0135761
    v_lshrrev_b32 v7, 6, v0
    s_nop 0
    v_readfirstlane_b32 s27, v7
    s_nop 3
    s_and_b32 s28, s27, 3
    s_waitcnt lgkmcnt(0)
    s_add_u32 s8, s36, 0x400000
    s_addc_u32 s9, s37, 0
    s_mov_b32 s10, 0x188000
    s_mov_b32 s11, 0x00020000
    s_add_u32 s12, s36, 0x1c00000
    s_addc_u32 s13, s37, 0
    s_mov_b32 s14, 0x1c0000
    s_mov_b32 s15, 0x00020000
    s_mul_i32 s32, s31, 128
    s_mul_i32 s33, s30, 128
    v_and_b32 v1, 63, v0
    v_lshrrev_b32 v2, 3, v1
    v_and_b32 v3, 7, v1
    v_xor_b32 v3, v3, v2
    s_lshl_b32 s34, s28, 3
    v_add_u32 v2, s34, v2
    v_add_u32 v16, s32, v2
    v_add_u32 v16, 0, v16
    s_mov_b32 s35, 896
    v_mul_lo_u32 v16, v16, s35
    v_lshl_add_u32 v16, v3, 4, v16
    v_add_u32 v17, s32, v2
    v_add_u32 v17, 32, v17
    s_mov_b32 s35, 896
    v_mul_lo_u32 v17, v17, s35
    v_lshl_add_u32 v17, v3, 4, v17
    v_add_u32 v18, s32, v2
    v_add_u32 v18, 64, v18
    s_mov_b32 s35, 896
    v_mul_lo_u32 v18, v18, s35
    v_lshl_add_u32 v18, v3, 4, v18
    v_add_u32 v19, s32, v2
    v_add_u32 v19, 96, v19
    s_mov_b32 s35, 896
    v_mul_lo_u32 v19, v19, s35
    v_lshl_add_u32 v19, v3, 4, v19
    v_add_u32 v20, s33, v2
    v_add_u32 v20, 0, v20
    s_mov_b32 s35, 896
    v_mul_lo_u32 v20, v20, s35
    v_lshl_add_u32 v20, v3, 4, v20
    v_add_u32 v21, s33, v2
    v_add_u32 v21, 32, v21
    s_mov_b32 s35, 896
    v_mul_lo_u32 v21, v21, s35
    v_lshl_add_u32 v21, v3, 4, v21
    v_add_u32 v22, s33, v2
    v_add_u32 v22, 64, v22
    s_mov_b32 s35, 896
    v_mul_lo_u32 v22, v22, s35
    v_lshl_add_u32 v22, v3, 4, v22
    v_add_u32 v23, s33, v2
    v_add_u32 v23, 96, v23
    s_mov_b32 s35, 896
    v_mul_lo_u32 v23, v23, s35
    v_lshl_add_u32 v23, v3, 4, v23
    s_lshl_b32 s43, s28, 10
    s_cmp_lt_u32 s27, 4
    s_cbranch_scc1 gemm1_comp
    s_mov_b32 s42, 0
    s_add_u32 m0, s43, 0
    s_nop 0
    buffer_load_dwordx4 v16, s[8:11], s42 offen lds
    s_add_u32 m0, s43, 4096
    s_nop 0
    buffer_load_dwordx4 v17, s[8:11], s42 offen lds
    s_add_u32 m0, s43, 8192
    s_nop 0
    buffer_load_dwordx4 v18, s[8:11], s42 offen lds
    s_add_u32 m0, s43, 12288
    s_nop 0
    buffer_load_dwordx4 v19, s[8:11], s42 offen lds
    s_add_u32 m0, s43, 16384
    s_nop 0
    buffer_load_dwordx4 v20, s[12:15], s42 offen lds
    s_add_u32 m0, s43, 20480
    s_nop 0
    buffer_load_dwordx4 v21, s[12:15], s42 offen lds
    s_add_u32 m0, s43, 24576
    s_nop 0
    buffer_load_dwordx4 v22, s[12:15], s42 offen lds
    s_add_u32 m0, s43, 28672
    s_nop 0
    buffer_load_dwordx4 v23, s[12:15], s42 offen lds
    s_mov_b32 s42, 128
    s_add_u32 m0, s43, 32768
    s_nop 0
    buffer_load_dwordx4 v16, s[8:11], s42 offen lds
    s_add_u32 m0, s43, 36864
    s_nop 0
    buffer_load_dwordx4 v17, s[8:11], s42 offen lds
    s_add_u32 m0, s43, 40960
    s_nop 0
    buffer_load_dwordx4 v18, s[8:11], s42 offen lds
    s_add_u32 m0, s43, 45056
    s_nop 0
    buffer_load_dwordx4 v19, s[8:11], s42 offen lds
    s_add_u32 m0, s43, 49152
    s_nop 0
    buffer_load_dwordx4 v20, s[12:15], s42 offen lds
    s_add_u32 m0, s43, 53248
    s_nop 0
    buffer_load_dwordx4 v21, s[12:15], s42 offen lds
    s_add_u32 m0, s43, 57344
    s_nop 0
    buffer_load_dwordx4 v22, s[12:15], s42 offen lds
    s_add_u32 m0, s43, 61440
    s_nop 0
    buffer_load_dwordx4 v23, s[12:15], s42 offen lds
    s_mov_b32 s42, 256
    s_add_u32 m0, s43, 65536
    s_nop 0
    buffer_load_dwordx4 v16, s[8:11], s42 offen lds
    s_add_u32 m0, s43, 69632
    s_nop 0
    buffer_load_dwordx4 v17, s[8:11], s42 offen lds
    s_add_u32 m0, s43, 73728
    s_nop 0
    buffer_load_dwordx4 v18, s[8:11], s42 offen lds
    s_add_u32 m0, s43, 77824
    s_nop 0
    buffer_load_dwordx4 v19, s[8:11], s42 offen lds
    s_add_u32 m0, s43, 81920
    s_nop 0
    buffer_load_dwordx4 v20, s[12:15], s42 offen lds
    s_add_u32 m0, s43, 86016
    s_nop 0
    buffer_load_dwordx4 v21, s[12:15], s42 offen lds
    s_add_u32 m0, s43, 90112
    s_nop 0
    buffer_load_dwordx4 v22, s[12:15], s42 offen lds
    s_add_u32 m0, s43, 94208
    s_nop 0
    buffer_load_dwordx4 v23, s[12:15], s42 offen lds
    s_waitcnt vmcnt(16)
    s_barrier
    s_mov_b32 s42, 384
    s_add_u32 m0, s43, 98304
    s_nop 0
    buffer_load_dwordx4 v16, s[8:11], s42 offen lds
    s_add_u32 m0, s43, 102400
    s_nop 0
    buffer_load_dwordx4 v17, s[8:11], s42 offen lds
    s_add_u32 m0, s43, 106496
    s_nop 0
    buffer_load_dwordx4 v18, s[8:11], s42 offen lds
    s_add_u32 m0, s43, 110592
    s_nop 0
    buffer_load_dwordx4 v19, s[8:11], s42 offen lds
    s_add_u32 m0, s43, 114688
    s_nop 0
    buffer_load_dwordx4 v20, s[12:15], s42 offen lds
    s_add_u32 m0, s43, 118784
    s_nop 0
    buffer_load_dwordx4 v21, s[12:15], s42 offen lds
    s_add_u32 m0, s43, 122880
    s_nop 0
    buffer_load_dwordx4 v22, s[12:15], s42 offen lds
    s_add_u32 m0, s43, 126976
    s_nop 0
    buffer_load_dwordx4 v23, s[12:15], s42 offen lds
    s_waitcnt vmcnt(16)
    s_barrier
    s_mov_b32 s42, 512
    s_add_u32 m0, s43, 0
    s_nop 0
    buffer_load_dwordx4 v16, s[8:11], s42 offen lds
    s_add_u32 m0, s43, 4096
    s_nop 0
    buffer_load_dwordx4 v17, s[8:11], s42 offen lds
    s_add_u32 m0, s43, 8192
    s_nop 0
    buffer_load_dwordx4 v18, s[8:11], s42 offen lds
    s_add_u32 m0, s43, 12288
    s_nop 0
    buffer_load_dwordx4 v19, s[8:11], s42 offen lds
    s_add_u32 m0, s43, 16384
    s_nop 0
    buffer_load_dwordx4 v20, s[12:15], s42 offen lds
    s_add_u32 m0, s43, 20480
    s_nop 0
    buffer_load_dwordx4 v21, s[12:15], s42 offen lds
    s_add_u32 m0, s43, 24576
    s_nop 0
    buffer_load_dwordx4 v22, s[12:15], s42 offen lds
    s_add_u32 m0, s43, 28672
    s_nop 0
    buffer_load_dwordx4 v23, s[12:15], s42 offen lds
    s_waitcnt vmcnt(16)
    s_barrier
    s_mov_b32 s42, 640
    s_add_u32 m0, s43, 32768
    s_nop 0
    buffer_load_dwordx4 v16, s[8:11], s42 offen lds
    s_add_u32 m0, s43, 36864
    s_nop 0
    buffer_load_dwordx4 v17, s[8:11], s42 offen lds
    s_add_u32 m0, s43, 40960
    s_nop 0
    buffer_load_dwordx4 v18, s[8:11], s42 offen lds
    s_add_u32 m0, s43, 45056
    s_nop 0
    buffer_load_dwordx4 v19, s[8:11], s42 offen lds
    s_add_u32 m0, s43, 49152
    s_nop 0
    buffer_load_dwordx4 v20, s[12:15], s42 offen lds
    s_add_u32 m0, s43, 53248
    s_nop 0
    buffer_load_dwordx4 v21, s[12:15], s42 offen lds
    s_add_u32 m0, s43, 57344
    s_nop 0
    buffer_load_dwordx4 v22, s[12:15], s42 offen lds
    s_add_u32 m0, s43, 61440
    s_nop 0
    buffer_load_dwordx4 v23, s[12:15], s42 offen lds
    s_waitcnt vmcnt(16)
    s_barrier
    s_mov_b32 s42, 768
    s_add_u32 m0, s43, 65536
    s_nop 0
    buffer_load_dwordx4 v16, s[8:11], s42 offen lds
    s_add_u32 m0, s43, 69632
    s_nop 0
    buffer_load_dwordx4 v17, s[8:11], s42 offen lds
    s_add_u32 m0, s43, 73728
    s_nop 0
    buffer_load_dwordx4 v18, s[8:11], s42 offen lds
    s_add_u32 m0, s43, 77824
    s_nop 0
    buffer_load_dwordx4 v19, s[8:11], s42 offen lds
    s_add_u32 m0, s43, 81920
    s_nop 0
    buffer_load_dwordx4 v20, s[12:15], s42 offen lds
    s_add_u32 m0, s43, 86016
    s_nop 0
    buffer_load_dwordx4 v21, s[12:15], s42 offen lds
    s_add_u32 m0, s43, 90112
    s_nop 0
    buffer_load_dwordx4 v22, s[12:15], s42 offen lds
    s_add_u32 m0, s43, 94208
    s_nop 0
    buffer_load_dwordx4 v23, s[12:15], s42 offen lds
    s_waitcnt vmcnt(16)
    s_barrier
    s_waitcnt vmcnt(8)
    s_barrier
    s_waitcnt vmcnt(0)
    s_barrier
    s_endpgm
gemm1_comp:
    v_and_b32 v8, 31, v0
    v_bfe_u32 v9, v0, 5, 1
    s_lshr_b32 s29, s28, 1
    s_and_b32 s35, s28, 1
    v_and_b32 v10, 7, v0
    v_lshlrev_b32 v11, 7, v8
    s_mul_i32 s44, s29, 8192
    s_mul_i32 s45, s35, 8192
    s_add_u32 s45, s45, 16384
    v_lshl_add_u32 v12, v9, 2, 0
    v_xor_b32 v12, v12, v10
    v_lshl_add_u32 v12, v12, 4, v11
    v_add_u32 v32, s44, v12
    v_add_u32 v36, s45, v12
    v_add_u32 v40, 65536, v32
    v_add_u32 v44, 65536, v36
    v_lshl_add_u32 v12, v9, 2, 1
    v_xor_b32 v12, v12, v10
    v_lshl_add_u32 v12, v12, 4, v11
    v_add_u32 v33, s44, v12
    v_add_u32 v37, s45, v12
    v_add_u32 v41, 65536, v33
    v_add_u32 v45, 65536, v37
    v_lshl_add_u32 v12, v9, 2, 2
    v_xor_b32 v12, v12, v10
    v_lshl_add_u32 v12, v12, 4, v11
    v_add_u32 v34, s44, v12
    v_add_u32 v38, s45, v12
    v_add_u32 v42, 65536, v34
    v_add_u32 v46, 65536, v38
    v_lshl_add_u32 v12, v9, 2, 3
    v_xor_b32 v12, v12, v10
    v_lshl_add_u32 v12, v12, 4, v11
    v_add_u32 v35, s44, v12
    v_add_u32 v39, s45, v12
    v_add_u32 v43, 65536, v35
    v_add_u32 v47, 65536, v39
    v_mov_b32 v64, 0
    v_mov_b32 v65, 0
    v_mov_b32 v66, 0
    v_mov_b32 v67, 0
    v_mov_b32 v68, 0
    v_mov_b32 v69, 0
    v_mov_b32 v70, 0
    v_mov_b32 v71, 0
    v_mov_b32 v72, 0
    v_mov_b32 v73, 0
    v_mov_b32 v74, 0
    v_mov_b32 v75, 0
    v_mov_b32 v76, 0
    v_mov_b32 v77, 0
    v_mov_b32 v78, 0
    v_mov_b32 v79, 0
    v_mov_b32 v80, 0
    v_mov_b32 v81, 0
    v_mov_b32 v82, 0
    v_mov_b32 v83, 0
    v_mov_b32 v84, 0
    v_mov_b32 v85, 0
    v_mov_b32 v86, 0
    v_mov_b32 v87, 0
    v_mov_b32 v88, 0
    v_mov_b32 v89, 0
    v_mov_b32 v90, 0
    v_mov_b32 v91, 0
    v_mov_b32 v92, 0
    v_mov_b32 v93, 0
    v_mov_b32 v94, 0
    v_mov_b32 v95, 0
    v_mov_b32 v96, 0
    v_mov_b32 v97, 0
    v_mov_b32 v98, 0
    v_mov_b32 v99, 0
    v_mov_b32 v100, 0
    v_mov_b32 v101, 0
    v_mov_b32 v102, 0
    v_mov_b32 v103, 0
    v_mov_b32 v104, 0
    v_mov_b32 v105, 0
    v_mov_b32 v106, 0
    v_mov_b32 v107, 0
    v_mov_b32 v108, 0
    v_mov_b32 v109, 0
    v_mov_b32 v110, 0
    v_mov_b32 v111, 0
    v_mov_b32 v112, 0
    v_mov_b32 v113, 0
    v_mov_b32 v114, 0
    v_mov_b32 v115, 0
    v_mov_b32 v116, 0
    v_mov_b32 v117, 0
    v_mov_b32 v118, 0
    v_mov_b32 v119, 0
    v_mov_b32 v120, 0
    v_mov_b32 v121, 0
    v_mov_b32 v122, 0
    v_mov_b32 v123, 0
    v_mov_b32 v124, 0
    v_mov_b32 v125, 0
    v_mov_b32 v126, 0
    v_mov_b32 v127, 0
    s_cmp_ge_u32 s31, 7
    s_cbranch_scc1 gemm1_sw
    s_barrier
    ds_read_b128 v[128:131], v32 offset:0
    ds_read_b128 v[132:135], v32 offset:4096
    ds_read_b128 v[160:163], v36 offset:0
    ds_read_b128 v[164:167], v36 offset:4096
    ds_read_b128 v[136:139], v33 offset:0
    ds_read_b128 v[140:143], v33 offset:4096
    ds_read_b128 v[168:171], v37 offset:0
    ds_read_b128 v[172:175], v37 offset:4096
    ds_read_b128 v[144:147], v34 offset:0
    ds_read_b128 v[148:151], v34 offset:4096
    ds_read_b128 v[176:179], v38 offset:0
    ds_read_b128 v[180:183], v38 offset:4096
    ds_read_b128 v[152:155], v35 offset:0
    ds_read_b128 v[156:159], v35 offset:4096
    ds_read_b128 v[184:187], v39 offset:0
    ds_read_b128 v[188:191], v39 offset:4096
    s_waitcnt lgkmcnt(12)
    v_mfma_f32_32x32x16_bf16 v[64:79], v[128:131], v[160:163], v[64:79]
    v_mfma_f32_32x32x16_bf16 v[80:95], v[128:131], v[164:167], v[80:95]
    v_mfma_f32_32x32x16_bf16 v[96:111], v[132:135], v[160:163], v[96:111]
    v_mfma_f32_32x32x16_bf16 v[112:127], v[132:135], v[164:167], v[112:127]
    s_waitcnt lgkmcnt(8)
    v_mfma_f32_32x32x16_bf16 v[64:79], v[136:139], v[168:171], v[64:79]
    v_mfma_f32_32x32x16_bf16 v[80:95], v[136:139], v[172:175], v[80:95]
    v_mfma_f32_32x32x16_bf16 v[96:111], v[140:143], v[168:171], v[96:111]
    v_mfma_f32_32x32x16_bf16 v[112:127], v[140:143], v[172:175], v[112:127]
    s_waitcnt lgkmcnt(4)
    v_mfma_f32_32x32x16_bf16 v[64:79], v[144:147], v[176:179], v[64:79]
    v_mfma_f32_32x32x16_bf16 v[80:95], v[144:147], v[180:183], v[80:95]
    v_mfma_f32_32x32x16_bf16 v[96:111], v[148:151], v[176:179], v[96:111]
    v_mfma_f32_32x32x16_bf16 v[112:127], v[148:151], v[180:183], v[112:127]
    s_waitcnt lgkmcnt(0)
    v_mfma_f32_32x32x16_bf16 v[64:79], v[152:155], v[184:187], v[64:79]
    v_mfma_f32_32x32x16_bf16 v[80:95], v[152:155], v[188:191], v[80:95]
    v_mfma_f32_32x32x16_bf16 v[96:111], v[156:159], v[184:187], v[96:111]
    v_mfma_f32_32x32x16_bf16 v[112:127], v[156:159], v[188:191], v[112:127]
    s_barrier
    ds_read_b128 v[128:131], v32 offset:32768
    ds_read_b128 v[132:135], v32 offset:36864
    ds_read_b128 v[160:163], v36 offset:32768
    ds_read_b128 v[164:167], v36 offset:36864
    ds_read_b128 v[136:139], v33 offset:32768
    ds_read_b128 v[140:143], v33 offset:36864
    ds_read_b128 v[168:171], v37 offset:32768
    ds_read_b128 v[172:175], v37 offset:36864
    ds_read_b128 v[144:147], v34 offset:32768
    ds_read_b128 v[148:151], v34 offset:36864
    ds_read_b128 v[176:179], v38 offset:32768
    ds_read_b128 v[180:183], v38 offset:36864
    ds_read_b128 v[152:155], v35 offset:32768
    ds_read_b128 v[156:159], v35 offset:36864
    ds_read_b128 v[184:187], v39 offset:32768
    ds_read_b128 v[188:191], v39 offset:36864
    s_waitcnt lgkmcnt(12)
    v_mfma_f32_32x32x16_bf16 v[64:79], v[128:131], v[160:163], v[64:79]
    v_mfma_f32_32x32x16_bf16 v[80:95], v[128:131], v[164:167], v[80:95]
    v_mfma_f32_32x32x16_bf16 v[96:111], v[132:135], v[160:163], v[96:111]
    v_mfma_f32_32x32x16_bf16 v[112:127], v[132:135], v[164:167], v[112:127]
    s_waitcnt lgkmcnt(8)
    v_mfma_f32_32x32x16_bf16 v[64:79], v[136:139], v[168:171], v[64:79]
    v_mfma_f32_32x32x16_bf16 v[80:95], v[136:139], v[172:175], v[80:95]
    v_mfma_f32_32x32x16_bf16 v[96:111], v[140:143], v[168:171], v[96:111]
    v_mfma_f32_32x32x16_bf16 v[112:127], v[140:143], v[172:175], v[112:127]
    s_waitcnt lgkmcnt(4)
    v_mfma_f32_32x32x16_bf16 v[64:79], v[144:147], v[176:179], v[64:79]
    v_mfma_f32_32x32x16_bf16 v[80:95], v[144:147], v[180:183], v[80:95]
    v_mfma_f32_32x32x16_bf16 v[96:111], v[148:151], v[176:179], v[96:111]
    v_mfma_f32_32x32x16_bf16 v[112:127], v[148:151], v[180:183], v[112:127]
    s_waitcnt lgkmcnt(0)
    v_mfma_f32_32x32x16_bf16 v[64:79], v[152:155], v[184:187], v[64:79]
    v_mfma_f32_32x32x16_bf16 v[80:95], v[152:155], v[188:191], v[80:95]
    v_mfma_f32_32x32x16_bf16 v[96:111], v[156:159], v[184:187], v[96:111]
    v_mfma_f32_32x32x16_bf16 v[112:127], v[156:159], v[188:191], v[112:127]
    s_barrier
    ds_read_b128 v[128:131], v40 offset:0
    ds_read_b128 v[132:135], v40 offset:4096
    ds_read_b128 v[160:163], v44 offset:0
    ds_read_b128 v[164:167], v44 offset:4096
    ds_read_b128 v[136:139], v41 offset:0
    ds_read_b128 v[140:143], v41 offset:4096
    ds_read_b128 v[168:171], v45 offset:0
    ds_read_b128 v[172:175], v45 offset:4096
    ds_read_b128 v[144:147], v42 offset:0
    ds_read_b128 v[148:151], v42 offset:4096
    ds_read_b128 v[176:179], v46 offset:0
    ds_read_b128 v[180:183], v46 offset:4096
    ds_read_b128 v[152:155], v43 offset:0
    ds_read_b128 v[156:159], v43 offset:4096
    ds_read_b128 v[184:187], v47 offset:0
    ds_read_b128 v[188:191], v47 offset:4096
    s_waitcnt lgkmcnt(12)
    v_mfma_f32_32x32x16_bf16 v[64:79], v[128:131], v[160:163], v[64:79]
    v_mfma_f32_32x32x16_bf16 v[80:95], v[128:131], v[164:167], v[80:95]
    v_mfma_f32_32x32x16_bf16 v[96:111], v[132:135], v[160:163], v[96:111]
    v_mfma_f32_32x32x16_bf16 v[112:127], v[132:135], v[164:167], v[112:127]
    s_waitcnt lgkmcnt(8)
    v_mfma_f32_32x32x16_bf16 v[64:79], v[136:139], v[168:171], v[64:79]
    v_mfma_f32_32x32x16_bf16 v[80:95], v[136:139], v[172:175], v[80:95]
    v_mfma_f32_32x32x16_bf16 v[96:111], v[140:143], v[168:171], v[96:111]
    v_mfma_f32_32x32x16_bf16 v[112:127], v[140:143], v[172:175], v[112:127]
    s_waitcnt lgkmcnt(4)
    v_mfma_f32_32x32x16_bf16 v[64:79], v[144:147], v[176:179], v[64:79]
    v_mfma_f32_32x32x16_bf16 v[80:95], v[144:147], v[180:183], v[80:95]
    v_mfma_f32_32x32x16_bf16 v[96:111], v[148:151], v[176:179], v[96:111]
    v_mfma_f32_32x32x16_bf16 v[112:127], v[148:151], v[180:183], v[112:127]
    s_waitcnt lgkmcnt(0)
    v_mfma_f32_32x32x16_bf16 v[64:79], v[152:155], v[184:187], v[64:79]
    v_mfma_f32_32x32x16_bf16 v[80:95], v[152:155], v[188:191], v[80:95]
    v_mfma_f32_32x32x16_bf16 v[96:111], v[156:159], v[184:187], v[96:111]
    v_mfma_f32_32x32x16_bf16 v[112:127], v[156:159], v[188:191], v[112:127]
    s_barrier
    ds_read_b128 v[128:131], v40 offset:32768
    ds_read_b128 v[132:135], v40 offset:36864
    ds_read_b128 v[160:163], v44 offset:32768
    ds_read_b128 v[164:167], v44 offset:36864
    ds_read_b128 v[136:139], v41 offset:32768
    ds_read_b128 v[140:143], v41 offset:36864
    ds_read_b128 v[168:171], v45 offset:32768
    ds_read_b128 v[172:175], v45 offset:36864
    ds_read_b128 v[144:147], v42 offset:32768
    ds_read_b128 v[148:151], v42 offset:36864
    ds_read_b128 v[176:179], v46 offset:32768
    ds_read_b128 v[180:183], v46 offset:36864
    ds_read_b128 v[152:155], v43 offset:32768
    ds_read_b128 v[156:159], v43 offset:36864
    ds_read_b128 v[184:187], v47 offset:32768
    ds_read_b128 v[188:191], v47 offset:36864
    s_waitcnt lgkmcnt(12)
    v_mfma_f32_32x32x16_bf16 v[64:79], v[128:131], v[160:163], v[64:79]
    v_mfma_f32_32x32x16_bf16 v[80:95], v[128:131], v[164:167], v[80:95]
    v_mfma_f32_32x32x16_bf16 v[96:111], v[132:135], v[160:163], v[96:111]
    v_mfma_f32_32x32x16_bf16 v[112:127], v[132:135], v[164:167], v[112:127]
    s_waitcnt lgkmcnt(8)
    v_mfma_f32_32x32x16_bf16 v[64:79], v[136:139], v[168:171], v[64:79]
    v_mfma_f32_32x32x16_bf16 v[80:95], v[136:139], v[172:175], v[80:95]
    v_mfma_f32_32x32x16_bf16 v[96:111], v[140:143], v[168:171], v[96:111]
    v_mfma_f32_32x32x16_bf16 v[112:127], v[140:143], v[172:175], v[112:127]
    s_waitcnt lgkmcnt(4)
    v_mfma_f32_32x32x16_bf16 v[64:79], v[144:147], v[176:179], v[64:79]
    v_mfma_f32_32x32x16_bf16 v[80:95], v[144:147], v[180:183], v[80:95]
    v_mfma_f32_32x32x16_bf16 v[96:111], v[148:151], v[176:179], v[96:111]
    v_mfma_f32_32x32x16_bf16 v[112:127], v[148:151], v[180:183], v[112:127]
    s_waitcnt lgkmcnt(0)
    v_mfma_f32_32x32x16_bf16 v[64:79], v[152:155], v[184:187], v[64:79]
    v_mfma_f32_32x32x16_bf16 v[80:95], v[152:155], v[188:191], v[80:95]
    v_mfma_f32_32x32x16_bf16 v[96:111], v[156:159], v[184:187], v[96:111]
    v_mfma_f32_32x32x16_bf16 v[112:127], v[156:159], v[188:191], v[112:127]
    s_barrier
    ds_read_b128 v[128:131], v32 offset:0
    ds_read_b128 v[132:135], v32 offset:4096
    ds_read_b128 v[160:163], v36 offset:0
    ds_read_b128 v[164:167], v36 offset:4096
    ds_read_b128 v[136:139], v33 offset:0
    ds_read_b128 v[140:143], v33 offset:4096
    ds_read_b128 v[168:171], v37 offset:0
    ds_read_b128 v[172:175], v37 offset:4096
    ds_read_b128 v[144:147], v34 offset:0
    ds_read_b128 v[148:151], v34 offset:4096
    ds_read_b128 v[176:179], v38 offset:0
    ds_read_b128 v[180:183], v38 offset:4096
    ds_read_b128 v[152:155], v35 offset:0
    ds_read_b128 v[156:159], v35 offset:4096
    ds_read_b128 v[184:187], v39 offset:0
    ds_read_b128 v[188:191], v39 offset:4096
    s_waitcnt lgkmcnt(12)
    v_mfma_f32_32x32x16_bf16 v[64:79], v[128:131], v[160:163], v[64:79]
    v_mfma_f32_32x32x16_bf16 v[80:95], v[128:131], v[164:167], v[80:95]
    v_mfma_f32_32x32x16_bf16 v[96:111], v[132:135], v[160:163], v[96:111]
    v_mfma_f32_32x32x16_bf16 v[112:127], v[132:135], v[164:167], v[112:127]
    s_waitcnt lgkmcnt(8)
    v_mfma_f32_32x32x16_bf16 v[64:79], v[136:139], v[168:171], v[64:79]
    v_mfma_f32_32x32x16_bf16 v[80:95], v[136:139], v[172:175], v[80:95]
    v_mfma_f32_32x32x16_bf16 v[96:111], v[140:143], v[168:171], v[96:111]
    v_mfma_f32_32x32x16_bf16 v[112:127], v[140:143], v[172:175], v[112:127]
    s_waitcnt lgkmcnt(4)
    v_mfma_f32_32x32x16_bf16 v[64:79], v[144:147], v[176:179], v[64:79]
    v_mfma_f32_32x32x16_bf16 v[80:95], v[144:147], v[180:183], v[80:95]
    v_mfma_f32_32x32x16_bf16 v[96:111], v[148:151], v[176:179], v[96:111]
    v_mfma_f32_32x32x16_bf16 v[112:127], v[148:151], v[180:183], v[112:127]
    s_waitcnt lgkmcnt(0)
    v_mfma_f32_32x32x16_bf16 v[64:79], v[152:155], v[184:187], v[64:79]
    v_mfma_f32_32x32x16_bf16 v[80:95], v[152:155], v[188:191], v[80:95]
    v_mfma_f32_32x32x16_bf16 v[96:111], v[156:159], v[184:187], v[96:111]
    v_mfma_f32_32x32x16_bf16 v[112:127], v[156:159], v[188:191], v[112:127]
    s_barrier
    ds_read_b128 v[128:131], v32 offset:32768
    ds_read_b128 v[132:135], v32 offset:36864
    ds_read_b128 v[160:163], v36 offset:32768
    ds_read_b128 v[164:167], v36 offset:36864
    ds_read_b128 v[136:139], v33 offset:32768
    ds_read_b128 v[140:143], v33 offset:36864
    ds_read_b128 v[168:171], v37 offset:32768
    ds_read_b128 v[172:175], v37 offset:36864
    ds_read_b128 v[144:147], v34 offset:32768
    ds_read_b128 v[148:151], v34 offset:36864
    ds_read_b128 v[176:179], v38 offset:32768
    ds_read_b128 v[180:183], v38 offset:36864
    ds_read_b128 v[152:155], v35 offset:32768
    ds_read_b128 v[156:159], v35 offset:36864
    ds_read_b128 v[184:187], v39 offset:32768
    ds_read_b128 v[188:191], v39 offset:36864
    s_waitcnt lgkmcnt(12)
    v_mfma_f32_32x32x16_bf16 v[64:79], v[128:131], v[160:163], v[64:79]
    v_mfma_f32_32x32x16_bf16 v[80:95], v[128:131], v[164:167], v[80:95]
    v_mfma_f32_32x32x16_bf16 v[96:111], v[132:135], v[160:163], v[96:111]
    v_mfma_f32_32x32x16_bf16 v[112:127], v[132:135], v[164:167], v[112:127]
    s_waitcnt lgkmcnt(8)
    v_mfma_f32_32x32x16_bf16 v[64:79], v[136:139], v[168:171], v[64:79]
    v_mfma_f32_32x32x16_bf16 v[80:95], v[136:139], v[172:175], v[80:95]
    v_mfma_f32_32x32x16_bf16 v[96:111], v[140:143], v[168:171], v[96:111]
    v_mfma_f32_32x32x16_bf16 v[112:127], v[140:143], v[172:175], v[112:127]
    s_waitcnt lgkmcnt(4)
    v_mfma_f32_32x32x16_bf16 v[64:79], v[144:147], v[176:179], v[64:79]
    v_mfma_f32_32x32x16_bf16 v[80:95], v[144:147], v[180:183], v[80:95]
    v_mfma_f32_32x32x16_bf16 v[96:111], v[148:151], v[176:179], v[96:111]
    v_mfma_f32_32x32x16_bf16 v[112:127], v[148:151], v[180:183], v[112:127]
    s_waitcnt lgkmcnt(0)
    v_mfma_f32_32x32x16_bf16 v[64:79], v[152:155], v[184:187], v[64:79]
    v_mfma_f32_32x32x16_bf16 v[80:95], v[152:155], v[188:191], v[80:95]
    v_mfma_f32_32x32x16_bf16 v[96:111], v[156:159], v[184:187], v[96:111]
    v_mfma_f32_32x32x16_bf16 v[112:127], v[156:159], v[188:191], v[112:127]
    s_barrier
    ds_read_b128 v[128:131], v40 offset:0
    ds_read_b128 v[132:135], v40 offset:4096
    ds_read_b128 v[160:163], v44 offset:0
    ds_read_b128 v[164:167], v44 offset:4096
    ds_read_b128 v[136:139], v41 offset:0
    ds_read_b128 v[140:143], v41 offset:4096
    ds_read_b128 v[168:171], v45 offset:0
    ds_read_b128 v[172:175], v45 offset:4096
    ds_read_b128 v[144:147], v42 offset:0
    ds_read_b128 v[148:151], v42 offset:4096
    ds_read_b128 v[176:179], v46 offset:0
    ds_read_b128 v[180:183], v46 offset:4096
    ds_read_b128 v[152:155], v43 offset:0
    ds_read_b128 v[156:159], v43 offset:4096
    ds_read_b128 v[184:187], v47 offset:0
    ds_read_b128 v[188:191], v47 offset:4096
    s_waitcnt lgkmcnt(12)
    v_mfma_f32_32x32x16_bf16 v[64:79], v[128:131], v[160:163], v[64:79]
    v_mfma_f32_32x32x16_bf16 v[80:95], v[128:131], v[164:167], v[80:95]
    v_mfma_f32_32x32x16_bf16 v[96:111], v[132:135], v[160:163], v[96:111]
    v_mfma_f32_32x32x16_bf16 v[112:127], v[132:135], v[164:167], v[112:127]
    s_waitcnt lgkmcnt(8)
    v_mfma_f32_32x32x16_bf16 v[64:79], v[136:139], v[168:171], v[64:79]
    v_mfma_f32_32x32x16_bf16 v[80:95], v[136:139], v[172:175], v[80:95]
    v_mfma_f32_32x32x16_bf16 v[96:111], v[140:143], v[168:171], v[96:111]
    v_mfma_f32_32x32x16_bf16 v[112:127], v[140:143], v[172:175], v[112:127]
    s_waitcnt lgkmcnt(4)
    v_mfma_f32_32x32x16_bf16 v[64:79], v[144:147], v[176:179], v[64:79]
    v_mfma_f32_32x32x16_bf16 v[80:95], v[144:147], v[180:183], v[80:95]
    v_mfma_f32_32x32x16_bf16 v[96:111], v[148:151], v[176:179], v[96:111]
    v_mfma_f32_32x32x16_bf16 v[112:127], v[148:151], v[180:183], v[112:127]
    s_waitcnt lgkmcnt(0)
    v_mfma_f32_32x32x16_bf16 v[64:79], v[152:155], v[184:187], v[64:79]
    v_mfma_f32_32x32x16_bf16 v[80:95], v[152:155], v[188:191], v[80:95]
    v_mfma_f32_32x32x16_bf16 v[96:111], v[156:159], v[184:187], v[96:111]
    v_mfma_f32_32x32x16_bf16 v[112:127], v[156:159], v[188:191], v[112:127]
    s_nop 15
    s_nop 7
    v_mul_f32 v6, v64, v64
    v_fma_f32 v6, v6, s40, 1.0
    v_mul_f32 v6, v6, v64
    v_mul_f32 v6, s41, v6
    v_exp_f32 v6, v6
    s_nop 0
    v_add_f32 v6, 1.0, v6
    v_rcp_f32 v6, v6
    s_nop 0
    v_mul_f32 v64, v64, v6
    v_mul_f32 v6, v65, v65
    v_fma_f32 v6, v6, s40, 1.0
    v_mul_f32 v6, v6, v65
    v_mul_f32 v6, s41, v6
    v_exp_f32 v6, v6
    s_nop 0
    v_add_f32 v6, 1.0, v6
    v_rcp_f32 v6, v6
    s_nop 0
    v_mul_f32 v65, v65, v6
    v_mul_f32 v6, v66, v66
    v_fma_f32 v6, v6, s40, 1.0
    v_mul_f32 v6, v6, v66
    v_mul_f32 v6, s41, v6
    v_exp_f32 v6, v6
    s_nop 0
    v_add_f32 v6, 1.0, v6
    v_rcp_f32 v6, v6
    s_nop 0
    v_mul_f32 v66, v66, v6
    v_mul_f32 v6, v67, v67
    v_fma_f32 v6, v6, s40, 1.0
    v_mul_f32 v6, v6, v67
    v_mul_f32 v6, s41, v6
    v_exp_f32 v6, v6
    s_nop 0
    v_add_f32 v6, 1.0, v6
    v_rcp_f32 v6, v6
    s_nop 0
    v_mul_f32 v67, v67, v6
    v_mul_f32 v6, v68, v68
    v_fma_f32 v6, v6, s40, 1.0
    v_mul_f32 v6, v6, v68
    v_mul_f32 v6, s41, v6
    v_exp_f32 v6, v6
    s_nop 0
    v_add_f32 v6, 1.0, v6
    v_rcp_f32 v6, v6
    s_nop 0
    v_mul_f32 v68, v68, v6
    v_mul_f32 v6, v69, v69
    v_fma_f32 v6, v6, s40, 1.0
    v_mul_f32 v6, v6, v69
    v_mul_f32 v6, s41, v6
    v_exp_f32 v6, v6
    s_nop 0
    v_add_f32 v6, 1.0, v6
    v_rcp_f32 v6, v6
    s_nop 0
    v_mul_f32 v69, v69, v6
    v_mul_f32 v6, v70, v70
    v_fma_f32 v6, v6, s40, 1.0
    v_mul_f32 v6, v6, v70
    v_mul_f32 v6, s41, v6
    v_exp_f32 v6, v6
    s_nop 0
    v_add_f32 v6, 1.0, v6
    v_rcp_f32 v6, v6
    s_nop 0
    v_mul_f32 v70, v70, v6
    v_mul_f32 v6, v71, v71
    v_fma_f32 v6, v6, s40, 1.0
    v_mul_f32 v6, v6, v71
    v_mul_f32 v6, s41, v6
    v_exp_f32 v6, v6
    s_nop 0
    v_add_f32 v6, 1.0, v6
    v_rcp_f32 v6, v6
    s_nop 0
    v_mul_f32 v71, v71, v6
    v_mul_f32 v6, v72, v72
    v_fma_f32 v6, v6, s40, 1.0
    v_mul_f32 v6, v6, v72
    v_mul_f32 v6, s41, v6
    v_exp_f32 v6, v6
    s_nop 0
    v_add_f32 v6, 1.0, v6
    v_rcp_f32 v6, v6
    s_nop 0
    v_mul_f32 v72, v72, v6
    v_mul_f32 v6, v73, v73
    v_fma_f32 v6, v6, s40, 1.0
    v_mul_f32 v6, v6, v73
    v_mul_f32 v6, s41, v6
    v_exp_f32 v6, v6
    s_nop 0
    v_add_f32 v6, 1.0, v6
    v_rcp_f32 v6, v6
    s_nop 0
    v_mul_f32 v73, v73, v6
    v_mul_f32 v6, v74, v74
    v_fma_f32 v6, v6, s40, 1.0
    v_mul_f32 v6, v6, v74
    v_mul_f32 v6, s41, v6
    v_exp_f32 v6, v6
    s_nop 0
    v_add_f32 v6, 1.0, v6
    v_rcp_f32 v6, v6
    s_nop 0
    v_mul_f32 v74, v74, v6
    v_mul_f32 v6, v75, v75
    v_fma_f32 v6, v6, s40, 1.0
    v_mul_f32 v6, v6, v75
    v_mul_f32 v6, s41, v6
    v_exp_f32 v6, v6
    s_nop 0
    v_add_f32 v6, 1.0, v6
    v_rcp_f32 v6, v6
    s_nop 0
    v_mul_f32 v75, v75, v6
    v_mul_f32 v6, v76, v76
    v_fma_f32 v6, v6, s40, 1.0
    v_mul_f32 v6, v6, v76
    v_mul_f32 v6, s41, v6
    v_exp_f32 v6, v6
    s_nop 0
    v_add_f32 v6, 1.0, v6
    v_rcp_f32 v6, v6
    s_nop 0
    v_mul_f32 v76, v76, v6
    v_mul_f32 v6, v77, v77
    v_fma_f32 v6, v6, s40, 1.0
    v_mul_f32 v6, v6, v77
    v_mul_f32 v6, s41, v6
    v_exp_f32 v6, v6
    s_nop 0
    v_add_f32 v6, 1.0, v6
    v_rcp_f32 v6, v6
    s_nop 0
    v_mul_f32 v77, v77, v6
    v_mul_f32 v6, v78, v78
    v_fma_f32 v6, v6, s40, 1.0
    v_mul_f32 v6, v6, v78
    v_mul_f32 v6, s41, v6
    v_exp_f32 v6, v6
    s_nop 0
    v_add_f32 v6, 1.0, v6
    v_rcp_f32 v6, v6
    s_nop 0
    v_mul_f32 v78, v78, v6
    v_mul_f32 v6, v79, v79
    v_fma_f32 v6, v6, s40, 1.0
    v_mul_f32 v6, v6, v79
    v_mul_f32 v6, s41, v6
    v_exp_f32 v6, v6
    s_nop 0
    v_add_f32 v6, 1.0, v6
    v_rcp_f32 v6, v6
    s_nop 0
    v_mul_f32 v79, v79, v6
    v_mul_f32 v6, v80, v80
    v_fma_f32 v6, v6, s40, 1.0
    v_mul_f32 v6, v6, v80
    v_mul_f32 v6, s41, v6
    v_exp_f32 v6, v6
    s_nop 0
    v_add_f32 v6, 1.0, v6
    v_rcp_f32 v6, v6
    s_nop 0
    v_mul_f32 v80, v80, v6
    v_mul_f32 v6, v81, v81
    v_fma_f32 v6, v6, s40, 1.0
    v_mul_f32 v6, v6, v81
    v_mul_f32 v6, s41, v6
    v_exp_f32 v6, v6
    s_nop 0
    v_add_f32 v6, 1.0, v6
    v_rcp_f32 v6, v6
    s_nop 0
    v_mul_f32 v81, v81, v6
    v_mul_f32 v6, v82, v82
    v_fma_f32 v6, v6, s40, 1.0
    v_mul_f32 v6, v6, v82
    v_mul_f32 v6, s41, v6
    v_exp_f32 v6, v6
    s_nop 0
    v_add_f32 v6, 1.0, v6
    v_rcp_f32 v6, v6
    s_nop 0
    v_mul_f32 v82, v82, v6
    v_mul_f32 v6, v83, v83
    v_fma_f32 v6, v6, s40, 1.0
    v_mul_f32 v6, v6, v83
    v_mul_f32 v6, s41, v6
    v_exp_f32 v6, v6
    s_nop 0
    v_add_f32 v6, 1.0, v6
    v_rcp_f32 v6, v6
    s_nop 0
    v_mul_f32 v83, v83, v6
    v_mul_f32 v6, v84, v84
    v_fma_f32 v6, v6, s40, 1.0
    v_mul_f32 v6, v6, v84
    v_mul_f32 v6, s41, v6
    v_exp_f32 v6, v6
    s_nop 0
    v_add_f32 v6, 1.0, v6
    v_rcp_f32 v6, v6
    s_nop 0
    v_mul_f32 v84, v84, v6
    v_mul_f32 v6, v85, v85
    v_fma_f32 v6, v6, s40, 1.0
    v_mul_f32 v6, v6, v85
    v_mul_f32 v6, s41, v6
    v_exp_f32 v6, v6
    s_nop 0
    v_add_f32 v6, 1.0, v6
    v_rcp_f32 v6, v6
    s_nop 0
    v_mul_f32 v85, v85, v6
    v_mul_f32 v6, v86, v86
    v_fma_f32 v6, v6, s40, 1.0
    v_mul_f32 v6, v6, v86
    v_mul_f32 v6, s41, v6
    v_exp_f32 v6, v6
    s_nop 0
    v_add_f32 v6, 1.0, v6
    v_rcp_f32 v6, v6
    s_nop 0
    v_mul_f32 v86, v86, v6
    v_mul_f32 v6, v87, v87
    v_fma_f32 v6, v6, s40, 1.0
    v_mul_f32 v6, v6, v87
    v_mul_f32 v6, s41, v6
    v_exp_f32 v6, v6
    s_nop 0
    v_add_f32 v6, 1.0, v6
    v_rcp_f32 v6, v6
    s_nop 0
    v_mul_f32 v87, v87, v6
    v_mul_f32 v6, v88, v88
    v_fma_f32 v6, v6, s40, 1.0
    v_mul_f32 v6, v6, v88
    v_mul_f32 v6, s41, v6
    v_exp_f32 v6, v6
    s_nop 0
    v_add_f32 v6, 1.0, v6
    v_rcp_f32 v6, v6
    s_nop 0
    v_mul_f32 v88, v88, v6
    v_mul_f32 v6, v89, v89
    v_fma_f32 v6, v6, s40, 1.0
    v_mul_f32 v6, v6, v89
    v_mul_f32 v6, s41, v6
    v_exp_f32 v6, v6
    s_nop 0
    v_add_f32 v6, 1.0, v6
    v_rcp_f32 v6, v6
    s_nop 0
    v_mul_f32 v89, v89, v6
    v_mul_f32 v6, v90, v90
    v_fma_f32 v6, v6, s40, 1.0
    v_mul_f32 v6, v6, v90
    v_mul_f32 v6, s41, v6
    v_exp_f32 v6, v6
    s_nop 0
    v_add_f32 v6, 1.0, v6
    v_rcp_f32 v6, v6
    s_nop 0
    v_mul_f32 v90, v90, v6
    v_mul_f32 v6, v91, v91
    v_fma_f32 v6, v6, s40, 1.0
    v_mul_f32 v6, v6, v91
    v_mul_f32 v6, s41, v6
    v_exp_f32 v6, v6
    s_nop 0
    v_add_f32 v6, 1.0, v6
    v_rcp_f32 v6, v6
    s_nop 0
    v_mul_f32 v91, v91, v6
    v_mul_f32 v6, v92, v92
    v_fma_f32 v6, v6, s40, 1.0
    v_mul_f32 v6, v6, v92
    v_mul_f32 v6, s41, v6
    v_exp_f32 v6, v6
    s_nop 0
    v_add_f32 v6, 1.0, v6
    v_rcp_f32 v6, v6
    s_nop 0
    v_mul_f32 v92, v92, v6
    v_mul_f32 v6, v93, v93
    v_fma_f32 v6, v6, s40, 1.0
    v_mul_f32 v6, v6, v93
    v_mul_f32 v6, s41, v6
    v_exp_f32 v6, v6
    s_nop 0
    v_add_f32 v6, 1.0, v6
    v_rcp_f32 v6, v6
    s_nop 0
    v_mul_f32 v93, v93, v6
    v_mul_f32 v6, v94, v94
    v_fma_f32 v6, v6, s40, 1.0
    v_mul_f32 v6, v6, v94
    v_mul_f32 v6, s41, v6
    v_exp_f32 v6, v6
    s_nop 0
    v_add_f32 v6, 1.0, v6
    v_rcp_f32 v6, v6
    s_nop 0
    v_mul_f32 v94, v94, v6
    v_mul_f32 v6, v95, v95
    v_fma_f32 v6, v6, s40, 1.0
    v_mul_f32 v6, v6, v95
    v_mul_f32 v6, s41, v6
    v_exp_f32 v6, v6
    s_nop 0
    v_add_f32 v6, 1.0, v6
    v_rcp_f32 v6, v6
    s_nop 0
    v_mul_f32 v95, v95, v6
    v_mul_f32 v6, v96, v96
    v_fma_f32 v6, v6, s40, 1.0
    v_mul_f32 v6, v6, v96
    v_mul_f32 v6, s41, v6
    v_exp_f32 v6, v6
    s_nop 0
    v_add_f32 v6, 1.0, v6
    v_rcp_f32 v6, v6
    s_nop 0
    v_mul_f32 v96, v96, v6
    v_mul_f32 v6, v97, v97
    v_fma_f32 v6, v6, s40, 1.0
    v_mul_f32 v6, v6, v97
    v_mul_f32 v6, s41, v6
    v_exp_f32 v6, v6
    s_nop 0
    v_add_f32 v6, 1.0, v6
    v_rcp_f32 v6, v6
    s_nop 0
    v_mul_f32 v97, v97, v6
    v_mul_f32 v6, v98, v98
    v_fma_f32 v6, v6, s40, 1.0
    v_mul_f32 v6, v6, v98
    v_mul_f32 v6, s41, v6
    v_exp_f32 v6, v6
    s_nop 0
    v_add_f32 v6, 1.0, v6
    v_rcp_f32 v6, v6
    s_nop 0
    v_mul_f32 v98, v98, v6
    v_mul_f32 v6, v99, v99
    v_fma_f32 v6, v6, s40, 1.0
    v_mul_f32 v6, v6, v99
    v_mul_f32 v6, s41, v6
    v_exp_f32 v6, v6
    s_nop 0
    v_add_f32 v6, 1.0, v6
    v_rcp_f32 v6, v6
    s_nop 0
    v_mul_f32 v99, v99, v6
    v_mul_f32 v6, v100, v100
    v_fma_f32 v6, v6, s40, 1.0
    v_mul_f32 v6, v6, v100
    v_mul_f32 v6, s41, v6
    v_exp_f32 v6, v6
    s_nop 0
    v_add_f32 v6, 1.0, v6
    v_rcp_f32 v6, v6
    s_nop 0
    v_mul_f32 v100, v100, v6
    v_mul_f32 v6, v101, v101
    v_fma_f32 v6, v6, s40, 1.0
    v_mul_f32 v6, v6, v101
    v_mul_f32 v6, s41, v6
    v_exp_f32 v6, v6
    s_nop 0
    v_add_f32 v6, 1.0, v6
    v_rcp_f32 v6, v6
    s_nop 0
    v_mul_f32 v101, v101, v6
    v_mul_f32 v6, v102, v102
    v_fma_f32 v6, v6, s40, 1.0
    v_mul_f32 v6, v6, v102
    v_mul_f32 v6, s41, v6
    v_exp_f32 v6, v6
    s_nop 0
    v_add_f32 v6, 1.0, v6
    v_rcp_f32 v6, v6
    s_nop 0
    v_mul_f32 v102, v102, v6
    v_mul_f32 v6, v103, v103
    v_fma_f32 v6, v6, s40, 1.0
    v_mul_f32 v6, v6, v103
    v_mul_f32 v6, s41, v6
    v_exp_f32 v6, v6
    s_nop 0
    v_add_f32 v6, 1.0, v6
    v_rcp_f32 v6, v6
    s_nop 0
    v_mul_f32 v103, v103, v6
    v_mul_f32 v6, v104, v104
    v_fma_f32 v6, v6, s40, 1.0
    v_mul_f32 v6, v6, v104
    v_mul_f32 v6, s41, v6
    v_exp_f32 v6, v6
    s_nop 0
    v_add_f32 v6, 1.0, v6
    v_rcp_f32 v6, v6
    s_nop 0
    v_mul_f32 v104, v104, v6
    v_mul_f32 v6, v105, v105
    v_fma_f32 v6, v6, s40, 1.0
    v_mul_f32 v6, v6, v105
    v_mul_f32 v6, s41, v6
    v_exp_f32 v6, v6
    s_nop 0
    v_add_f32 v6, 1.0, v6
    v_rcp_f32 v6, v6
    s_nop 0
    v_mul_f32 v105, v105, v6
    v_mul_f32 v6, v106, v106
    v_fma_f32 v6, v6, s40, 1.0
    v_mul_f32 v6, v6, v106
    v_mul_f32 v6, s41, v6
    v_exp_f32 v6, v6
    s_nop 0
    v_add_f32 v6, 1.0, v6
    v_rcp_f32 v6, v6
    s_nop 0
    v_mul_f32 v106, v106, v6
    v_mul_f32 v6, v107, v107
    v_fma_f32 v6, v6, s40, 1.0
    v_mul_f32 v6, v6, v107
    v_mul_f32 v6, s41, v6
    v_exp_f32 v6, v6
    s_nop 0
    v_add_f32 v6, 1.0, v6
    v_rcp_f32 v6, v6
    s_nop 0
    v_mul_f32 v107, v107, v6
    v_mul_f32 v6, v108, v108
    v_fma_f32 v6, v6, s40, 1.0
    v_mul_f32 v6, v6, v108
    v_mul_f32 v6, s41, v6
    v_exp_f32 v6, v6
    s_nop 0
    v_add_f32 v6, 1.0, v6
    v_rcp_f32 v6, v6
    s_nop 0
    v_mul_f32 v108, v108, v6
    v_mul_f32 v6, v109, v109
    v_fma_f32 v6, v6, s40, 1.0
    v_mul_f32 v6, v6, v109
    v_mul_f32 v6, s41, v6
    v_exp_f32 v6, v6
    s_nop 0
    v_add_f32 v6, 1.0, v6
    v_rcp_f32 v6, v6
    s_nop 0
    v_mul_f32 v109, v109, v6
    v_mul_f32 v6, v110, v110
    v_fma_f32 v6, v6, s40, 1.0
    v_mul_f32 v6, v6, v110
    v_mul_f32 v6, s41, v6
    v_exp_f32 v6, v6
    s_nop 0
    v_add_f32 v6, 1.0, v6
    v_rcp_f32 v6, v6
    s_nop 0
    v_mul_f32 v110, v110, v6
    v_mul_f32 v6, v111, v111
    v_fma_f32 v6, v6, s40, 1.0
    v_mul_f32 v6, v6, v111
    v_mul_f32 v6, s41, v6
    v_exp_f32 v6, v6
    s_nop 0
    v_add_f32 v6, 1.0, v6
    v_rcp_f32 v6, v6
    s_nop 0
    v_mul_f32 v111, v111, v6
    v_mul_f32 v6, v112, v112
    v_fma_f32 v6, v6, s40, 1.0
    v_mul_f32 v6, v6, v112
    v_mul_f32 v6, s41, v6
    v_exp_f32 v6, v6
    s_nop 0
    v_add_f32 v6, 1.0, v6
    v_rcp_f32 v6, v6
    s_nop 0
    v_mul_f32 v112, v112, v6
    v_mul_f32 v6, v113, v113
    v_fma_f32 v6, v6, s40, 1.0
    v_mul_f32 v6, v6, v113
    v_mul_f32 v6, s41, v6
    v_exp_f32 v6, v6
    s_nop 0
    v_add_f32 v6, 1.0, v6
    v_rcp_f32 v6, v6
    s_nop 0
    v_mul_f32 v113, v113, v6
    v_mul_f32 v6, v114, v114
    v_fma_f32 v6, v6, s40, 1.0
    v_mul_f32 v6, v6, v114
    v_mul_f32 v6, s41, v6
    v_exp_f32 v6, v6
    s_nop 0
    v_add_f32 v6, 1.0, v6
    v_rcp_f32 v6, v6
    s_nop 0
    v_mul_f32 v114, v114, v6
    v_mul_f32 v6, v115, v115
    v_fma_f32 v6, v6, s40, 1.0
    v_mul_f32 v6, v6, v115
    v_mul_f32 v6, s41, v6
    v_exp_f32 v6, v6
    s_nop 0
    v_add_f32 v6, 1.0, v6
    v_rcp_f32 v6, v6
    s_nop 0
    v_mul_f32 v115, v115, v6
    v_mul_f32 v6, v116, v116
    v_fma_f32 v6, v6, s40, 1.0
    v_mul_f32 v6, v6, v116
    v_mul_f32 v6, s41, v6
    v_exp_f32 v6, v6
    s_nop 0
    v_add_f32 v6, 1.0, v6
    v_rcp_f32 v6, v6
    s_nop 0
    v_mul_f32 v116, v116, v6
    v_mul_f32 v6, v117, v117
    v_fma_f32 v6, v6, s40, 1.0
    v_mul_f32 v6, v6, v117
    v_mul_f32 v6, s41, v6
    v_exp_f32 v6, v6
    s_nop 0
    v_add_f32 v6, 1.0, v6
    v_rcp_f32 v6, v6
    s_nop 0
    v_mul_f32 v117, v117, v6
    v_mul_f32 v6, v118, v118
    v_fma_f32 v6, v6, s40, 1.0
    v_mul_f32 v6, v6, v118
    v_mul_f32 v6, s41, v6
    v_exp_f32 v6, v6
    s_nop 0
    v_add_f32 v6, 1.0, v6
    v_rcp_f32 v6, v6
    s_nop 0
    v_mul_f32 v118, v118, v6
    v_mul_f32 v6, v119, v119
    v_fma_f32 v6, v6, s40, 1.0
    v_mul_f32 v6, v6, v119
    v_mul_f32 v6, s41, v6
    v_exp_f32 v6, v6
    s_nop 0
    v_add_f32 v6, 1.0, v6
    v_rcp_f32 v6, v6
    s_nop 0
    v_mul_f32 v119, v119, v6
    v_mul_f32 v6, v120, v120
    v_fma_f32 v6, v6, s40, 1.0
    v_mul_f32 v6, v6, v120
    v_mul_f32 v6, s41, v6
    v_exp_f32 v6, v6
    s_nop 0
    v_add_f32 v6, 1.0, v6
    v_rcp_f32 v6, v6
    s_nop 0
    v_mul_f32 v120, v120, v6
    v_mul_f32 v6, v121, v121
    v_fma_f32 v6, v6, s40, 1.0
    v_mul_f32 v6, v6, v121
    v_mul_f32 v6, s41, v6
    v_exp_f32 v6, v6
    s_nop 0
    v_add_f32 v6, 1.0, v6
    v_rcp_f32 v6, v6
    s_nop 0
    v_mul_f32 v121, v121, v6
    v_mul_f32 v6, v122, v122
    v_fma_f32 v6, v6, s40, 1.0
    v_mul_f32 v6, v6, v122
    v_mul_f32 v6, s41, v6
    v_exp_f32 v6, v6
    s_nop 0
    v_add_f32 v6, 1.0, v6
    v_rcp_f32 v6, v6
    s_nop 0
    v_mul_f32 v122, v122, v6
    v_mul_f32 v6, v123, v123
    v_fma_f32 v6, v6, s40, 1.0
    v_mul_f32 v6, v6, v123
    v_mul_f32 v6, s41, v6
    v_exp_f32 v6, v6
    s_nop 0
    v_add_f32 v6, 1.0, v6
    v_rcp_f32 v6, v6
    s_nop 0
    v_mul_f32 v123, v123, v6
    v_mul_f32 v6, v124, v124
    v_fma_f32 v6, v6, s40, 1.0
    v_mul_f32 v6, v6, v124
    v_mul_f32 v6, s41, v6
    v_exp_f32 v6, v6
    s_nop 0
    v_add_f32 v6, 1.0, v6
    v_rcp_f32 v6, v6
    s_nop 0
    v_mul_f32 v124, v124, v6
    v_mul_f32 v6, v125, v125
    v_fma_f32 v6, v6, s40, 1.0
    v_mul_f32 v6, v6, v125
    v_mul_f32 v6, s41, v6
    v_exp_f32 v6, v6
    s_nop 0
    v_add_f32 v6, 1.0, v6
    v_rcp_f32 v6, v6
    s_nop 0
    v_mul_f32 v125, v125, v6
    v_mul_f32 v6, v126, v126
    v_fma_f32 v6, v6, s40, 1.0
    v_mul_f32 v6, v6, v126
    v_mul_f32 v6, s41, v6
    v_exp_f32 v6, v6
    s_nop 0
    v_add_f32 v6, 1.0, v6
    v_rcp_f32 v6, v6
    s_nop 0
    v_mul_f32 v126, v126, v6
    v_mul_f32 v6, v127, v127
    v_fma_f32 v6, v6, s40, 1.0
    v_mul_f32 v6, v6, v127
    v_mul_f32 v6, s41, v6
    v_exp_f32 v6, v6
    s_nop 0
    v_add_f32 v6, 1.0, v6
    v_rcp_f32 v6, v6
    s_nop 0
    v_mul_f32 v127, v127, v6
    v_cvt_pk_bf16_f32 v128, v64, v65
    v_cvt_pk_bf16_f32 v129, v66, v67
    v_cvt_pk_bf16_f32 v130, v68, v69
    v_cvt_pk_bf16_f32 v131, v70, v71
    v_cvt_pk_bf16_f32 v132, v72, v73
    v_cvt_pk_bf16_f32 v133, v74, v75
    v_cvt_pk_bf16_f32 v134, v76, v77
    v_cvt_pk_bf16_f32 v135, v78, v79
    v_cvt_pk_bf16_f32 v136, v80, v81
    v_cvt_pk_bf16_f32 v137, v82, v83
    v_cvt_pk_bf16_f32 v138, v84, v85
    v_cvt_pk_bf16_f32 v139, v86, v87
    v_cvt_pk_bf16_f32 v140, v88, v89
    v_cvt_pk_bf16_f32 v141, v90, v91
    v_cvt_pk_bf16_f32 v142, v92, v93
    v_cvt_pk_bf16_f32 v143, v94, v95
    v_cvt_pk_bf16_f32 v144, v96, v97
    v_cvt_pk_bf16_f32 v145, v98, v99
    v_cvt_pk_bf16_f32 v146, v100, v101
    v_cvt_pk_bf16_f32 v147, v102, v103
    v_cvt_pk_bf16_f32 v148, v104, v105
    v_cvt_pk_bf16_f32 v149, v106, v107
    v_cvt_pk_bf16_f32 v150, v108, v109
    v_cvt_pk_bf16_f32 v151, v110, v111
    v_cvt_pk_bf16_f32 v152, v112, v113
    v_cvt_pk_bf16_f32 v153, v114, v115
    v_cvt_pk_bf16_f32 v154, v116, v117
    v_cvt_pk_bf16_f32 v155, v118, v119
    v_cvt_pk_bf16_f32 v156, v120, v121
    v_cvt_pk_bf16_f32 v157, v122, v123
    v_cvt_pk_bf16_f32 v158, v124, v125
    v_cvt_pk_bf16_f32 v159, v126, v127
    s_mul_i32 s40, s35, 64
    s_add_u32 s40, s40, s33
    s_mul_i32 s41, s29, 64
    s_add_u32 s41, s41, s32
    s_add_u32 s16, s36, 0xa00000
    s_addc_u32 s17, s37, 0
    s_mov_b32 s18, 0x380000
    s_mov_b32 s19, 0x00020000
    v_add_u32 v13, s40, v8
    v_mul_u32_u24 v14, 1792, v13
    v_lshl_add_u32 v14, v9, 3, v14
    s_lshl_b32 s41, s41, 1
    v_add_u32 v14, s41, v14
    v_add_u32 v6, 0, v14
    buffer_store_dwordx2 v[128:129], v6, s[16:19], 0 offen
    v_add_u32 v6, 16, v14
    buffer_store_dwordx2 v[130:131], v6, s[16:19], 0 offen
    v_add_u32 v6, 32, v14
    buffer_store_dwordx2 v[132:133], v6, s[16:19], 0 offen
    v_add_u32 v6, 48, v14
    buffer_store_dwordx2 v[134:135], v6, s[16:19], 0 offen
    v_add_u32 v6, 57344, v14
    buffer_store_dwordx2 v[136:137], v6, s[16:19], 0 offen
    v_add_u32 v6, 57360, v14
    buffer_store_dwordx2 v[138:139], v6, s[16:19], 0 offen
    v_add_u32 v6, 57376, v14
    buffer_store_dwordx2 v[140:141], v6, s[16:19], 0 offen
    v_add_u32 v6, 57392, v14
    buffer_store_dwordx2 v[142:143], v6, s[16:19], 0 offen
    v_add_u32 v6, 64, v14
    buffer_store_dwordx2 v[144:145], v6, s[16:19], 0 offen
    v_add_u32 v6, 80, v14
    buffer_store_dwordx2 v[146:147], v6, s[16:19], 0 offen
    v_add_u32 v6, 96, v14
    buffer_store_dwordx2 v[148:149], v6, s[16:19], 0 offen
    v_add_u32 v6, 112, v14
    buffer_store_dwordx2 v[150:151], v6, s[16:19], 0 offen
    v_add_u32 v6, 57408, v14
    buffer_store_dwordx2 v[152:153], v6, s[16:19], 0 offen
    v_add_u32 v6, 57424, v14
    buffer_store_dwordx2 v[154:155], v6, s[16:19], 0 offen
    v_add_u32 v6, 57440, v14
    buffer_store_dwordx2 v[156:157], v6, s[16:19], 0 offen
    v_add_u32 v6, 57456, v14
    buffer_store_dwordx2 v[158:159], v6, s[16:19], 0 offen
    s_branch gemm1_done
gemm1_sw:
    s_barrier
    ds_read_b128 v[128:131], v32 offset:0
    ds_read_b128 v[132:135], v32 offset:4096
    ds_read_b128 v[160:163], v36 offset:0
    ds_read_b128 v[164:167], v36 offset:4096
    ds_read_b128 v[136:139], v33 offset:0
    ds_read_b128 v[140:143], v33 offset:4096
    ds_read_b128 v[168:171], v37 offset:0
    ds_read_b128 v[172:175], v37 offset:4096
    ds_read_b128 v[144:147], v34 offset:0
    ds_read_b128 v[148:151], v34 offset:4096
    ds_read_b128 v[176:179], v38 offset:0
    ds_read_b128 v[180:183], v38 offset:4096
    ds_read_b128 v[152:155], v35 offset:0
    ds_read_b128 v[156:159], v35 offset:4096
    ds_read_b128 v[184:187], v39 offset:0
    ds_read_b128 v[188:191], v39 offset:4096
    s_waitcnt lgkmcnt(12)
    v_mfma_f32_32x32x16_bf16 v[64:79], v[160:163], v[128:131], v[64:79]
    v_mfma_f32_32x32x16_bf16 v[80:95], v[164:167], v[128:131], v[80:95]
    v_mfma_f32_32x32x16_bf16 v[96:111], v[160:163], v[132:135], v[96:111]
    v_mfma_f32_32x32x16_bf16 v[112:127], v[164:167], v[132:135], v[112:127]
    s_waitcnt lgkmcnt(8)
    v_mfma_f32_32x32x16_bf16 v[64:79], v[168:171], v[136:139], v[64:79]
    v_mfma_f32_32x32x16_bf16 v[80:95], v[172:175], v[136:139], v[80:95]
    v_mfma_f32_32x32x16_bf16 v[96:111], v[168:171], v[140:143], v[96:111]
    v_mfma_f32_32x32x16_bf16 v[112:127], v[172:175], v[140:143], v[112:127]
    s_waitcnt lgkmcnt(4)
    v_mfma_f32_32x32x16_bf16 v[64:79], v[176:179], v[144:147], v[64:79]
    v_mfma_f32_32x32x16_bf16 v[80:95], v[180:183], v[144:147], v[80:95]
    v_mfma_f32_32x32x16_bf16 v[96:111], v[176:179], v[148:151], v[96:111]
    v_mfma_f32_32x32x16_bf16 v[112:127], v[180:183], v[148:151], v[112:127]
    s_waitcnt lgkmcnt(0)
    v_mfma_f32_32x32x16_bf16 v[64:79], v[184:187], v[152:155], v[64:79]
    v_mfma_f32_32x32x16_bf16 v[80:95], v[188:191], v[152:155], v[80:95]
    v_mfma_f32_32x32x16_bf16 v[96:111], v[184:187], v[156:159], v[96:111]
    v_mfma_f32_32x32x16_bf16 v[112:127], v[188:191], v[156:159], v[112:127]
    s_barrier
    ds_read_b128 v[128:131], v32 offset:32768
    ds_read_b128 v[132:135], v32 offset:36864
    ds_read_b128 v[160:163], v36 offset:32768
    ds_read_b128 v[164:167], v36 offset:36864
    ds_read_b128 v[136:139], v33 offset:32768
    ds_read_b128 v[140:143], v33 offset:36864
    ds_read_b128 v[168:171], v37 offset:32768
    ds_read_b128 v[172:175], v37 offset:36864
    ds_read_b128 v[144:147], v34 offset:32768
    ds_read_b128 v[148:151], v34 offset:36864
    ds_read_b128 v[176:179], v38 offset:32768
    ds_read_b128 v[180:183], v38 offset:36864
    ds_read_b128 v[152:155], v35 offset:32768
    ds_read_b128 v[156:159], v35 offset:36864
    ds_read_b128 v[184:187], v39 offset:32768
    ds_read_b128 v[188:191], v39 offset:36864
    s_waitcnt lgkmcnt(12)
    v_mfma_f32_32x32x16_bf16 v[64:79], v[160:163], v[128:131], v[64:79]
    v_mfma_f32_32x32x16_bf16 v[80:95], v[164:167], v[128:131], v[80:95]
    v_mfma_f32_32x32x16_bf16 v[96:111], v[160:163], v[132:135], v[96:111]
    v_mfma_f32_32x32x16_bf16 v[112:127], v[164:167], v[132:135], v[112:127]
    s_waitcnt lgkmcnt(8)
    v_mfma_f32_32x32x16_bf16 v[64:79], v[168:171], v[136:139], v[64:79]
    v_mfma_f32_32x32x16_bf16 v[80:95], v[172:175], v[136:139], v[80:95]
    v_mfma_f32_32x32x16_bf16 v[96:111], v[168:171], v[140:143], v[96:111]
    v_mfma_f32_32x32x16_bf16 v[112:127], v[172:175], v[140:143], v[112:127]
    s_waitcnt lgkmcnt(4)
    v_mfma_f32_32x32x16_bf16 v[64:79], v[176:179], v[144:147], v[64:79]
    v_mfma_f32_32x32x16_bf16 v[80:95], v[180:183], v[144:147], v[80:95]
    v_mfma_f32_32x32x16_bf16 v[96:111], v[176:179], v[148:151], v[96:111]
    v_mfma_f32_32x32x16_bf16 v[112:127], v[180:183], v[148:151], v[112:127]
    s_waitcnt lgkmcnt(0)
    v_mfma_f32_32x32x16_bf16 v[64:79], v[184:187], v[152:155], v[64:79]
    v_mfma_f32_32x32x16_bf16 v[80:95], v[188:191], v[152:155], v[80:95]
    v_mfma_f32_32x32x16_bf16 v[96:111], v[184:187], v[156:159], v[96:111]
    v_mfma_f32_32x32x16_bf16 v[112:127], v[188:191], v[156:159], v[112:127]
    s_barrier
    ds_read_b128 v[128:131], v40 offset:0
    ds_read_b128 v[132:135], v40 offset:4096
    ds_read_b128 v[160:163], v44 offset:0
    ds_read_b128 v[164:167], v44 offset:4096
    ds_read_b128 v[136:139], v41 offset:0
    ds_read_b128 v[140:143], v41 offset:4096
    ds_read_b128 v[168:171], v45 offset:0
    ds_read_b128 v[172:175], v45 offset:4096
    ds_read_b128 v[144:147], v42 offset:0
    ds_read_b128 v[148:151], v42 offset:4096
    ds_read_b128 v[176:179], v46 offset:0
    ds_read_b128 v[180:183], v46 offset:4096
    ds_read_b128 v[152:155], v43 offset:0
    ds_read_b128 v[156:159], v43 offset:4096
    ds_read_b128 v[184:187], v47 offset:0
    ds_read_b128 v[188:191], v47 offset:4096
    s_waitcnt lgkmcnt(12)
    v_mfma_f32_32x32x16_bf16 v[64:79], v[160:163], v[128:131], v[64:79]
    v_mfma_f32_32x32x16_bf16 v[80:95], v[164:167], v[128:131], v[80:95]
    v_mfma_f32_32x32x16_bf16 v[96:111], v[160:163], v[132:135], v[96:111]
    v_mfma_f32_32x32x16_bf16 v[112:127], v[164:167], v[132:135], v[112:127]
    s_waitcnt lgkmcnt(8)
    v_mfma_f32_32x32x16_bf16 v[64:79], v[168:171], v[136:139], v[64:79]
    v_mfma_f32_32x32x16_bf16 v[80:95], v[172:175], v[136:139], v[80:95]
    v_mfma_f32_32x32x16_bf16 v[96:111], v[168:171], v[140:143], v[96:111]
    v_mfma_f32_32x32x16_bf16 v[112:127], v[172:175], v[140:143], v[112:127]
    s_waitcnt lgkmcnt(4)
    v_mfma_f32_32x32x16_bf16 v[64:79], v[176:179], v[144:147], v[64:79]
    v_mfma_f32_32x32x16_bf16 v[80:95], v[180:183], v[144:147], v[80:95]
    v_mfma_f32_32x32x16_bf16 v[96:111], v[176:179], v[148:151], v[96:111]
    v_mfma_f32_32x32x16_bf16 v[112:127], v[180:183], v[148:151], v[112:127]
    s_waitcnt lgkmcnt(0)
    v_mfma_f32_32x32x16_bf16 v[64:79], v[184:187], v[152:155], v[64:79]
    v_mfma_f32_32x32x16_bf16 v[80:95], v[188:191], v[152:155], v[80:95]
    v_mfma_f32_32x32x16_bf16 v[96:111], v[184:187], v[156:159], v[96:111]
    v_mfma_f32_32x32x16_bf16 v[112:127], v[188:191], v[156:159], v[112:127]
    s_barrier
    ds_read_b128 v[128:131], v40 offset:32768
    ds_read_b128 v[132:135], v40 offset:36864
    ds_read_b128 v[160:163], v44 offset:32768
    ds_read_b128 v[164:167], v44 offset:36864
    ds_read_b128 v[136:139], v41 offset:32768
    ds_read_b128 v[140:143], v41 offset:36864
    ds_read_b128 v[168:171], v45 offset:32768
    ds_read_b128 v[172:175], v45 offset:36864
    ds_read_b128 v[144:147], v42 offset:32768
    ds_read_b128 v[148:151], v42 offset:36864
    ds_read_b128 v[176:179], v46 offset:32768
    ds_read_b128 v[180:183], v46 offset:36864
    ds_read_b128 v[152:155], v43 offset:32768
    ds_read_b128 v[156:159], v43 offset:36864
    ds_read_b128 v[184:187], v47 offset:32768
    ds_read_b128 v[188:191], v47 offset:36864
    s_waitcnt lgkmcnt(12)
    v_mfma_f32_32x32x16_bf16 v[64:79], v[160:163], v[128:131], v[64:79]
    v_mfma_f32_32x32x16_bf16 v[80:95], v[164:167], v[128:131], v[80:95]
    v_mfma_f32_32x32x16_bf16 v[96:111], v[160:163], v[132:135], v[96:111]
    v_mfma_f32_32x32x16_bf16 v[112:127], v[164:167], v[132:135], v[112:127]
    s_waitcnt lgkmcnt(8)
    v_mfma_f32_32x32x16_bf16 v[64:79], v[168:171], v[136:139], v[64:79]
    v_mfma_f32_32x32x16_bf16 v[80:95], v[172:175], v[136:139], v[80:95]
    v_mfma_f32_32x32x16_bf16 v[96:111], v[168:171], v[140:143], v[96:111]
    v_mfma_f32_32x32x16_bf16 v[112:127], v[172:175], v[140:143], v[112:127]
    s_waitcnt lgkmcnt(4)
    v_mfma_f32_32x32x16_bf16 v[64:79], v[176:179], v[144:147], v[64:79]
    v_mfma_f32_32x32x16_bf16 v[80:95], v[180:183], v[144:147], v[80:95]
    v_mfma_f32_32x32x16_bf16 v[96:111], v[176:179], v[148:151], v[96:111]
    v_mfma_f32_32x32x16_bf16 v[112:127], v[180:183], v[148:151], v[112:127]
    s_waitcnt lgkmcnt(0)
    v_mfma_f32_32x32x16_bf16 v[64:79], v[184:187], v[152:155], v[64:79]
    v_mfma_f32_32x32x16_bf16 v[80:95], v[188:191], v[152:155], v[80:95]
    v_mfma_f32_32x32x16_bf16 v[96:111], v[184:187], v[156:159], v[96:111]
    v_mfma_f32_32x32x16_bf16 v[112:127], v[188:191], v[156:159], v[112:127]
    s_barrier
    ds_read_b128 v[128:131], v32 offset:0
    ds_read_b128 v[132:135], v32 offset:4096
    ds_read_b128 v[160:163], v36 offset:0
    ds_read_b128 v[164:167], v36 offset:4096
    ds_read_b128 v[136:139], v33 offset:0
    ds_read_b128 v[140:143], v33 offset:4096
    ds_read_b128 v[168:171], v37 offset:0
    ds_read_b128 v[172:175], v37 offset:4096
    ds_read_b128 v[144:147], v34 offset:0
    ds_read_b128 v[148:151], v34 offset:4096
    ds_read_b128 v[176:179], v38 offset:0
    ds_read_b128 v[180:183], v38 offset:4096
    ds_read_b128 v[152:155], v35 offset:0
    ds_read_b128 v[156:159], v35 offset:4096
    ds_read_b128 v[184:187], v39 offset:0
    ds_read_b128 v[188:191], v39 offset:4096
    s_waitcnt lgkmcnt(12)
    v_mfma_f32_32x32x16_bf16 v[64:79], v[160:163], v[128:131], v[64:79]
    v_mfma_f32_32x32x16_bf16 v[80:95], v[164:167], v[128:131], v[80:95]
    v_mfma_f32_32x32x16_bf16 v[96:111], v[160:163], v[132:135], v[96:111]
    v_mfma_f32_32x32x16_bf16 v[112:127], v[164:167], v[132:135], v[112:127]
    s_waitcnt lgkmcnt(8)
    v_mfma_f32_32x32x16_bf16 v[64:79], v[168:171], v[136:139], v[64:79]
    v_mfma_f32_32x32x16_bf16 v[80:95], v[172:175], v[136:139], v[80:95]
    v_mfma_f32_32x32x16_bf16 v[96:111], v[168:171], v[140:143], v[96:111]
    v_mfma_f32_32x32x16_bf16 v[112:127], v[172:175], v[140:143], v[112:127]
    s_waitcnt lgkmcnt(4)
    v_mfma_f32_32x32x16_bf16 v[64:79], v[176:179], v[144:147], v[64:79]
    v_mfma_f32_32x32x16_bf16 v[80:95], v[180:183], v[144:147], v[80:95]
    v_mfma_f32_32x32x16_bf16 v[96:111], v[176:179], v[148:151], v[96:111]
    v_mfma_f32_32x32x16_bf16 v[112:127], v[180:183], v[148:151], v[112:127]
    s_waitcnt lgkmcnt(0)
    v_mfma_f32_32x32x16_bf16 v[64:79], v[184:187], v[152:155], v[64:79]
    v_mfma_f32_32x32x16_bf16 v[80:95], v[188:191], v[152:155], v[80:95]
    v_mfma_f32_32x32x16_bf16 v[96:111], v[184:187], v[156:159], v[96:111]
    v_mfma_f32_32x32x16_bf16 v[112:127], v[188:191], v[156:159], v[112:127]
    s_barrier
    ds_read_b128 v[128:131], v32 offset:32768
    ds_read_b128 v[132:135], v32 offset:36864
    ds_read_b128 v[160:163], v36 offset:32768
    ds_read_b128 v[164:167], v36 offset:36864
    ds_read_b128 v[136:139], v33 offset:32768
    ds_read_b128 v[140:143], v33 offset:36864
    ds_read_b128 v[168:171], v37 offset:32768
    ds_read_b128 v[172:175], v37 offset:36864
    ds_read_b128 v[144:147], v34 offset:32768
    ds_read_b128 v[148:151], v34 offset:36864
    ds_read_b128 v[176:179], v38 offset:32768
    ds_read_b128 v[180:183], v38 offset:36864
    ds_read_b128 v[152:155], v35 offset:32768
    ds_read_b128 v[156:159], v35 offset:36864
    ds_read_b128 v[184:187], v39 offset:32768
    ds_read_b128 v[188:191], v39 offset:36864
    s_waitcnt lgkmcnt(12)
    v_mfma_f32_32x32x16_bf16 v[64:79], v[160:163], v[128:131], v[64:79]
    v_mfma_f32_32x32x16_bf16 v[80:95], v[164:167], v[128:131], v[80:95]
    v_mfma_f32_32x32x16_bf16 v[96:111], v[160:163], v[132:135], v[96:111]
    v_mfma_f32_32x32x16_bf16 v[112:127], v[164:167], v[132:135], v[112:127]
    s_waitcnt lgkmcnt(8)
    v_mfma_f32_32x32x16_bf16 v[64:79], v[168:171], v[136:139], v[64:79]
    v_mfma_f32_32x32x16_bf16 v[80:95], v[172:175], v[136:139], v[80:95]
    v_mfma_f32_32x32x16_bf16 v[96:111], v[168:171], v[140:143], v[96:111]
    v_mfma_f32_32x32x16_bf16 v[112:127], v[172:175], v[140:143], v[112:127]
    s_waitcnt lgkmcnt(4)
    v_mfma_f32_32x32x16_bf16 v[64:79], v[176:179], v[144:147], v[64:79]
    v_mfma_f32_32x32x16_bf16 v[80:95], v[180:183], v[144:147], v[80:95]
    v_mfma_f32_32x32x16_bf16 v[96:111], v[176:179], v[148:151], v[96:111]
    v_mfma_f32_32x32x16_bf16 v[112:127], v[180:183], v[148:151], v[112:127]
    s_waitcnt lgkmcnt(0)
    v_mfma_f32_32x32x16_bf16 v[64:79], v[184:187], v[152:155], v[64:79]
    v_mfma_f32_32x32x16_bf16 v[80:95], v[188:191], v[152:155], v[80:95]
    v_mfma_f32_32x32x16_bf16 v[96:111], v[184:187], v[156:159], v[96:111]
    v_mfma_f32_32x32x16_bf16 v[112:127], v[188:191], v[156:159], v[112:127]
    s_barrier
    ds_read_b128 v[128:131], v40 offset:0
    ds_read_b128 v[132:135], v40 offset:4096
    ds_read_b128 v[160:163], v44 offset:0
    ds_read_b128 v[164:167], v44 offset:4096
    ds_read_b128 v[136:139], v41 offset:0
    ds_read_b128 v[140:143], v41 offset:4096
    ds_read_b128 v[168:171], v45 offset:0
    ds_read_b128 v[172:175], v45 offset:4096
    ds_read_b128 v[144:147], v42 offset:0
    ds_read_b128 v[148:151], v42 offset:4096
    ds_read_b128 v[176:179], v46 offset:0
    ds_read_b128 v[180:183], v46 offset:4096
    ds_read_b128 v[152:155], v43 offset:0
    ds_read_b128 v[156:159], v43 offset:4096
    ds_read_b128 v[184:187], v47 offset:0
    ds_read_b128 v[188:191], v47 offset:4096
    s_waitcnt lgkmcnt(12)
    v_mfma_f32_32x32x16_bf16 v[64:79], v[160:163], v[128:131], v[64:79]
    v_mfma_f32_32x32x16_bf16 v[80:95], v[164:167], v[128:131], v[80:95]
    v_mfma_f32_32x32x16_bf16 v[96:111], v[160:163], v[132:135], v[96:111]
    v_mfma_f32_32x32x16_bf16 v[112:127], v[164:167], v[132:135], v[112:127]
    s_waitcnt lgkmcnt(8)
    v_mfma_f32_32x32x16_bf16 v[64:79], v[168:171], v[136:139], v[64:79]
    v_mfma_f32_32x32x16_bf16 v[80:95], v[172:175], v[136:139], v[80:95]
    v_mfma_f32_32x32x16_bf16 v[96:111], v[168:171], v[140:143], v[96:111]
    v_mfma_f32_32x32x16_bf16 v[112:127], v[172:175], v[140:143], v[112:127]
    s_waitcnt lgkmcnt(4)
    v_mfma_f32_32x32x16_bf16 v[64:79], v[176:179], v[144:147], v[64:79]
    v_mfma_f32_32x32x16_bf16 v[80:95], v[180:183], v[144:147], v[80:95]
    v_mfma_f32_32x32x16_bf16 v[96:111], v[176:179], v[148:151], v[96:111]
    v_mfma_f32_32x32x16_bf16 v[112:127], v[180:183], v[148:151], v[112:127]
    s_waitcnt lgkmcnt(0)
    v_mfma_f32_32x32x16_bf16 v[64:79], v[184:187], v[152:155], v[64:79]
    v_mfma_f32_32x32x16_bf16 v[80:95], v[188:191], v[152:155], v[80:95]
    v_mfma_f32_32x32x16_bf16 v[96:111], v[184:187], v[156:159], v[96:111]
    v_mfma_f32_32x32x16_bf16 v[112:127], v[188:191], v[156:159], v[112:127]
    s_nop 15
    s_nop 7
    v_mul_f32 v6, v64, v64
    v_fma_f32 v6, v6, s40, 1.0
    v_mul_f32 v6, v6, v64
    v_mul_f32 v6, s41, v6
    v_exp_f32 v6, v6
    s_nop 0
    v_add_f32 v6, 1.0, v6
    v_rcp_f32 v6, v6
    s_nop 0
    v_mul_f32 v64, v64, v6
    v_mul_f32 v6, v65, v65
    v_fma_f32 v6, v6, s40, 1.0
    v_mul_f32 v6, v6, v65
    v_mul_f32 v6, s41, v6
    v_exp_f32 v6, v6
    s_nop 0
    v_add_f32 v6, 1.0, v6
    v_rcp_f32 v6, v6
    s_nop 0
    v_mul_f32 v65, v65, v6
    v_mul_f32 v6, v66, v66
    v_fma_f32 v6, v6, s40, 1.0
    v_mul_f32 v6, v6, v66
    v_mul_f32 v6, s41, v6
    v_exp_f32 v6, v6
    s_nop 0
    v_add_f32 v6, 1.0, v6
    v_rcp_f32 v6, v6
    s_nop 0
    v_mul_f32 v66, v66, v6
    v_mul_f32 v6, v67, v67
    v_fma_f32 v6, v6, s40, 1.0
    v_mul_f32 v6, v6, v67
    v_mul_f32 v6, s41, v6
    v_exp_f32 v6, v6
    s_nop 0
    v_add_f32 v6, 1.0, v6
    v_rcp_f32 v6, v6
    s_nop 0
    v_mul_f32 v67, v67, v6
    v_mul_f32 v6, v68, v68
    v_fma_f32 v6, v6, s40, 1.0
    v_mul_f32 v6, v6, v68
    v_mul_f32 v6, s41, v6
    v_exp_f32 v6, v6
    s_nop 0
    v_add_f32 v6, 1.0, v6
    v_rcp_f32 v6, v6
    s_nop 0
    v_mul_f32 v68, v68, v6
    v_mul_f32 v6, v69, v69
    v_fma_f32 v6, v6, s40, 1.0
    v_mul_f32 v6, v6, v69
    v_mul_f32 v6, s41, v6
    v_exp_f32 v6, v6
    s_nop 0
    v_add_f32 v6, 1.0, v6
    v_rcp_f32 v6, v6
    s_nop 0
    v_mul_f32 v69, v69, v6
    v_mul_f32 v6, v70, v70
    v_fma_f32 v6, v6, s40, 1.0
    v_mul_f32 v6, v6, v70
    v_mul_f32 v6, s41, v6
    v_exp_f32 v6, v6
    s_nop 0
    v_add_f32 v6, 1.0, v6
    v_rcp_f32 v6, v6
    s_nop 0
    v_mul_f32 v70, v70, v6
    v_mul_f32 v6, v71, v71
    v_fma_f32 v6, v6, s40, 1.0
    v_mul_f32 v6, v6, v71
    v_mul_f32 v6, s41, v6
    v_exp_f32 v6, v6
    s_nop 0
    v_add_f32 v6, 1.0, v6
    v_rcp_f32 v6, v6
    s_nop 0
    v_mul_f32 v71, v71, v6
    v_mul_f32 v6, v72, v72
    v_fma_f32 v6, v6, s40, 1.0
    v_mul_f32 v6, v6, v72
    v_mul_f32 v6, s41, v6
    v_exp_f32 v6, v6
    s_nop 0
    v_add_f32 v6, 1.0, v6
    v_rcp_f32 v6, v6
    s_nop 0
    v_mul_f32 v72, v72, v6
    v_mul_f32 v6, v73, v73
    v_fma_f32 v6, v6, s40, 1.0
    v_mul_f32 v6, v6, v73
    v_mul_f32 v6, s41, v6
    v_exp_f32 v6, v6
    s_nop 0
    v_add_f32 v6, 1.0, v6
    v_rcp_f32 v6, v6
    s_nop 0
    v_mul_f32 v73, v73, v6
    v_mul_f32 v6, v74, v74
    v_fma_f32 v6, v6, s40, 1.0
    v_mul_f32 v6, v6, v74
    v_mul_f32 v6, s41, v6
    v_exp_f32 v6, v6
    s_nop 0
    v_add_f32 v6, 1.0, v6
    v_rcp_f32 v6, v6
    s_nop 0
    v_mul_f32 v74, v74, v6
    v_mul_f32 v6, v75, v75
    v_fma_f32 v6, v6, s40, 1.0
    v_mul_f32 v6, v6, v75
    v_mul_f32 v6, s41, v6
    v_exp_f32 v6, v6
    s_nop 0
    v_add_f32 v6, 1.0, v6
    v_rcp_f32 v6, v6
    s_nop 0
    v_mul_f32 v75, v75, v6
    v_mul_f32 v6, v76, v76
    v_fma_f32 v6, v6, s40, 1.0
    v_mul_f32 v6, v6, v76
    v_mul_f32 v6, s41, v6
    v_exp_f32 v6, v6
    s_nop 0
    v_add_f32 v6, 1.0, v6
    v_rcp_f32 v6, v6
    s_nop 0
    v_mul_f32 v76, v76, v6
    v_mul_f32 v6, v77, v77
    v_fma_f32 v6, v6, s40, 1.0
    v_mul_f32 v6, v6, v77
    v_mul_f32 v6, s41, v6
    v_exp_f32 v6, v6
    s_nop 0
    v_add_f32 v6, 1.0, v6
    v_rcp_f32 v6, v6
    s_nop 0
    v_mul_f32 v77, v77, v6
    v_mul_f32 v6, v78, v78
    v_fma_f32 v6, v6, s40, 1.0
    v_mul_f32 v6, v6, v78
    v_mul_f32 v6, s41, v6
    v_exp_f32 v6, v6
    s_nop 0
    v_add_f32 v6, 1.0, v6
    v_rcp_f32 v6, v6
    s_nop 0
    v_mul_f32 v78, v78, v6
    v_mul_f32 v6, v79, v79
    v_fma_f32 v6, v6, s40, 1.0
    v_mul_f32 v6, v6, v79
    v_mul_f32 v6, s41, v6
    v_exp_f32 v6, v6
    s_nop 0
    v_add_f32 v6, 1.0, v6
    v_rcp_f32 v6, v6
    s_nop 0
    v_mul_f32 v79, v79, v6
    v_mul_f32 v6, v80, v80
    v_fma_f32 v6, v6, s40, 1.0
    v_mul_f32 v6, v6, v80
    v_mul_f32 v6, s41, v6
    v_exp_f32 v6, v6
    s_nop 0
    v_add_f32 v6, 1.0, v6
    v_rcp_f32 v6, v6
    s_nop 0
    v_mul_f32 v80, v80, v6
    v_mul_f32 v6, v81, v81
    v_fma_f32 v6, v6, s40, 1.0
    v_mul_f32 v6, v6, v81
    v_mul_f32 v6, s41, v6
    v_exp_f32 v6, v6
    s_nop 0
    v_add_f32 v6, 1.0, v6
    v_rcp_f32 v6, v6
    s_nop 0
    v_mul_f32 v81, v81, v6
    v_mul_f32 v6, v82, v82
    v_fma_f32 v6, v6, s40, 1.0
    v_mul_f32 v6, v6, v82
    v_mul_f32 v6, s41, v6
    v_exp_f32 v6, v6
    s_nop 0
    v_add_f32 v6, 1.0, v6
    v_rcp_f32 v6, v6
    s_nop 0
    v_mul_f32 v82, v82, v6
    v_mul_f32 v6, v83, v83
    v_fma_f32 v6, v6, s40, 1.0
    v_mul_f32 v6, v6, v83
    v_mul_f32 v6, s41, v6
    v_exp_f32 v6, v6
    s_nop 0
    v_add_f32 v6, 1.0, v6
    v_rcp_f32 v6, v6
    s_nop 0
    v_mul_f32 v83, v83, v6
    v_mul_f32 v6, v84, v84
    v_fma_f32 v6, v6, s40, 1.0
    v_mul_f32 v6, v6, v84
    v_mul_f32 v6, s41, v6
    v_exp_f32 v6, v6
    s_nop 0
    v_add_f32 v6, 1.0, v6
    v_rcp_f32 v6, v6
    s_nop 0
    v_mul_f32 v84, v84, v6
    v_mul_f32 v6, v85, v85
    v_fma_f32 v6, v6, s40, 1.0
    v_mul_f32 v6, v6, v85
    v_mul_f32 v6, s41, v6
    v_exp_f32 v6, v6
    s_nop 0
    v_add_f32 v6, 1.0, v6
    v_rcp_f32 v6, v6
    s_nop 0
    v_mul_f32 v85, v85, v6
    v_mul_f32 v6, v86, v86
    v_fma_f32 v6, v6, s40, 1.0
    v_mul_f32 v6, v6, v86
    v_mul_f32 v6, s41, v6
    v_exp_f32 v6, v6
    s_nop 0
    v_add_f32 v6, 1.0, v6
    v_rcp_f32 v6, v6
    s_nop 0
    v_mul_f32 v86, v86, v6
    v_mul_f32 v6, v87, v87
    v_fma_f32 v6, v6, s40, 1.0
    v_mul_f32 v6, v6, v87
    v_mul_f32 v6, s41, v6
    v_exp_f32 v6, v6
    s_nop 0
    v_add_f32 v6, 1.0, v6
    v_rcp_f32 v6, v6
    s_nop 0
    v_mul_f32 v87, v87, v6
    v_mul_f32 v6, v88, v88
    v_fma_f32 v6, v6, s40, 1.0
    v_mul_f32 v6, v6, v88
    v_mul_f32 v6, s41, v6
    v_exp_f32 v6, v6
    s_nop 0
    v_add_f32 v6, 1.0, v6
    v_rcp_f32 v6, v6
    s_nop 0
    v_mul_f32 v88, v88, v6
    v_mul_f32 v6, v89, v89
    v_fma_f32 v6, v6, s40, 1.0
    v_mul_f32 v6, v6, v89
    v_mul_f32 v6, s41, v6
    v_exp_f32 v6, v6
    s_nop 0
    v_add_f32 v6, 1.0, v6
    v_rcp_f32 v6, v6
    s_nop 0
    v_mul_f32 v89, v89, v6
    v_mul_f32 v6, v90, v90
    v_fma_f32 v6, v6, s40, 1.0
    v_mul_f32 v6, v6, v90
    v_mul_f32 v6, s41, v6
    v_exp_f32 v6, v6
    s_nop 0
    v_add_f32 v6, 1.0, v6
    v_rcp_f32 v6, v6
    s_nop 0
    v_mul_f32 v90, v90, v6
    v_mul_f32 v6, v91, v91
    v_fma_f32 v6, v6, s40, 1.0
    v_mul_f32 v6, v6, v91
    v_mul_f32 v6, s41, v6
    v_exp_f32 v6, v6
    s_nop 0
    v_add_f32 v6, 1.0, v6
    v_rcp_f32 v6, v6
    s_nop 0
    v_mul_f32 v91, v91, v6
    v_mul_f32 v6, v92, v92
    v_fma_f32 v6, v6, s40, 1.0
    v_mul_f32 v6, v6, v92
    v_mul_f32 v6, s41, v6
    v_exp_f32 v6, v6
    s_nop 0
    v_add_f32 v6, 1.0, v6
    v_rcp_f32 v6, v6
    s_nop 0
    v_mul_f32 v92, v92, v6
    v_mul_f32 v6, v93, v93
    v_fma_f32 v6, v6, s40, 1.0
    v_mul_f32 v6, v6, v93
    v_mul_f32 v6, s41, v6
    v_exp_f32 v6, v6
    s_nop 0
    v_add_f32 v6, 1.0, v6
    v_rcp_f32 v6, v6
    s_nop 0
    v_mul_f32 v93, v93, v6
    v_mul_f32 v6, v94, v94
    v_fma_f32 v6, v6, s40, 1.0
    v_mul_f32 v6, v6, v94
    v_mul_f32 v6, s41, v6
    v_exp_f32 v6, v6
    s_nop 0
    v_add_f32 v6, 1.0, v6
    v_rcp_f32 v6, v6
    s_nop 0
    v_mul_f32 v94, v94, v6
    v_mul_f32 v6, v95, v95
    v_fma_f32 v6, v6, s40, 1.0
    v_mul_f32 v6, v6, v95
    v_mul_f32 v6, s41, v6
    v_exp_f32 v6, v6
    s_nop 0
    v_add_f32 v6, 1.0, v6
    v_rcp_f32 v6, v6
    s_nop 0
    v_mul_f32 v95, v95, v6
    v_mul_f32 v6, v96, v96
    v_fma_f32 v6, v6, s40, 1.0
    v_mul_f32 v6, v6, v96
    v_mul_f32 v6, s41, v6
    v_exp_f32 v6, v6
    s_nop 0
    v_add_f32 v6, 1.0, v6
    v_rcp_f32 v6, v6
    s_nop 0
    v_mul_f32 v96, v96, v6
    v_mul_f32 v6, v97, v97
    v_fma_f32 v6, v6, s40, 1.0
    v_mul_f32 v6, v6, v97
    v_mul_f32 v6, s41, v6
    v_exp_f32 v6, v6
    s_nop 0
    v_add_f32 v6, 1.0, v6
    v_rcp_f32 v6, v6
    s_nop 0
    v_mul_f32 v97, v97, v6
    v_mul_f32 v6, v98, v98
    v_fma_f32 v6, v6, s40, 1.0
    v_mul_f32 v6, v6, v98
    v_mul_f32 v6, s41, v6
    v_exp_f32 v6, v6
    s_nop 0
    v_add_f32 v6, 1.0, v6
    v_rcp_f32 v6, v6
    s_nop 0
    v_mul_f32 v98, v98, v6
    v_mul_f32 v6, v99, v99
    v_fma_f32 v6, v6, s40, 1.0
    v_mul_f32 v6, v6, v99
    v_mul_f32 v6, s41, v6
    v_exp_f32 v6, v6
    s_nop 0
    v_add_f32 v6, 1.0, v6
    v_rcp_f32 v6, v6
    s_nop 0
    v_mul_f32 v99, v99, v6
    v_mul_f32 v6, v100, v100
    v_fma_f32 v6, v6, s40, 1.0
    v_mul_f32 v6, v6, v100
    v_mul_f32 v6, s41, v6
    v_exp_f32 v6, v6
    s_nop 0
    v_add_f32 v6, 1.0, v6
    v_rcp_f32 v6, v6
    s_nop 0
    v_mul_f32 v100, v100, v6
    v_mul_f32 v6, v101, v101
    v_fma_f32 v6, v6, s40, 1.0
    v_mul_f32 v6, v6, v101
    v_mul_f32 v6, s41, v6
    v_exp_f32 v6, v6
    s_nop 0
    v_add_f32 v6, 1.0, v6
    v_rcp_f32 v6, v6
    s_nop 0
    v_mul_f32 v101, v101, v6
    v_mul_f32 v6, v102, v102
    v_fma_f32 v6, v6, s40, 1.0
    v_mul_f32 v6, v6, v102
    v_mul_f32 v6, s41, v6
    v_exp_f32 v6, v6
    s_nop 0
    v_add_f32 v6, 1.0, v6
    v_rcp_f32 v6, v6
    s_nop 0
    v_mul_f32 v102, v102, v6
    v_mul_f32 v6, v103, v103
    v_fma_f32 v6, v6, s40, 1.0
    v_mul_f32 v6, v6, v103
    v_mul_f32 v6, s41, v6
    v_exp_f32 v6, v6
    s_nop 0
    v_add_f32 v6, 1.0, v6
    v_rcp_f32 v6, v6
    s_nop 0
    v_mul_f32 v103, v103, v6
    v_mul_f32 v6, v104, v104
    v_fma_f32 v6, v6, s40, 1.0
    v_mul_f32 v6, v6, v104
    v_mul_f32 v6, s41, v6
    v_exp_f32 v6, v6
    s_nop 0
    v_add_f32 v6, 1.0, v6
    v_rcp_f32 v6, v6
    s_nop 0
    v_mul_f32 v104, v104, v6
    v_mul_f32 v6, v105, v105
    v_fma_f32 v6, v6, s40, 1.0
    v_mul_f32 v6, v6, v105
    v_mul_f32 v6, s41, v6
    v_exp_f32 v6, v6
    s_nop 0
    v_add_f32 v6, 1.0, v6
    v_rcp_f32 v6, v6
    s_nop 0
    v_mul_f32 v105, v105, v6
    v_mul_f32 v6, v106, v106
    v_fma_f32 v6, v6, s40, 1.0
    v_mul_f32 v6, v6, v106
    v_mul_f32 v6, s41, v6
    v_exp_f32 v6, v6
    s_nop 0
    v_add_f32 v6, 1.0, v6
    v_rcp_f32 v6, v6
    s_nop 0
    v_mul_f32 v106, v106, v6
    v_mul_f32 v6, v107, v107
    v_fma_f32 v6, v6, s40, 1.0
    v_mul_f32 v6, v6, v107
    v_mul_f32 v6, s41, v6
    v_exp_f32 v6, v6
    s_nop 0
    v_add_f32 v6, 1.0, v6
    v_rcp_f32 v6, v6
    s_nop 0
    v_mul_f32 v107, v107, v6
    v_mul_f32 v6, v108, v108
    v_fma_f32 v6, v6, s40, 1.0
    v_mul_f32 v6, v6, v108
    v_mul_f32 v6, s41, v6
    v_exp_f32 v6, v6
    s_nop 0
    v_add_f32 v6, 1.0, v6
    v_rcp_f32 v6, v6
    s_nop 0
    v_mul_f32 v108, v108, v6
    v_mul_f32 v6, v109, v109
    v_fma_f32 v6, v6, s40, 1.0
    v_mul_f32 v6, v6, v109
    v_mul_f32 v6, s41, v6
    v_exp_f32 v6, v6
    s_nop 0
    v_add_f32 v6, 1.0, v6
    v_rcp_f32 v6, v6
    s_nop 0
    v_mul_f32 v109, v109, v6
    v_mul_f32 v6, v110, v110
    v_fma_f32 v6, v6, s40, 1.0
    v_mul_f32 v6, v6, v110
    v_mul_f32 v6, s41, v6
    v_exp_f32 v6, v6
    s_nop 0
    v_add_f32 v6, 1.0, v6
    v_rcp_f32 v6, v6
    s_nop 0
    v_mul_f32 v110, v110, v6
    v_mul_f32 v6, v111, v111
    v_fma_f32 v6, v6, s40, 1.0
    v_mul_f32 v6, v6, v111
    v_mul_f32 v6, s41, v6
    v_exp_f32 v6, v6
    s_nop 0
    v_add_f32 v6, 1.0, v6
    v_rcp_f32 v6, v6
    s_nop 0
    v_mul_f32 v111, v111, v6
    v_mul_f32 v6, v112, v112
    v_fma_f32 v6, v6, s40, 1.0
    v_mul_f32 v6, v6, v112
    v_mul_f32 v6, s41, v6
    v_exp_f32 v6, v6
    s_nop 0
    v_add_f32 v6, 1.0, v6
    v_rcp_f32 v6, v6
    s_nop 0
    v_mul_f32 v112, v112, v6
    v_mul_f32 v6, v113, v113
    v_fma_f32 v6, v6, s40, 1.0
    v_mul_f32 v6, v6, v113
    v_mul_f32 v6, s41, v6
    v_exp_f32 v6, v6
    s_nop 0
    v_add_f32 v6, 1.0, v6
    v_rcp_f32 v6, v6
    s_nop 0
    v_mul_f32 v113, v113, v6
    v_mul_f32 v6, v114, v114
    v_fma_f32 v6, v6, s40, 1.0
    v_mul_f32 v6, v6, v114
    v_mul_f32 v6, s41, v6
    v_exp_f32 v6, v6
    s_nop 0
    v_add_f32 v6, 1.0, v6
    v_rcp_f32 v6, v6
    s_nop 0
    v_mul_f32 v114, v114, v6
    v_mul_f32 v6, v115, v115
    v_fma_f32 v6, v6, s40, 1.0
    v_mul_f32 v6, v6, v115
    v_mul_f32 v6, s41, v6
    v_exp_f32 v6, v6
    s_nop 0
    v_add_f32 v6, 1.0, v6
    v_rcp_f32 v6, v6
    s_nop 0
    v_mul_f32 v115, v115, v6
    v_mul_f32 v6, v116, v116
    v_fma_f32 v6, v6, s40, 1.0
    v_mul_f32 v6, v6, v116
    v_mul_f32 v6, s41, v6
    v_exp_f32 v6, v6
    s_nop 0
    v_add_f32 v6, 1.0, v6
    v_rcp_f32 v6, v6
    s_nop 0
    v_mul_f32 v116, v116, v6
    v_mul_f32 v6, v117, v117
    v_fma_f32 v6, v6, s40, 1.0
    v_mul_f32 v6, v6, v117
    v_mul_f32 v6, s41, v6
    v_exp_f32 v6, v6
    s_nop 0
    v_add_f32 v6, 1.0, v6
    v_rcp_f32 v6, v6
    s_nop 0
    v_mul_f32 v117, v117, v6
    v_mul_f32 v6, v118, v118
    v_fma_f32 v6, v6, s40, 1.0
    v_mul_f32 v6, v6, v118
    v_mul_f32 v6, s41, v6
    v_exp_f32 v6, v6
    s_nop 0
    v_add_f32 v6, 1.0, v6
    v_rcp_f32 v6, v6
    s_nop 0
    v_mul_f32 v118, v118, v6
    v_mul_f32 v6, v119, v119
    v_fma_f32 v6, v6, s40, 1.0
    v_mul_f32 v6, v6, v119
    v_mul_f32 v6, s41, v6
    v_exp_f32 v6, v6
    s_nop 0
    v_add_f32 v6, 1.0, v6
    v_rcp_f32 v6, v6
    s_nop 0
    v_mul_f32 v119, v119, v6
    v_mul_f32 v6, v120, v120
    v_fma_f32 v6, v6, s40, 1.0
    v_mul_f32 v6, v6, v120
    v_mul_f32 v6, s41, v6
    v_exp_f32 v6, v6
    s_nop 0
    v_add_f32 v6, 1.0, v6
    v_rcp_f32 v6, v6
    s_nop 0
    v_mul_f32 v120, v120, v6
    v_mul_f32 v6, v121, v121
    v_fma_f32 v6, v6, s40, 1.0
    v_mul_f32 v6, v6, v121
    v_mul_f32 v6, s41, v6
    v_exp_f32 v6, v6
    s_nop 0
    v_add_f32 v6, 1.0, v6
    v_rcp_f32 v6, v6
    s_nop 0
    v_mul_f32 v121, v121, v6
    v_mul_f32 v6, v122, v122
    v_fma_f32 v6, v6, s40, 1.0
    v_mul_f32 v6, v6, v122
    v_mul_f32 v6, s41, v6
    v_exp_f32 v6, v6
    s_nop 0
    v_add_f32 v6, 1.0, v6
    v_rcp_f32 v6, v6
    s_nop 0
    v_mul_f32 v122, v122, v6
    v_mul_f32 v6, v123, v123
    v_fma_f32 v6, v6, s40, 1.0
    v_mul_f32 v6, v6, v123
    v_mul_f32 v6, s41, v6
    v_exp_f32 v6, v6
    s_nop 0
    v_add_f32 v6, 1.0, v6
    v_rcp_f32 v6, v6
    s_nop 0
    v_mul_f32 v123, v123, v6
    v_mul_f32 v6, v124, v124
    v_fma_f32 v6, v6, s40, 1.0
    v_mul_f32 v6, v6, v124
    v_mul_f32 v6, s41, v6
    v_exp_f32 v6, v6
    s_nop 0
    v_add_f32 v6, 1.0, v6
    v_rcp_f32 v6, v6
    s_nop 0
    v_mul_f32 v124, v124, v6
    v_mul_f32 v6, v125, v125
    v_fma_f32 v6, v6, s40, 1.0
    v_mul_f32 v6, v6, v125
    v_mul_f32 v6, s41, v6
    v_exp_f32 v6, v6
    s_nop 0
    v_add_f32 v6, 1.0, v6
    v_rcp_f32 v6, v6
    s_nop 0
    v_mul_f32 v125, v125, v6
    v_mul_f32 v6, v126, v126
    v_fma_f32 v6, v6, s40, 1.0
    v_mul_f32 v6, v6, v126
    v_mul_f32 v6, s41, v6
    v_exp_f32 v6, v6
    s_nop 0
    v_add_f32 v6, 1.0, v6
    v_rcp_f32 v6, v6
    s_nop 0
    v_mul_f32 v126, v126, v6
    v_mul_f32 v6, v127, v127
    v_fma_f32 v6, v6, s40, 1.0
    v_mul_f32 v6, v6, v127
    v_mul_f32 v6, s41, v6
    v_exp_f32 v6, v6
    s_nop 0
    v_add_f32 v6, 1.0, v6
    v_rcp_f32 v6, v6
    s_nop 0
    v_mul_f32 v127, v127, v6
    v_cvt_pk_bf16_f32 v128, v64, v65
    v_cvt_pk_bf16_f32 v129, v66, v67
    v_cvt_pk_bf16_f32 v130, v68, v69
    v_cvt_pk_bf16_f32 v131, v70, v71
    v_cvt_pk_bf16_f32 v132, v72, v73
    v_cvt_pk_bf16_f32 v133, v74, v75
    v_cvt_pk_bf16_f32 v134, v76, v77
    v_cvt_pk_bf16_f32 v135, v78, v79
    v_cvt_pk_bf16_f32 v136, v80, v81
    v_cvt_pk_bf16_f32 v137, v82, v83
    v_cvt_pk_bf16_f32 v138, v84, v85
    v_cvt_pk_bf16_f32 v139, v86, v87
    v_cvt_pk_bf16_f32 v140, v88, v89
    v_cvt_pk_bf16_f32 v141, v90, v91
    v_cvt_pk_bf16_f32 v142, v92, v93
    v_cvt_pk_bf16_f32 v143, v94, v95
    v_cvt_pk_bf16_f32 v144, v96, v97
    v_cvt_pk_bf16_f32 v145, v98, v99
    v_cvt_pk_bf16_f32 v146, v100, v101
    v_cvt_pk_bf16_f32 v147, v102, v103
    v_cvt_pk_bf16_f32 v148, v104, v105
    v_cvt_pk_bf16_f32 v149, v106, v107
    v_cvt_pk_bf16_f32 v150, v108, v109
    v_cvt_pk_bf16_f32 v151, v110, v111
    v_cvt_pk_bf16_f32 v152, v112, v113
    v_cvt_pk_bf16_f32 v153, v114, v115
    v_cvt_pk_bf16_f32 v154, v116, v117
    v_cvt_pk_bf16_f32 v155, v118, v119
    v_cvt_pk_bf16_f32 v156, v120, v121
    v_cvt_pk_bf16_f32 v157, v122, v123
    v_cvt_pk_bf16_f32 v158, v124, v125
    v_cvt_pk_bf16_f32 v159, v126, v127
    s_mul_i32 s40, s35, 64
    s_add_u32 s40, s40, s33
    s_mul_i32 s41, s29, 64
    s_add_u32 s41, s41, s32
    s_add_u32 s16, s36, 0xe00000
    s_addc_u32 s17, s37, 0
    s_mov_b32 s18, 0x380000
    s_mov_b32 s19, 0x00020000
    s_add_u32 s20, s36, 0x1200000
    s_addc_u32 s21, s37, 0
    s_mov_b32 s22, 0x1c000
    s_mov_b32 s23, 0x00020000
    s_sub_u32 s41, s41, 896
    v_add_u32 v13, s41, v8
    v_lshlrev_b32 v14, 12, v13
    v_lshl_add_u32 v14, v9, 3, v14
    s_lshl_b32 s46, s40, 1
    v_add_u32 v14, s46, v14
    v_add_u32 v6, 0, v14
    buffer_store_dwordx2 v[128:129], v6, s[16:19], 0 offen
    v_add_u32 v6, 16, v14
    buffer_store_dwordx2 v[130:131], v6, s[16:19], 0 offen
    v_add_u32 v6, 32, v14
    buffer_store_dwordx2 v[132:133], v6, s[16:19], 0 offen
    v_add_u32 v6, 48, v14
    buffer_store_dwordx2 v[134:135], v6, s[16:19], 0 offen
    v_add_u32 v6, 64, v14
    buffer_store_dwordx2 v[136:137], v6, s[16:19], 0 offen
    v_add_u32 v6, 80, v14
    buffer_store_dwordx2 v[138:139], v6, s[16:19], 0 offen
    v_add_u32 v6, 96, v14
    buffer_store_dwordx2 v[140:141], v6, s[16:19], 0 offen
    v_add_u32 v6, 112, v14
    buffer_store_dwordx2 v[142:143], v6, s[16:19], 0 offen
    v_add_u32 v6, 131072, v14
    buffer_store_dwordx2 v[144:145], v6, s[16:19], 0 offen
    v_add_u32 v6, 131088, v14
    buffer_store_dwordx2 v[146:147], v6, s[16:19], 0 offen
    v_add_u32 v6, 131104, v14
    buffer_store_dwordx2 v[148:149], v6, s[16:19], 0 offen
    v_add_u32 v6, 131120, v14
    buffer_store_dwordx2 v[150:151], v6, s[16:19], 0 offen
    v_add_u32 v6, 131136, v14
    buffer_store_dwordx2 v[152:153], v6, s[16:19], 0 offen
    v_add_u32 v6, 131152, v14
    buffer_store_dwordx2 v[154:155], v6, s[16:19], 0 offen
    v_add_u32 v6, 131168, v14
    buffer_store_dwordx2 v[156:157], v6, s[16:19], 0 offen
    v_add_u32 v6, 131184, v14
    buffer_store_dwordx2 v[158:159], v6, s[16:19], 0 offen
    s_barrier
    v_mov_b32 v10, 0
    v_lshlrev_b32 v11, 2, v0
    ds_write_b32 v11, v10
    s_waitcnt lgkmcnt(0)
    s_barrier
    s_mul_i32 s46, s35, 512
    v_lshlrev_b32 v11, 5, v9
    v_add_u32 v11, s46, v11
    s_mov_b32 s52, 0x80008000
    s_mov_b32 s53, 0x80008000
    v_mov_b32 v14, 0
    v_mov_b32 v15, 0
    v_lshlrev_b32 v12, 16, v128
    v_add_f32 v14, v14, v12
    v_fmac_f32 v15, v12, v12
    v_lshlrev_b32 v12, 16, v144
    v_add_f32 v14, v14, v12
    v_fmac_f32 v15, v12, v12
    s_nop 1
    v_add_f32_dpp v14, v14, v14 row_shr:1 row_mask:0xf bank_mask:0xf bound_ctrl:0
    v_add_f32_dpp v15, v15, v15 row_shr:1 row_mask:0xf bank_mask:0xf bound_ctrl:0
    s_nop 1
    v_add_f32_dpp v14, v14, v14 row_shr:2 row_mask:0xf bank_mask:0xf bound_ctrl:0
    v_add_f32_dpp v15, v15, v15 row_shr:2 row_mask:0xf bank_mask:0xf bound_ctrl:0
    s_nop 1
    v_add_f32_dpp v14, v14, v14 row_shr:4 row_mask:0xf bank_mask:0xf bound_ctrl:0
    v_add_f32_dpp v15, v15, v15 row_shr:4 row_mask:0xf bank_mask:0xf bound_ctrl:0
    s_nop 1
    v_add_f32_dpp v14, v14, v14 row_shr:8 row_mask:0xf bank_mask:0xf bound_ctrl:0
    v_add_f32_dpp v15, v15, v15 row_shr:8 row_mask:0xf bank_mask:0xf bound_ctrl:0
    s_mov_b64 s[54:55], exec
    s_mov_b64 exec, s[52:53]
    ds_add_f32 v11, v14 offset:0
    ds_add_f32 v11, v15 offset:4
    s_mov_b64 exec, s[54:55]
    v_mov_b32 v14, 0
    v_mov_b32 v15, 0
    v_and_b32 v12, 0xffff0000, v128
    v_add_f32 v14, v14, v12
    v_fmac_f32 v15, v12, v12
    v_and_b32 v12, 0xffff0000, v144
    v_add_f32 v14, v14, v12
    v_fmac_f32 v15, v12, v12
    s_nop 1
    v_add_f32_dpp v14, v14, v14 row_shr:1 row_mask:0xf bank_mask:0xf bound_ctrl:0
    v_add_f32_dpp v15, v15, v15 row_shr:1 row_mask:0xf bank_mask:0xf bound_ctrl:0
    s_nop 1
    v_add_f32_dpp v14, v14, v14 row_shr:2 row_mask:0xf bank_mask:0xf bound_ctrl:0
    v_add_f32_dpp v15, v15, v15 row_shr:2 row_mask:0xf bank_mask:0xf bound_ctrl:0
    s_nop 1
    v_add_f32_dpp v14, v14, v14 row_shr:4 row_mask:0xf bank_mask:0xf bound_ctrl:0
    v_add_f32_dpp v15, v15, v15 row_shr:4 row_mask:0xf bank_mask:0xf bound_ctrl:0
    s_nop 1
    v_add_f32_dpp v14, v14, v14 row_shr:8 row_mask:0xf bank_mask:0xf bound_ctrl:0
    v_add_f32_dpp v15, v15, v15 row_shr:8 row_mask:0xf bank_mask:0xf bound_ctrl:0
    s_mov_b64 s[54:55], exec
    s_mov_b64 exec, s[52:53]
    ds_add_f32 v11, v14 offset:8
    ds_add_f32 v11, v15 offset:12
    s_mov_b64 exec, s[54:55]
    v_mov_b32 v14, 0
    v_mov_b32 v15, 0
    v_lshlrev_b32 v12, 16, v129
    v_add_f32 v14, v14, v12
    v_fmac_f32 v15, v12, v12
    v_lshlrev_b32 v12, 16, v145
    v_add_f32 v14, v14, v12
    v_fmac_f32 v15, v12, v12
    s_nop 1
    v_add_f32_dpp v14, v14, v14 row_shr:1 row_mask:0xf bank_mask:0xf bound_ctrl:0
    v_add_f32_dpp v15, v15, v15 row_shr:1 row_mask:0xf bank_mask:0xf bound_ctrl:0
    s_nop 1
    v_add_f32_dpp v14, v14, v14 row_shr:2 row_mask:0xf bank_mask:0xf bound_ctrl:0
    v_add_f32_dpp v15, v15, v15 row_shr:2 row_mask:0xf bank_mask:0xf bound_ctrl:0
    s_nop 1
    v_add_f32_dpp v14, v14, v14 row_shr:4 row_mask:0xf bank_mask:0xf bound_ctrl:0
    v_add_f32_dpp v15, v15, v15 row_shr:4 row_mask:0xf bank_mask:0xf bound_ctrl:0
    s_nop 1
    v_add_f32_dpp v14, v14, v14 row_shr:8 row_mask:0xf bank_mask:0xf bound_ctrl:0
    v_add_f32_dpp v15, v15, v15 row_shr:8 row_mask:0xf bank_mask:0xf bound_ctrl:0
    s_mov_b64 s[54:55], exec
    s_mov_b64 exec, s[52:53]
    ds_add_f32 v11, v14 offset:16
    ds_add_f32 v11, v15 offset:20
    s_mov_b64 exec, s[54:55]
    v_mov_b32 v14, 0
    v_mov_b32 v15, 0
    v_and_b32 v12, 0xffff0000, v129
    v_add_f32 v14, v14, v12
    v_fmac_f32 v15, v12, v12
    v_and_b32 v12, 0xffff0000, v145
    v_add_f32 v14, v14, v12
    v_fmac_f32 v15, v12, v12
    s_nop 1
    v_add_f32_dpp v14, v14, v14 row_shr:1 row_mask:0xf bank_mask:0xf bound_ctrl:0
    v_add_f32_dpp v15, v15, v15 row_shr:1 row_mask:0xf bank_mask:0xf bound_ctrl:0
    s_nop 1
    v_add_f32_dpp v14, v14, v14 row_shr:2 row_mask:0xf bank_mask:0xf bound_ctrl:0
    v_add_f32_dpp v15, v15, v15 row_shr:2 row_mask:0xf bank_mask:0xf bound_ctrl:0
    s_nop 1
    v_add_f32_dpp v14, v14, v14 row_shr:4 row_mask:0xf bank_mask:0xf bound_ctrl:0
    v_add_f32_dpp v15, v15, v15 row_shr:4 row_mask:0xf bank_mask:0xf bound_ctrl:0
    s_nop 1
    v_add_f32_dpp v14, v14, v14 row_shr:8 row_mask:0xf bank_mask:0xf bound_ctrl:0
    v_add_f32_dpp v15, v15, v15 row_shr:8 row_mask:0xf bank_mask:0xf bound_ctrl:0
    s_mov_b64 s[54:55], exec
    s_mov_b64 exec, s[52:53]
    ds_add_f32 v11, v14 offset:24
    ds_add_f32 v11, v15 offset:28
    s_mov_b64 exec, s[54:55]
    v_mov_b32 v14, 0
    v_mov_b32 v15, 0
    v_lshlrev_b32 v12, 16, v130
    v_add_f32 v14, v14, v12
    v_fmac_f32 v15, v12, v12
    v_lshlrev_b32 v12, 16, v146
    v_add_f32 v14, v14, v12
    v_fmac_f32 v15, v12, v12
    s_nop 1
    v_add_f32_dpp v14, v14, v14 row_shr:1 row_mask:0xf bank_mask:0xf bound_ctrl:0
    v_add_f32_dpp v15, v15, v15 row_shr:1 row_mask:0xf bank_mask:0xf bound_ctrl:0
    s_nop 1
    v_add_f32_dpp v14, v14, v14 row_shr:2 row_mask:0xf bank_mask:0xf bound_ctrl:0
    v_add_f32_dpp v15, v15, v15 row_shr:2 row_mask:0xf bank_mask:0xf bound_ctrl:0
    s_nop 1
    v_add_f32_dpp v14, v14, v14 row_shr:4 row_mask:0xf bank_mask:0xf bound_ctrl:0
    v_add_f32_dpp v15, v15, v15 row_shr:4 row_mask:0xf bank_mask:0xf bound_ctrl:0
    s_nop 1
    v_add_f32_dpp v14, v14, v14 row_shr:8 row_mask:0xf bank_mask:0xf bound_ctrl:0
    v_add_f32_dpp v15, v15, v15 row_shr:8 row_mask:0xf bank_mask:0xf bound_ctrl:0
    s_mov_b64 s[54:55], exec
    s_mov_b64 exec, s[52:53]
    ds_add_f32 v11, v14 offset:64
    ds_add_f32 v11, v15 offset:68
    s_mov_b64 exec, s[54:55]
    v_mov_b32 v14, 0
    v_mov_b32 v15, 0
    v_and_b32 v12, 0xffff0000, v130
    v_add_f32 v14, v14, v12
    v_fmac_f32 v15, v12, v12
    v_and_b32 v12, 0xffff0000, v146
    v_add_f32 v14, v14, v12
    v_fmac_f32 v15, v12, v12
    s_nop 1
    v_add_f32_dpp v14, v14, v14 row_shr:1 row_mask:0xf bank_mask:0xf bound_ctrl:0
    v_add_f32_dpp v15, v15, v15 row_shr:1 row_mask:0xf bank_mask:0xf bound_ctrl:0
    s_nop 1
    v_add_f32_dpp v14, v14, v14 row_shr:2 row_mask:0xf bank_mask:0xf bound_ctrl:0
    v_add_f32_dpp v15, v15, v15 row_shr:2 row_mask:0xf bank_mask:0xf bound_ctrl:0
    s_nop 1
    v_add_f32_dpp v14, v14, v14 row_shr:4 row_mask:0xf bank_mask:0xf bound_ctrl:0
    v_add_f32_dpp v15, v15, v15 row_shr:4 row_mask:0xf bank_mask:0xf bound_ctrl:0
    s_nop 1
    v_add_f32_dpp v14, v14, v14 row_shr:8 row_mask:0xf bank_mask:0xf bound_ctrl:0
    v_add_f32_dpp v15, v15, v15 row_shr:8 row_mask:0xf bank_mask:0xf bound_ctrl:0
    s_mov_b64 s[54:55], exec
    s_mov_b64 exec, s[52:53]
    ds_add_f32 v11, v14 offset:72
    ds_add_f32 v11, v15 offset:76
    s_mov_b64 exec, s[54:55]
    v_mov_b32 v14, 0
    v_mov_b32 v15, 0
    v_lshlrev_b32 v12, 16, v131
    v_add_f32 v14, v14, v12
    v_fmac_f32 v15, v12, v12
    v_lshlrev_b32 v12, 16, v147
    v_add_f32 v14, v14, v12
    v_fmac_f32 v15, v12, v12
    s_nop 1
    v_add_f32_dpp v14, v14, v14 row_shr:1 row_mask:0xf bank_mask:0xf bound_ctrl:0
    v_add_f32_dpp v15, v15, v15 row_shr:1 row_mask:0xf bank_mask:0xf bound_ctrl:0
    s_nop 1
    v_add_f32_dpp v14, v14, v14 row_shr:2 row_mask:0xf bank_mask:0xf bound_ctrl:0
    v_add_f32_dpp v15, v15, v15 row_shr:2 row_mask:0xf bank_mask:0xf bound_ctrl:0
    s_nop 1
    v_add_f32_dpp v14, v14, v14 row_shr:4 row_mask:0xf bank_mask:0xf bound_ctrl:0
    v_add_f32_dpp v15, v15, v15 row_shr:4 row_mask:0xf bank_mask:0xf bound_ctrl:0
    s_nop 1
    v_add_f32_dpp v14, v14, v14 row_shr:8 row_mask:0xf bank_mask:0xf bound_ctrl:0
    v_add_f32_dpp v15, v15, v15 row_shr:8 row_mask:0xf bank_mask:0xf bound_ctrl:0
    s_mov_b64 s[54:55], exec
    s_mov_b64 exec, s[52:53]
    ds_add_f32 v11, v14 offset:80
    ds_add_f32 v11, v15 offset:84
    s_mov_b64 exec, s[54:55]
    v_mov_b32 v14, 0
    v_mov_b32 v15, 0
    v_and_b32 v12, 0xffff0000, v131
    v_add_f32 v14, v14, v12
    v_fmac_f32 v15, v12, v12
    v_and_b32 v12, 0xffff0000, v147
    v_add_f32 v14, v14, v12
    v_fmac_f32 v15, v12, v12
    s_nop 1
    v_add_f32_dpp v14, v14, v14 row_shr:1 row_mask:0xf bank_mask:0xf bound_ctrl:0
    v_add_f32_dpp v15, v15, v15 row_shr:1 row_mask:0xf bank_mask:0xf bound_ctrl:0
    s_nop 1
    v_add_f32_dpp v14, v14, v14 row_shr:2 row_mask:0xf bank_mask:0xf bound_ctrl:0
    v_add_f32_dpp v15, v15, v15 row_shr:2 row_mask:0xf bank_mask:0xf bound_ctrl:0
    s_nop 1
    v_add_f32_dpp v14, v14, v14 row_shr:4 row_mask:0xf bank_mask:0xf bound_ctrl:0
    v_add_f32_dpp v15, v15, v15 row_shr:4 row_mask:0xf bank_mask:0xf bound_ctrl:0
    s_nop 1
    v_add_f32_dpp v14, v14, v14 row_shr:8 row_mask:0xf bank_mask:0xf bound_ctrl:0
    v_add_f32_dpp v15, v15, v15 row_shr:8 row_mask:0xf bank_mask:0xf bound_ctrl:0
    s_mov_b64 s[54:55], exec
    s_mov_b64 exec, s[52:53]
    ds_add_f32 v11, v14 offset:88
    ds_add_f32 v11, v15 offset:92
    s_mov_b64 exec, s[54:55]
    v_mov_b32 v14, 0
    v_mov_b32 v15, 0
    v_lshlrev_b32 v12, 16, v132
    v_add_f32 v14, v14, v12
    v_fmac_f32 v15, v12, v12
    v_lshlrev_b32 v12, 16, v148
    v_add_f32 v14, v14, v12
    v_fmac_f32 v15, v12, v12
    s_nop 1
    v_add_f32_dpp v14, v14, v14 row_shr:1 row_mask:0xf bank_mask:0xf bound_ctrl:0
    v_add_f32_dpp v15, v15, v15 row_shr:1 row_mask:0xf bank_mask:0xf bound_ctrl:0
    s_nop 1
    v_add_f32_dpp v14, v14, v14 row_shr:2 row_mask:0xf bank_mask:0xf bound_ctrl:0
    v_add_f32_dpp v15, v15, v15 row_shr:2 row_mask:0xf bank_mask:0xf bound_ctrl:0
    s_nop 1
    v_add_f32_dpp v14, v14, v14 row_shr:4 row_mask:0xf bank_mask:0xf bound_ctrl:0
    v_add_f32_dpp v15, v15, v15 row_shr:4 row_mask:0xf bank_mask:0xf bound_ctrl:0
    s_nop 1
    v_add_f32_dpp v14, v14, v14 row_shr:8 row_mask:0xf bank_mask:0xf bound_ctrl:0
    v_add_f32_dpp v15, v15, v15 row_shr:8 row_mask:0xf bank_mask:0xf bound_ctrl:0
    s_mov_b64 s[54:55], exec
    s_mov_b64 exec, s[52:53]
    ds_add_f32 v11, v14 offset:128
    ds_add_f32 v11, v15 offset:132
    s_mov_b64 exec, s[54:55]
    v_mov_b32 v14, 0
    v_mov_b32 v15, 0
    v_and_b32 v12, 0xffff0000, v132
    v_add_f32 v14, v14, v12
    v_fmac_f32 v15, v12, v12
    v_and_b32 v12, 0xffff0000, v148
    v_add_f32 v14, v14, v12
    v_fmac_f32 v15, v12, v12
    s_nop 1
    v_add_f32_dpp v14, v14, v14 row_shr:1 row_mask:0xf bank_mask:0xf bound_ctrl:0
    v_add_f32_dpp v15, v15, v15 row_shr:1 row_mask:0xf bank_mask:0xf bound_ctrl:0
    s_nop 1
    v_add_f32_dpp v14, v14, v14 row_shr:2 row_mask:0xf bank_mask:0xf bound_ctrl:0
    v_add_f32_dpp v15, v15, v15 row_shr:2 row_mask:0xf bank_mask:0xf bound_ctrl:0
    s_nop 1
    v_add_f32_dpp v14, v14, v14 row_shr:4 row_mask:0xf bank_mask:0xf bound_ctrl:0
    v_add_f32_dpp v15, v15, v15 row_shr:4 row_mask:0xf bank_mask:0xf bound_ctrl:0
    s_nop 1
    v_add_f32_dpp v14, v14, v14 row_shr:8 row_mask:0xf bank_mask:0xf bound_ctrl:0
    v_add_f32_dpp v15, v15, v15 row_shr:8 row_mask:0xf bank_mask:0xf bound_ctrl:0
    s_mov_b64 s[54:55], exec
    s_mov_b64 exec, s[52:53]
    ds_add_f32 v11, v14 offset:136
    ds_add_f32 v11, v15 offset:140
    s_mov_b64 exec, s[54:55]
    v_mov_b32 v14, 0
    v_mov_b32 v15, 0
    v_lshlrev_b32 v12, 16, v133
    v_add_f32 v14, v14, v12
    v_fmac_f32 v15, v12, v12
    v_lshlrev_b32 v12, 16, v149
    v_add_f32 v14, v14, v12
    v_fmac_f32 v15, v12, v12
    s_nop 1
    v_add_f32_dpp v14, v14, v14 row_shr:1 row_mask:0xf bank_mask:0xf bound_ctrl:0
    v_add_f32_dpp v15, v15, v15 row_shr:1 row_mask:0xf bank_mask:0xf bound_ctrl:0
    s_nop 1
    v_add_f32_dpp v14, v14, v14 row_shr:2 row_mask:0xf bank_mask:0xf bound_ctrl:0
    v_add_f32_dpp v15, v15, v15 row_shr:2 row_mask:0xf bank_mask:0xf bound_ctrl:0
    s_nop 1
    v_add_f32_dpp v14, v14, v14 row_shr:4 row_mask:0xf bank_mask:0xf bound_ctrl:0
    v_add_f32_dpp v15, v15, v15 row_shr:4 row_mask:0xf bank_mask:0xf bound_ctrl:0
    s_nop 1
    v_add_f32_dpp v14, v14, v14 row_shr:8 row_mask:0xf bank_mask:0xf bound_ctrl:0
    v_add_f32_dpp v15, v15, v15 row_shr:8 row_mask:0xf bank_mask:0xf bound_ctrl:0
    s_mov_b64 s[54:55], exec
    s_mov_b64 exec, s[52:53]
    ds_add_f32 v11, v14 offset:144
    ds_add_f32 v11, v15 offset:148
    s_mov_b64 exec, s[54:55]
    v_mov_b32 v14, 0
    v_mov_b32 v15, 0
    v_and_b32 v12, 0xffff0000, v133
    v_add_f32 v14, v14, v12
    v_fmac_f32 v15, v12, v12
    v_and_b32 v12, 0xffff0000, v149
    v_add_f32 v14, v14, v12
    v_fmac_f32 v15, v12, v12
    s_nop 1
    v_add_f32_dpp v14, v14, v14 row_shr:1 row_mask:0xf bank_mask:0xf bound_ctrl:0
    v_add_f32_dpp v15, v15, v15 row_shr:1 row_mask:0xf bank_mask:0xf bound_ctrl:0
    s_nop 1
    v_add_f32_dpp v14, v14, v14 row_shr:2 row_mask:0xf bank_mask:0xf bound_ctrl:0
    v_add_f32_dpp v15, v15, v15 row_shr:2 row_mask:0xf bank_mask:0xf bound_ctrl:0
    s_nop 1
    v_add_f32_dpp v14, v14, v14 row_shr:4 row_mask:0xf bank_mask:0xf bound_ctrl:0
    v_add_f32_dpp v15, v15, v15 row_shr:4 row_mask:0xf bank_mask:0xf bound_ctrl:0
    s_nop 1
    v_add_f32_dpp v14, v14, v14 row_shr:8 row_mask:0xf bank_mask:0xf bound_ctrl:0
    v_add_f32_dpp v15, v15, v15 row_shr:8 row_mask:0xf bank_mask:0xf bound_ctrl:0
    s_mov_b64 s[54:55], exec
    s_mov_b64 exec, s[52:53]
    ds_add_f32 v11, v14 offset:152
    ds_add_f32 v11, v15 offset:156
    s_mov_b64 exec, s[54:55]
    v_mov_b32 v14, 0
    v_mov_b32 v15, 0
    v_lshlrev_b32 v12, 16, v134
    v_add_f32 v14, v14, v12
    v_fmac_f32 v15, v12, v12
    v_lshlrev_b32 v12, 16, v150
    v_add_f32 v14, v14, v12
    v_fmac_f32 v15, v12, v12
    s_nop 1
    v_add_f32_dpp v14, v14, v14 row_shr:1 row_mask:0xf bank_mask:0xf bound_ctrl:0
    v_add_f32_dpp v15, v15, v15 row_shr:1 row_mask:0xf bank_mask:0xf bound_ctrl:0
    s_nop 1
    v_add_f32_dpp v14, v14, v14 row_shr:2 row_mask:0xf bank_mask:0xf bound_ctrl:0
    v_add_f32_dpp v15, v15, v15 row_shr:2 row_mask:0xf bank_mask:0xf bound_ctrl:0
    s_nop 1
    v_add_f32_dpp v14, v14, v14 row_shr:4 row_mask:0xf bank_mask:0xf bound_ctrl:0
    v_add_f32_dpp v15, v15, v15 row_shr:4 row_mask:0xf bank_mask:0xf bound_ctrl:0
    s_nop 1
    v_add_f32_dpp v14, v14, v14 row_shr:8 row_mask:0xf bank_mask:0xf bound_ctrl:0
    v_add_f32_dpp v15, v15, v15 row_shr:8 row_mask:0xf bank_mask:0xf bound_ctrl:0
    s_mov_b64 s[54:55], exec
    s_mov_b64 exec, s[52:53]
    ds_add_f32 v11, v14 offset:192
    ds_add_f32 v11, v15 offset:196
    s_mov_b64 exec, s[54:55]
    v_mov_b32 v14, 0
    v_mov_b32 v15, 0
    v_and_b32 v12, 0xffff0000, v134
    v_add_f32 v14, v14, v12
    v_fmac_f32 v15, v12, v12
    v_and_b32 v12, 0xffff0000, v150
    v_add_f32 v14, v14, v12
    v_fmac_f32 v15, v12, v12
    s_nop 1
    v_add_f32_dpp v14, v14, v14 row_shr:1 row_mask:0xf bank_mask:0xf bound_ctrl:0
    v_add_f32_dpp v15, v15, v15 row_shr:1 row_mask:0xf bank_mask:0xf bound_ctrl:0
    s_nop 1
    v_add_f32_dpp v14, v14, v14 row_shr:2 row_mask:0xf bank_mask:0xf bound_ctrl:0
    v_add_f32_dpp v15, v15, v15 row_shr:2 row_mask:0xf bank_mask:0xf bound_ctrl:0
    s_nop 1
    v_add_f32_dpp v14, v14, v14 row_shr:4 row_mask:0xf bank_mask:0xf bound_ctrl:0
    v_add_f32_dpp v15, v15, v15 row_shr:4 row_mask:0xf bank_mask:0xf bound_ctrl:0
    s_nop 1
    v_add_f32_dpp v14, v14, v14 row_shr:8 row_mask:0xf bank_mask:0xf bound_ctrl:0
    v_add_f32_dpp v15, v15, v15 row_shr:8 row_mask:0xf bank_mask:0xf bound_ctrl:0
    s_mov_b64 s[54:55], exec
    s_mov_b64 exec, s[52:53]
    ds_add_f32 v11, v14 offset:200
    ds_add_f32 v11, v15 offset:204
    s_mov_b64 exec, s[54:55]
    v_mov_b32 v14, 0
    v_mov_b32 v15, 0
    v_lshlrev_b32 v12, 16, v135
    v_add_f32 v14, v14, v12
    v_fmac_f32 v15, v12, v12
    v_lshlrev_b32 v12, 16, v151
    v_add_f32 v14, v14, v12
    v_fmac_f32 v15, v12, v12
    s_nop 1
    v_add_f32_dpp v14, v14, v14 row_shr:1 row_mask:0xf bank_mask:0xf bound_ctrl:0
    v_add_f32_dpp v15, v15, v15 row_shr:1 row_mask:0xf bank_mask:0xf bound_ctrl:0
    s_nop 1
    v_add_f32_dpp v14, v14, v14 row_shr:2 row_mask:0xf bank_mask:0xf bound_ctrl:0
    v_add_f32_dpp v15, v15, v15 row_shr:2 row_mask:0xf bank_mask:0xf bound_ctrl:0
    s_nop 1
    v_add_f32_dpp v14, v14, v14 row_shr:4 row_mask:0xf bank_mask:0xf bound_ctrl:0
    v_add_f32_dpp v15, v15, v15 row_shr:4 row_mask:0xf bank_mask:0xf bound_ctrl:0
    s_nop 1
    v_add_f32_dpp v14, v14, v14 row_shr:8 row_mask:0xf bank_mask:0xf bound_ctrl:0
    v_add_f32_dpp v15, v15, v15 row_shr:8 row_mask:0xf bank_mask:0xf bound_ctrl:0
    s_mov_b64 s[54:55], exec
    s_mov_b64 exec, s[52:53]
    ds_add_f32 v11, v14 offset:208
    ds_add_f32 v11, v15 offset:212
    s_mov_b64 exec, s[54:55]
    v_mov_b32 v14, 0
    v_mov_b32 v15, 0
    v_and_b32 v12, 0xffff0000, v135
    v_add_f32 v14, v14, v12
    v_fmac_f32 v15, v12, v12
    v_and_b32 v12, 0xffff0000, v151
    v_add_f32 v14, v14, v12
    v_fmac_f32 v15, v12, v12
    s_nop 1
    v_add_f32_dpp v14, v14, v14 row_shr:1 row_mask:0xf bank_mask:0xf bound_ctrl:0
    v_add_f32_dpp v15, v15, v15 row_shr:1 row_mask:0xf bank_mask:0xf bound_ctrl:0
    s_nop 1
    v_add_f32_dpp v14, v14, v14 row_shr:2 row_mask:0xf bank_mask:0xf bound_ctrl:0
    v_add_f32_dpp v15, v15, v15 row_shr:2 row_mask:0xf bank_mask:0xf bound_ctrl:0
    s_nop 1
    v_add_f32_dpp v14, v14, v14 row_shr:4 row_mask:0xf bank_mask:0xf bound_ctrl:0
    v_add_f32_dpp v15, v15, v15 row_shr:4 row_mask:0xf bank_mask:0xf bound_ctrl:0
    s_nop 1
    v_add_f32_dpp v14, v14, v14 row_shr:8 row_mask:0xf bank_mask:0xf bound_ctrl:0
    v_add_f32_dpp v15, v15, v15 row_shr:8 row_mask:0xf bank_mask:0xf bound_ctrl:0
    s_mov_b64 s[54:55], exec
    s_mov_b64 exec, s[52:53]
    ds_add_f32 v11, v14 offset:216
    ds_add_f32 v11, v15 offset:220
    s_mov_b64 exec, s[54:55]
    v_mov_b32 v14, 0
    v_mov_b32 v15, 0
    v_lshlrev_b32 v12, 16, v136
    v_add_f32 v14, v14, v12
    v_fmac_f32 v15, v12, v12
    v_lshlrev_b32 v12, 16, v152
    v_add_f32 v14, v14, v12
    v_fmac_f32 v15, v12, v12
    s_nop 1
    v_add_f32_dpp v14, v14, v14 row_shr:1 row_mask:0xf bank_mask:0xf bound_ctrl:0
    v_add_f32_dpp v15, v15, v15 row_shr:1 row_mask:0xf bank_mask:0xf bound_ctrl:0
    s_nop 1
    v_add_f32_dpp v14, v14, v14 row_shr:2 row_mask:0xf bank_mask:0xf bound_ctrl:0
    v_add_f32_dpp v15, v15, v15 row_shr:2 row_mask:0xf bank_mask:0xf bound_ctrl:0
    s_nop 1
    v_add_f32_dpp v14, v14, v14 row_shr:4 row_mask:0xf bank_mask:0xf bound_ctrl:0
    v_add_f32_dpp v15, v15, v15 row_shr:4 row_mask:0xf bank_mask:0xf bound_ctrl:0
    s_nop 1
    v_add_f32_dpp v14, v14, v14 row_shr:8 row_mask:0xf bank_mask:0xf bound_ctrl:0
    v_add_f32_dpp v15, v15, v15 row_shr:8 row_mask:0xf bank_mask:0xf bound_ctrl:0
    s_mov_b64 s[54:55], exec
    s_mov_b64 exec, s[52:53]
    ds_add_f32 v11, v14 offset:256
    ds_add_f32 v11, v15 offset:260
    s_mov_b64 exec, s[54:55]
    v_mov_b32 v14, 0
    v_mov_b32 v15, 0
    v_and_b32 v12, 0xffff0000, v136
    v_add_f32 v14, v14, v12
    v_fmac_f32 v15, v12, v12
    v_and_b32 v12, 0xffff0000, v152
    v_add_f32 v14, v14, v12
    v_fmac_f32 v15, v12, v12
    s_nop 1
    v_add_f32_dpp v14, v14, v14 row_shr:1 row_mask:0xf bank_mask:0xf bound_ctrl:0
    v_add_f32_dpp v15, v15, v15 row_shr:1 row_mask:0xf bank_mask:0xf bound_ctrl:0
    s_nop 1
    v_add_f32_dpp v14, v14, v14 row_shr:2 row_mask:0xf bank_mask:0xf bound_ctrl:0
    v_add_f32_dpp v15, v15, v15 row_shr:2 row_mask:0xf bank_mask:0xf bound_ctrl:0
    s_nop 1
    v_add_f32_dpp v14, v14, v14 row_shr:4 row_mask:0xf bank_mask:0xf bound_ctrl:0
    v_add_f32_dpp v15, v15, v15 row_shr:4 row_mask:0xf bank_mask:0xf bound_ctrl:0
    s_nop 1
    v_add_f32_dpp v14, v14, v14 row_shr:8 row_mask:0xf bank_mask:0xf bound_ctrl:0
    v_add_f32_dpp v15, v15, v15 row_shr:8 row_mask:0xf bank_mask:0xf bound_ctrl:0
    s_mov_b64 s[54:55], exec
    s_mov_b64 exec, s[52:53]
    ds_add_f32 v11, v14 offset:264
    ds_add_f32 v11, v15 offset:268
    s_mov_b64 exec, s[54:55]
    v_mov_b32 v14, 0
    v_mov_b32 v15, 0
    v_lshlrev_b32 v12, 16, v137
    v_add_f32 v14, v14, v12
    v_fmac_f32 v15, v12, v12
    v_lshlrev_b32 v12, 16, v153
    v_add_f32 v14, v14, v12
    v_fmac_f32 v15, v12, v12
    s_nop 1
    v_add_f32_dpp v14, v14, v14 row_shr:1 row_mask:0xf bank_mask:0xf bound_ctrl:0
    v_add_f32_dpp v15, v15, v15 row_shr:1 row_mask:0xf bank_mask:0xf bound_ctrl:0
    s_nop 1
    v_add_f32_dpp v14, v14, v14 row_shr:2 row_mask:0xf bank_mask:0xf bound_ctrl:0
    v_add_f32_dpp v15, v15, v15 row_shr:2 row_mask:0xf bank_mask:0xf bound_ctrl:0
    s_nop 1
    v_add_f32_dpp v14, v14, v14 row_shr:4 row_mask:0xf bank_mask:0xf bound_ctrl:0
    v_add_f32_dpp v15, v15, v15 row_shr:4 row_mask:0xf bank_mask:0xf bound_ctrl:0
    s_nop 1
    v_add_f32_dpp v14, v14, v14 row_shr:8 row_mask:0xf bank_mask:0xf bound_ctrl:0
    v_add_f32_dpp v15, v15, v15 row_shr:8 row_mask:0xf bank_mask:0xf bound_ctrl:0
    s_mov_b64 s[54:55], exec
    s_mov_b64 exec, s[52:53]
    ds_add_f32 v11, v14 offset:272
    ds_add_f32 v11, v15 offset:276
    s_mov_b64 exec, s[54:55]
    v_mov_b32 v14, 0
    v_mov_b32 v15, 0
    v_and_b32 v12, 0xffff0000, v137
    v_add_f32 v14, v14, v12
    v_fmac_f32 v15, v12, v12
    v_and_b32 v12, 0xffff0000, v153
    v_add_f32 v14, v14, v12
    v_fmac_f32 v15, v12, v12
    s_nop 1
    v_add_f32_dpp v14, v14, v14 row_shr:1 row_mask:0xf bank_mask:0xf bound_ctrl:0
    v_add_f32_dpp v15, v15, v15 row_shr:1 row_mask:0xf bank_mask:0xf bound_ctrl:0
    s_nop 1
    v_add_f32_dpp v14, v14, v14 row_shr:2 row_mask:0xf bank_mask:0xf bound_ctrl:0
    v_add_f32_dpp v15, v15, v15 row_shr:2 row_mask:0xf bank_mask:0xf bound_ctrl:0
    s_nop 1
    v_add_f32_dpp v14, v14, v14 row_shr:4 row_mask:0xf bank_mask:0xf bound_ctrl:0
    v_add_f32_dpp v15, v15, v15 row_shr:4 row_mask:0xf bank_mask:0xf bound_ctrl:0
    s_nop 1
    v_add_f32_dpp v14, v14, v14 row_shr:8 row_mask:0xf bank_mask:0xf bound_ctrl:0
    v_add_f32_dpp v15, v15, v15 row_shr:8 row_mask:0xf bank_mask:0xf bound_ctrl:0
    s_mov_b64 s[54:55], exec
    s_mov_b64 exec, s[52:53]
    ds_add_f32 v11, v14 offset:280
    ds_add_f32 v11, v15 offset:284
    s_mov_b64 exec, s[54:55]
    v_mov_b32 v14, 0
    v_mov_b32 v15, 0
    v_lshlrev_b32 v12, 16, v138
    v_add_f32 v14, v14, v12
    v_fmac_f32 v15, v12, v12
    v_lshlrev_b32 v12, 16, v154
    v_add_f32 v14, v14, v12
    v_fmac_f32 v15, v12, v12
    s_nop 1
    v_add_f32_dpp v14, v14, v14 row_shr:1 row_mask:0xf bank_mask:0xf bound_ctrl:0
    v_add_f32_dpp v15, v15, v15 row_shr:1 row_mask:0xf bank_mask:0xf bound_ctrl:0
    s_nop 1
    v_add_f32_dpp v14, v14, v14 row_shr:2 row_mask:0xf bank_mask:0xf bound_ctrl:0
    v_add_f32_dpp v15, v15, v15 row_shr:2 row_mask:0xf bank_mask:0xf bound_ctrl:0
    s_nop 1
    v_add_f32_dpp v14, v14, v14 row_shr:4 row_mask:0xf bank_mask:0xf bound_ctrl:0
    v_add_f32_dpp v15, v15, v15 row_shr:4 row_mask:0xf bank_mask:0xf bound_ctrl:0
    s_nop 1
    v_add_f32_dpp v14, v14, v14 row_shr:8 row_mask:0xf bank_mask:0xf bound_ctrl:0
    v_add_f32_dpp v15, v15, v15 row_shr:8 row_mask:0xf bank_mask:0xf bound_ctrl:0
    s_mov_b64 s[54:55], exec
    s_mov_b64 exec, s[52:53]
    ds_add_f32 v11, v14 offset:320
    ds_add_f32 v11, v15 offset:324
    s_mov_b64 exec, s[54:55]
    v_mov_b32 v14, 0
    v_mov_b32 v15, 0
    v_and_b32 v12, 0xffff0000, v138
    v_add_f32 v14, v14, v12
    v_fmac_f32 v15, v12, v12
    v_and_b32 v12, 0xffff0000, v154
    v_add_f32 v14, v14, v12
    v_fmac_f32 v15, v12, v12
    s_nop 1
    v_add_f32_dpp v14, v14, v14 row_shr:1 row_mask:0xf bank_mask:0xf bound_ctrl:0
    v_add_f32_dpp v15, v15, v15 row_shr:1 row_mask:0xf bank_mask:0xf bound_ctrl:0
    s_nop 1
    v_add_f32_dpp v14, v14, v14 row_shr:2 row_mask:0xf bank_mask:0xf bound_ctrl:0
    v_add_f32_dpp v15, v15, v15 row_shr:2 row_mask:0xf bank_mask:0xf bound_ctrl:0
    s_nop 1
    v_add_f32_dpp v14, v14, v14 row_shr:4 row_mask:0xf bank_mask:0xf bound_ctrl:0
    v_add_f32_dpp v15, v15, v15 row_shr:4 row_mask:0xf bank_mask:0xf bound_ctrl:0
    s_nop 1
    v_add_f32_dpp v14, v14, v14 row_shr:8 row_mask:0xf bank_mask:0xf bound_ctrl:0
    v_add_f32_dpp v15, v15, v15 row_shr:8 row_mask:0xf bank_mask:0xf bound_ctrl:0
    s_mov_b64 s[54:55], exec
    s_mov_b64 exec, s[52:53]
    ds_add_f32 v11, v14 offset:328
    ds_add_f32 v11, v15 offset:332
    s_mov_b64 exec, s[54:55]
    v_mov_b32 v14, 0
    v_mov_b32 v15, 0
    v_lshlrev_b32 v12, 16, v139
    v_add_f32 v14, v14, v12
    v_fmac_f32 v15, v12, v12
    v_lshlrev_b32 v12, 16, v155
    v_add_f32 v14, v14, v12
    v_fmac_f32 v15, v12, v12
    s_nop 1
    v_add_f32_dpp v14, v14, v14 row_shr:1 row_mask:0xf bank_mask:0xf bound_ctrl:0
    v_add_f32_dpp v15, v15, v15 row_shr:1 row_mask:0xf bank_mask:0xf bound_ctrl:0
    s_nop 1
    v_add_f32_dpp v14, v14, v14 row_shr:2 row_mask:0xf bank_mask:0xf bound_ctrl:0
    v_add_f32_dpp v15, v15, v15 row_shr:2 row_mask:0xf bank_mask:0xf bound_ctrl:0
    s_nop 1
    v_add_f32_dpp v14, v14, v14 row_shr:4 row_mask:0xf bank_mask:0xf bound_ctrl:0
    v_add_f32_dpp v15, v15, v15 row_shr:4 row_mask:0xf bank_mask:0xf bound_ctrl:0
    s_nop 1
    v_add_f32_dpp v14, v14, v14 row_shr:8 row_mask:0xf bank_mask:0xf bound_ctrl:0
    v_add_f32_dpp v15, v15, v15 row_shr:8 row_mask:0xf bank_mask:0xf bound_ctrl:0
    s_mov_b64 s[54:55], exec
    s_mov_b64 exec, s[52:53]
    ds_add_f32 v11, v14 offset:336
    ds_add_f32 v11, v15 offset:340
    s_mov_b64 exec, s[54:55]
    v_mov_b32 v14, 0
    v_mov_b32 v15, 0
    v_and_b32 v12, 0xffff0000, v139
    v_add_f32 v14, v14, v12
    v_fmac_f32 v15, v12, v12
    v_and_b32 v12, 0xffff0000, v155
    v_add_f32 v14, v14, v12
    v_fmac_f32 v15, v12, v12
    s_nop 1
    v_add_f32_dpp v14, v14, v14 row_shr:1 row_mask:0xf bank_mask:0xf bound_ctrl:0
    v_add_f32_dpp v15, v15, v15 row_shr:1 row_mask:0xf bank_mask:0xf bound_ctrl:0
    s_nop 1
    v_add_f32_dpp v14, v14, v14 row_shr:2 row_mask:0xf bank_mask:0xf bound_ctrl:0
    v_add_f32_dpp v15, v15, v15 row_shr:2 row_mask:0xf bank_mask:0xf bound_ctrl:0
    s_nop 1
    v_add_f32_dpp v14, v14, v14 row_shr:4 row_mask:0xf bank_mask:0xf bound_ctrl:0
    v_add_f32_dpp v15, v15, v15 row_shr:4 row_mask:0xf bank_mask:0xf bound_ctrl:0
    s_nop 1
    v_add_f32_dpp v14, v14, v14 row_shr:8 row_mask:0xf bank_mask:0xf bound_ctrl:0
    v_add_f32_dpp v15, v15, v15 row_shr:8 row_mask:0xf bank_mask:0xf bound_ctrl:0
    s_mov_b64 s[54:55], exec
    s_mov_b64 exec, s[52:53]
    ds_add_f32 v11, v14 offset:344
    ds_add_f32 v11, v15 offset:348
    s_mov_b64 exec, s[54:55]
    v_mov_b32 v14, 0
    v_mov_b32 v15, 0
    v_lshlrev_b32 v12, 16, v140
    v_add_f32 v14, v14, v12
    v_fmac_f32 v15, v12, v12
    v_lshlrev_b32 v12, 16, v156
    v_add_f32 v14, v14, v12
    v_fmac_f32 v15, v12, v12
    s_nop 1
    v_add_f32_dpp v14, v14, v14 row_shr:1 row_mask:0xf bank_mask:0xf bound_ctrl:0
    v_add_f32_dpp v15, v15, v15 row_shr:1 row_mask:0xf bank_mask:0xf bound_ctrl:0
    s_nop 1
    v_add_f32_dpp v14, v14, v14 row_shr:2 row_mask:0xf bank_mask:0xf bound_ctrl:0
    v_add_f32_dpp v15, v15, v15 row_shr:2 row_mask:0xf bank_mask:0xf bound_ctrl:0
    s_nop 1
    v_add_f32_dpp v14, v14, v14 row_shr:4 row_mask:0xf bank_mask:0xf bound_ctrl:0
    v_add_f32_dpp v15, v15, v15 row_shr:4 row_mask:0xf bank_mask:0xf bound_ctrl:0
    s_nop 1
    v_add_f32_dpp v14, v14, v14 row_shr:8 row_mask:0xf bank_mask:0xf bound_ctrl:0
    v_add_f32_dpp v15, v15, v15 row_shr:8 row_mask:0xf bank_mask:0xf bound_ctrl:0
    s_mov_b64 s[54:55], exec
    s_mov_b64 exec, s[52:53]
    ds_add_f32 v11, v14 offset:384
    ds_add_f32 v11, v15 offset:388
    s_mov_b64 exec, s[54:55]
    v_mov_b32 v14, 0
    v_mov_b32 v15, 0
    v_and_b32 v12, 0xffff0000, v140
    v_add_f32 v14, v14, v12
    v_fmac_f32 v15, v12, v12
    v_and_b32 v12, 0xffff0000, v156
    v_add_f32 v14, v14, v12
    v_fmac_f32 v15, v12, v12
    s_nop 1
    v_add_f32_dpp v14, v14, v14 row_shr:1 row_mask:0xf bank_mask:0xf bound_ctrl:0
    v_add_f32_dpp v15, v15, v15 row_shr:1 row_mask:0xf bank_mask:0xf bound_ctrl:0
    s_nop 1
    v_add_f32_dpp v14, v14, v14 row_shr:2 row_mask:0xf bank_mask:0xf bound_ctrl:0
    v_add_f32_dpp v15, v15, v15 row_shr:2 row_mask:0xf bank_mask:0xf bound_ctrl:0
    s_nop 1
    v_add_f32_dpp v14, v14, v14 row_shr:4 row_mask:0xf bank_mask:0xf bound_ctrl:0
    v_add_f32_dpp v15, v15, v15 row_shr:4 row_mask:0xf bank_mask:0xf bound_ctrl:0
    s_nop 1
    v_add_f32_dpp v14, v14, v14 row_shr:8 row_mask:0xf bank_mask:0xf bound_ctrl:0
    v_add_f32_dpp v15, v15, v15 row_shr:8 row_mask:0xf bank_mask:0xf bound_ctrl:0
    s_mov_b64 s[54:55], exec
    s_mov_b64 exec, s[52:53]
    ds_add_f32 v11, v14 offset:392
    ds_add_f32 v11, v15 offset:396
    s_mov_b64 exec, s[54:55]
    v_mov_b32 v14, 0
    v_mov_b32 v15, 0
    v_lshlrev_b32 v12, 16, v141
    v_add_f32 v14, v14, v12
    v_fmac_f32 v15, v12, v12
    v_lshlrev_b32 v12, 16, v157
    v_add_f32 v14, v14, v12
    v_fmac_f32 v15, v12, v12
    s_nop 1
    v_add_f32_dpp v14, v14, v14 row_shr:1 row_mask:0xf bank_mask:0xf bound_ctrl:0
    v_add_f32_dpp v15, v15, v15 row_shr:1 row_mask:0xf bank_mask:0xf bound_ctrl:0
    s_nop 1
    v_add_f32_dpp v14, v14, v14 row_shr:2 row_mask:0xf bank_mask:0xf bound_ctrl:0
    v_add_f32_dpp v15, v15, v15 row_shr:2 row_mask:0xf bank_mask:0xf bound_ctrl:0
    s_nop 1
    v_add_f32_dpp v14, v14, v14 row_shr:4 row_mask:0xf bank_mask:0xf bound_ctrl:0
    v_add_f32_dpp v15, v15, v15 row_shr:4 row_mask:0xf bank_mask:0xf bound_ctrl:0
    s_nop 1
    v_add_f32_dpp v14, v14, v14 row_shr:8 row_mask:0xf bank_mask:0xf bound_ctrl:0
    v_add_f32_dpp v15, v15, v15 row_shr:8 row_mask:0xf bank_mask:0xf bound_ctrl:0
    s_mov_b64 s[54:55], exec
    s_mov_b64 exec, s[52:53]
    ds_add_f32 v11, v14 offset:400
    ds_add_f32 v11, v15 offset:404
    s_mov_b64 exec, s[54:55]
    v_mov_b32 v14, 0
    v_mov_b32 v15, 0
    v_and_b32 v12, 0xffff0000, v141
    v_add_f32 v14, v14, v12
    v_fmac_f32 v15, v12, v12
    v_and_b32 v12, 0xffff0000, v157
    v_add_f32 v14, v14, v12
    v_fmac_f32 v15, v12, v12
    s_nop 1
    v_add_f32_dpp v14, v14, v14 row_shr:1 row_mask:0xf bank_mask:0xf bound_ctrl:0
    v_add_f32_dpp v15, v15, v15 row_shr:1 row_mask:0xf bank_mask:0xf bound_ctrl:0
    s_nop 1
    v_add_f32_dpp v14, v14, v14 row_shr:2 row_mask:0xf bank_mask:0xf bound_ctrl:0
    v_add_f32_dpp v15, v15, v15 row_shr:2 row_mask:0xf bank_mask:0xf bound_ctrl:0
    s_nop 1
    v_add_f32_dpp v14, v14, v14 row_shr:4 row_mask:0xf bank_mask:0xf bound_ctrl:0
    v_add_f32_dpp v15, v15, v15 row_shr:4 row_mask:0xf bank_mask:0xf bound_ctrl:0
    s_nop 1
    v_add_f32_dpp v14, v14, v14 row_shr:8 row_mask:0xf bank_mask:0xf bound_ctrl:0
    v_add_f32_dpp v15, v15, v15 row_shr:8 row_mask:0xf bank_mask:0xf bound_ctrl:0
    s_mov_b64 s[54:55], exec
    s_mov_b64 exec, s[52:53]
    ds_add_f32 v11, v14 offset:408
    ds_add_f32 v11, v15 offset:412
    s_mov_b64 exec, s[54:55]
    v_mov_b32 v14, 0
    v_mov_b32 v15, 0
    v_lshlrev_b32 v12, 16, v142
    v_add_f32 v14, v14, v12
    v_fmac_f32 v15, v12, v12
    v_lshlrev_b32 v12, 16, v158
    v_add_f32 v14, v14, v12
    v_fmac_f32 v15, v12, v12
    s_nop 1
    v_add_f32_dpp v14, v14, v14 row_shr:1 row_mask:0xf bank_mask:0xf bound_ctrl:0
    v_add_f32_dpp v15, v15, v15 row_shr:1 row_mask:0xf bank_mask:0xf bound_ctrl:0
    s_nop 1
    v_add_f32_dpp v14, v14, v14 row_shr:2 row_mask:0xf bank_mask:0xf bound_ctrl:0
    v_add_f32_dpp v15, v15, v15 row_shr:2 row_mask:0xf bank_mask:0xf bound_ctrl:0
    s_nop 1
    v_add_f32_dpp v14, v14, v14 row_shr:4 row_mask:0xf bank_mask:0xf bound_ctrl:0
    v_add_f32_dpp v15, v15, v15 row_shr:4 row_mask:0xf bank_mask:0xf bound_ctrl:0
    s_nop 1
    v_add_f32_dpp v14, v14, v14 row_shr:8 row_mask:0xf bank_mask:0xf bound_ctrl:0
    v_add_f32_dpp v15, v15, v15 row_shr:8 row_mask:0xf bank_mask:0xf bound_ctrl:0
    s_mov_b64 s[54:55], exec
    s_mov_b64 exec, s[52:53]
    ds_add_f32 v11, v14 offset:448
    ds_add_f32 v11, v15 offset:452
    s_mov_b64 exec, s[54:55]
    v_mov_b32 v14, 0
    v_mov_b32 v15, 0
    v_and_b32 v12, 0xffff0000, v142
    v_add_f32 v14, v14, v12
    v_fmac_f32 v15, v12, v12
    v_and_b32 v12, 0xffff0000, v158
    v_add_f32 v14, v14, v12
    v_fmac_f32 v15, v12, v12
    s_nop 1
    v_add_f32_dpp v14, v14, v14 row_shr:1 row_mask:0xf bank_mask:0xf bound_ctrl:0
    v_add_f32_dpp v15, v15, v15 row_shr:1 row_mask:0xf bank_mask:0xf bound_ctrl:0
    s_nop 1
    v_add_f32_dpp v14, v14, v14 row_shr:2 row_mask:0xf bank_mask:0xf bound_ctrl:0
    v_add_f32_dpp v15, v15, v15 row_shr:2 row_mask:0xf bank_mask:0xf bound_ctrl:0
    s_nop 1
    v_add_f32_dpp v14, v14, v14 row_shr:4 row_mask:0xf bank_mask:0xf bound_ctrl:0
    v_add_f32_dpp v15, v15, v15 row_shr:4 row_mask:0xf bank_mask:0xf bound_ctrl:0
    s_nop 1
    v_add_f32_dpp v14, v14, v14 row_shr:8 row_mask:0xf bank_mask:0xf bound_ctrl:0
    v_add_f32_dpp v15, v15, v15 row_shr:8 row_mask:0xf bank_mask:0xf bound_ctrl:0
    s_mov_b64 s[54:55], exec
    s_mov_b64 exec, s[52:53]
    ds_add_f32 v11, v14 offset:456
    ds_add_f32 v11, v15 offset:460
    s_mov_b64 exec, s[54:55]
    v_mov_b32 v14, 0
    v_mov_b32 v15, 0
    v_lshlrev_b32 v12, 16, v143
    v_add_f32 v14, v14, v12
    v_fmac_f32 v15, v12, v12
    v_lshlrev_b32 v12, 16, v159
    v_add_f32 v14, v14, v12
    v_fmac_f32 v15, v12, v12
    s_nop 1
    v_add_f32_dpp v14, v14, v14 row_shr:1 row_mask:0xf bank_mask:0xf bound_ctrl:0
    v_add_f32_dpp v15, v15, v15 row_shr:1 row_mask:0xf bank_mask:0xf bound_ctrl:0
    s_nop 1
    v_add_f32_dpp v14, v14, v14 row_shr:2 row_mask:0xf bank_mask:0xf bound_ctrl:0
    v_add_f32_dpp v15, v15, v15 row_shr:2 row_mask:0xf bank_mask:0xf bound_ctrl:0
    s_nop 1
    v_add_f32_dpp v14, v14, v14 row_shr:4 row_mask:0xf bank_mask:0xf bound_ctrl:0
    v_add_f32_dpp v15, v15, v15 row_shr:4 row_mask:0xf bank_mask:0xf bound_ctrl:0
    s_nop 1
    v_add_f32_dpp v14, v14, v14 row_shr:8 row_mask:0xf bank_mask:0xf bound_ctrl:0
    v_add_f32_dpp v15, v15, v15 row_shr:8 row_mask:0xf bank_mask:0xf bound_ctrl:0
    s_mov_b64 s[54:55], exec
    s_mov_b64 exec, s[52:53]
    ds_add_f32 v11, v14 offset:464
    ds_add_f32 v11, v15 offset:468
    s_mov_b64 exec, s[54:55]
    v_mov_b32 v14, 0
    v_mov_b32 v15, 0
    v_and_b32 v12, 0xffff0000, v143
    v_add_f32 v14, v14, v12
    v_fmac_f32 v15, v12, v12
    v_and_b32 v12, 0xffff0000, v159
    v_add_f32 v14, v14, v12
    v_fmac_f32 v15, v12, v12
    s_nop 1
    v_add_f32_dpp v14, v14, v14 row_shr:1 row_mask:0xf bank_mask:0xf bound_ctrl:0
    v_add_f32_dpp v15, v15, v15 row_shr:1 row_mask:0xf bank_mask:0xf bound_ctrl:0
    s_nop 1
    v_add_f32_dpp v14, v14, v14 row_shr:2 row_mask:0xf bank_mask:0xf bound_ctrl:0
    v_add_f32_dpp v15, v15, v15 row_shr:2 row_mask:0xf bank_mask:0xf bound_ctrl:0
    s_nop 1
    v_add_f32_dpp v14, v14, v14 row_shr:4 row_mask:0xf bank_mask:0xf bound_ctrl:0
    v_add_f32_dpp v15, v15, v15 row_shr:4 row_mask:0xf bank_mask:0xf bound_ctrl:0
    s_nop 1
    v_add_f32_dpp v14, v14, v14 row_shr:8 row_mask:0xf bank_mask:0xf bound_ctrl:0
    v_add_f32_dpp v15, v15, v15 row_shr:8 row_mask:0xf bank_mask:0xf bound_ctrl:0
    s_mov_b64 s[54:55], exec
    s_mov_b64 exec, s[52:53]
    ds_add_f32 v11, v14 offset:472
    ds_add_f32 v11, v15 offset:476
    s_mov_b64 exec, s[54:55]
    s_waitcnt lgkmcnt(0)
    s_barrier
    v_lshlrev_b32 v11, 2, v0
    ds_read_b32 v12, v11
    v_lshrrev_b32 v13, 1, v0
    v_add_u32 v13, s33, v13
    v_mul_u32_u24 v13, 56, v13
    v_and_b32 v14, 1, v0
    v_lshl_add_u32 v13, v14, 2, v13
    s_sub_u32 s46, s31, 7
    s_lshl_b32 s46, s46, 3
    v_add_u32 v13, s46, v13
    s_waitcnt lgkmcnt(0)
    buffer_store_dword v12, v13, s[20:23], 0 offen
gemm1_done:
    s_endpgm
.globl norm_kernel
.p2align 8
.type norm_kernel,@function
norm_kernel:
    s_cmp_ge_u32 s2, 224
    s_cbranch_scc1 norm_done
    s_load_dwordx2 s[36:37], s[0:1], 104
    s_and_b32 s30, s2, 7
    s_lshr_b32 s31, s2, 3
    s_waitcnt lgkmcnt(0)
    s_add_u32 s8, s36, 0x1200000
    s_addc_u32 s9, s37, 0
    s_mov_b32 s10, 0x1c000
    s_mov_b32 s11, 0x00020000
    s_add_u32 s12, s36, 0xe00000
    s_addc_u32 s13, s37, 0
    s_mov_b32 s14, 0x380000
    s_mov_b32 s15, 0x00020000
    s_add_u32 s16, s36, 0x1400000
    s_addc_u32 s17, s37, 0
    s_mov_b32 s18, 0x380000
    s_mov_b32 s19, 0x00020000
    s_lshl_b32 s32, s30, 8
    v_add_u32 v1, s32, v0
    v_mul_u32_u24 v1, 56, v1
    buffer_load_dwordx2 v[16:17], v1, s[8:11], 0 offen offset:0
    buffer_load_dwordx2 v[18:19], v1, s[8:11], 0 offen offset:8
    buffer_load_dwordx2 v[20:21], v1, s[8:11], 0 offen offset:16
    buffer_load_dwordx2 v[22:23], v1, s[8:11], 0 offen offset:24
    buffer_load_dwordx2 v[24:25], v1, s[8:11], 0 offen offset:32
    buffer_load_dwordx2 v[26:27], v1, s[8:11], 0 offen offset:40
    buffer_load_dwordx2 v[28:29], v1, s[8:11], 0 offen offset:48
    v_lshrrev_b32 v2, 3, v0
    v_and_b32 v3, 7, v0
    s_lshl_b32 s33, s31, 5
    v_add_u32 v4, s33, v2
    v_lshlrev_b32 v4, 12, v4
    v_lshl_add_u32 v4, v3, 6, v4
    s_lshl_b32 s34, s30, 9
    v_add_u32 v4, s34, v4
    buffer_load_dwordx4 v[32:35], v4, s[12:15], 0 offen offset:0
    buffer_load_dwordx4 v[36:39], v4, s[12:15], 0 offen offset:16
    buffer_load_dwordx4 v[40:43], v4, s[12:15], 0 offen offset:32
    buffer_load_dwordx4 v[44:47], v4, s[12:15], 0 offen offset:48
    s_waitcnt vmcnt(4)
    v_add_f32 v16, v16, v18
    v_add_f32 v17, v17, v19
    v_add_f32 v16, v16, v20
    v_add_f32 v17, v17, v21
    v_add_f32 v16, v16, v22
    v_add_f32 v17, v17, v23
    v_add_f32 v16, v16, v24
    v_add_f32 v17, v17, v25
    v_add_f32 v16, v16, v26
    v_add_f32 v17, v17, v27
    v_add_f32 v16, v16, v28
    v_add_f32 v17, v17, v29
    v_mul_f32 v16, 0x3a924925, v16
    v_mul_f32 v17, 0x3a924925, v17
    v_fma_f32 v17, -v16, v16, v17
    v_max_f32 v17, 0, v17
    v_add_f32 v17, 0x3727c5ac, v17
    v_rsq_f32 v17, v17
    s_nop 0
    v_mul_f32 v16, v16, v17
    v_lshlrev_b32 v5, 2, v0
    ds_write_b32 v5, v17
    ds_write_b32 v5, v16 offset:1024
    s_waitcnt lgkmcnt(0)
    s_barrier
    v_lshlrev_b32 v6, 7, v3
    ds_read_b128 v[48:51], v6 offset:0
    ds_read_b128 v[80:83], v6 offset:1024
    ds_read_b128 v[52:55], v6 offset:16
    ds_read_b128 v[84:87], v6 offset:1040
    ds_read_b128 v[56:59], v6 offset:32
    ds_read_b128 v[88:91], v6 offset:1056
    ds_read_b128 v[60:63], v6 offset:48
    ds_read_b128 v[92:95], v6 offset:1072
    ds_read_b128 v[64:67], v6 offset:64
    ds_read_b128 v[96:99], v6 offset:1088
    ds_read_b128 v[68:71], v6 offset:80
    ds_read_b128 v[100:103], v6 offset:1104
    ds_read_b128 v[72:75], v6 offset:96
    ds_read_b128 v[104:107], v6 offset:1120
    ds_read_b128 v[76:79], v6 offset:112
    ds_read_b128 v[108:111], v6 offset:1136
    s_waitcnt vmcnt(0) lgkmcnt(0)
    v_lshlrev_b32 v8, 16, v32
    v_and_b32 v9, 0xffff0000, v32
    v_fma_f32 v8, v8, v48, -v80
    v_fma_f32 v9, v9, v49, -v81
    v_cvt_pk_bf16_f32 v32, v8, v9
    v_lshlrev_b32 v8, 16, v33
    v_and_b32 v9, 0xffff0000, v33
    v_fma_f32 v8, v8, v50, -v82
    v_fma_f32 v9, v9, v51, -v83
    v_cvt_pk_bf16_f32 v33, v8, v9
    v_lshlrev_b32 v8, 16, v34
    v_and_b32 v9, 0xffff0000, v34
    v_fma_f32 v8, v8, v52, -v84
    v_fma_f32 v9, v9, v53, -v85
    v_cvt_pk_bf16_f32 v34, v8, v9
    v_lshlrev_b32 v8, 16, v35
    v_and_b32 v9, 0xffff0000, v35
    v_fma_f32 v8, v8, v54, -v86
    v_fma_f32 v9, v9, v55, -v87
    v_cvt_pk_bf16_f32 v35, v8, v9
    v_lshlrev_b32 v8, 16, v36
    v_and_b32 v9, 0xffff0000, v36
    v_fma_f32 v8, v8, v56, -v88
    v_fma_f32 v9, v9, v57, -v89
    v_cvt_pk_bf16_f32 v36, v8, v9
    v_lshlrev_b32 v8, 16, v37
    v_and_b32 v9, 0xffff0000, v37
    v_fma_f32 v8, v8, v58, -v90
    v_fma_f32 v9, v9, v59, -v91
    v_cvt_pk_bf16_f32 v37, v8, v9
    v_lshlrev_b32 v8, 16, v38
    v_and_b32 v9, 0xffff0000, v38
    v_fma_f32 v8, v8, v60, -v92
    v_fma_f32 v9, v9, v61, -v93
    v_cvt_pk_bf16_f32 v38, v8, v9
    v_lshlrev_b32 v8, 16, v39
    v_and_b32 v9, 0xffff0000, v39
    v_fma_f32 v8, v8, v62, -v94
    v_fma_f32 v9, v9, v63, -v95
    v_cvt_pk_bf16_f32 v39, v8, v9
    v_lshlrev_b32 v8, 16, v40
    v_and_b32 v9, 0xffff0000, v40
    v_fma_f32 v8, v8, v64, -v96
    v_fma_f32 v9, v9, v65, -v97
    v_cvt_pk_bf16_f32 v40, v8, v9
    v_lshlrev_b32 v8, 16, v41
    v_and_b32 v9, 0xffff0000, v41
    v_fma_f32 v8, v8, v66, -v98
    v_fma_f32 v9, v9, v67, -v99
    v_cvt_pk_bf16_f32 v41, v8, v9
    v_lshlrev_b32 v8, 16, v42
    v_and_b32 v9, 0xffff0000, v42
    v_fma_f32 v8, v8, v68, -v100
    v_fma_f32 v9, v9, v69, -v101
    v_cvt_pk_bf16_f32 v42, v8, v9
    v_lshlrev_b32 v8, 16, v43
    v_and_b32 v9, 0xffff0000, v43
    v_fma_f32 v8, v8, v70, -v102
    v_fma_f32 v9, v9, v71, -v103
    v_cvt_pk_bf16_f32 v43, v8, v9
    v_lshlrev_b32 v8, 16, v44
    v_and_b32 v9, 0xffff0000, v44
    v_fma_f32 v8, v8, v72, -v104
    v_fma_f32 v9, v9, v73, -v105
    v_cvt_pk_bf16_f32 v44, v8, v9
    v_lshlrev_b32 v8, 16, v45
    v_and_b32 v9, 0xffff0000, v45
    v_fma_f32 v8, v8, v74, -v106
    v_fma_f32 v9, v9, v75, -v107
    v_cvt_pk_bf16_f32 v45, v8, v9
    v_lshlrev_b32 v8, 16, v46
    v_and_b32 v9, 0xffff0000, v46
    v_fma_f32 v8, v8, v76, -v108
    v_fma_f32 v9, v9, v77, -v109
    v_cvt_pk_bf16_f32 v46, v8, v9
    v_lshlrev_b32 v8, 16, v47
    v_and_b32 v9, 0xffff0000, v47
    v_fma_f32 v8, v8, v78, -v110
    v_fma_f32 v9, v9, v79, -v111
    v_cvt_pk_bf16_f32 v47, v8, v9
    buffer_store_dwordx4 v[32:35], v4, s[16:19], 0 offen offset:0
    buffer_store_dwordx4 v[36:39], v4, s[16:19], 0 offen offset:16
    buffer_store_dwordx4 v[40:43], v4, s[16:19], 0 offen offset:32
    buffer_store_dwordx4 v[44:47], v4, s[16:19], 0 offen offset:48
norm_done:
    s_endpgm
.globl gemm2_kernel
.p2align 8
.type gemm2_kernel,@function
gemm2_kernel:
    s_cmp_ge_u32 s2, 224
    s_cbranch_scc1 gemm2_done
    s_load_dwordx2 s[36:37], s[0:1], 104
    s_load_dwordx2 s[4:5], s[0:1], 64
    s_load_dwordx2 s[6:7], s[0:1], 72
    s_load_dwordx2 s[38:39], s[0:1], 88
    s_mul_hi_u32 s30, s2, 0x12492493
    s_mul_i32 s31, s30, 14
    s_sub_u32 s31, s2, s31
    s_and_b32 s46, s2, 7
    s_lshr_b32 s47, s2, 3
    s_lshr_b32 s31, s46, 2
    s_mul_i32 s31, s31, 7
    s_lshr_b32 s30, s47, 2
    s_add_u32 s31, s31, s30
    s_and_b32 s30, s46, 3
    s_lshl_b32 s30, s30, 2
    s_and_b32 s47, s47, 3
    s_add_u32 s30, s30, s47
    s_mov_b32 s40, 0x3d372713
    s_mov_b32 s41, 0xc0135761
    v_lshrrev_b32 v7, 6, v0
    s_nop 0
    v_readfirstlane_b32 s27, v7
    s_nop 3
    s_and_b32 s28, s27, 3
    s_waitcnt lgkmcnt(0)
    s_add_u32 s8, s36, 0x1400000
    s_addc_u32 s9, s37, 0
    s_mov_b32 s10, 0x380000
    s_mov_b32 s11, 0x00020000
    s_mov_b32 s12, s4
    s_mov_b32 s13, s5
    s_mov_b32 s14, 0x800000
    s_mov_b32 s15, 0x00020000
    s_mul_i32 s32, s31, 64
    s_mul_i32 s33, s30, 128
    v_and_b32 v1, 63, v0
    v_lshrrev_b32 v2, 3, v1
    v_and_b32 v3, 7, v1
    v_xor_b32 v3, v3, v2
    s_lshl_b32 s34, s28, 3
    v_add_u32 v2, s34, v2
    v_add_u32 v16, s32, v2
    v_add_u32 v16, 0, v16
    s_mov_b32 s35, 4096
    v_mul_lo_u32 v16, v16, s35
    v_lshl_add_u32 v16, v3, 4, v16
    v_add_u32 v17, s32, v2
    v_add_u32 v17, 32, v17
    s_mov_b32 s35, 4096
    v_mul_lo_u32 v17, v17, s35
    v_lshl_add_u32 v17, v3, 4, v17
    v_add_u32 v18, s33, v2
    v_add_u32 v18, 0, v18
    s_mov_b32 s35, 4096
    v_mul_lo_u32 v18, v18, s35
    v_lshl_add_u32 v18, v3, 4, v18
    v_add_u32 v19, s33, v2
    v_add_u32 v19, 32, v19
    s_mov_b32 s35, 4096
    v_mul_lo_u32 v19, v19, s35
    v_lshl_add_u32 v19, v3, 4, v19
    v_add_u32 v20, s33, v2
    v_add_u32 v20, 64, v20
    s_mov_b32 s35, 4096
    v_mul_lo_u32 v20, v20, s35
    v_lshl_add_u32 v20, v3, 4, v20
    v_add_u32 v21, s33, v2
    v_add_u32 v21, 96, v21
    s_mov_b32 s35, 4096
    v_mul_lo_u32 v21, v21, s35
    v_lshl_add_u32 v21, v3, 4, v21
    s_lshl_b32 s43, s28, 10
    s_cmp_lt_u32 s27, 4
    s_cbranch_scc1 gemm2_comp
    s_mov_b32 s42, 0
    s_add_u32 m0, s43, 0
    s_nop 0
    buffer_load_dwordx4 v16, s[8:11], s42 offen lds
    s_add_u32 m0, s43, 4096
    s_nop 0
    buffer_load_dwordx4 v17, s[8:11], s42 offen lds
    s_add_u32 m0, s43, 8192
    s_nop 0
    buffer_load_dwordx4 v18, s[12:15], s42 offen lds
    s_add_u32 m0, s43, 12288
    s_nop 0
    buffer_load_dwordx4 v19, s[12:15], s42 offen lds
    s_add_u32 m0, s43, 16384
    s_nop 0
    buffer_load_dwordx4 v20, s[12:15], s42 offen lds
    s_add_u32 m0, s43, 20480
    s_nop 0
    buffer_load_dwordx4 v21, s[12:15], s42 offen lds
    s_mov_b32 s42, 128
    s_add_u32 m0, s43, 24576
    s_nop 0
    buffer_load_dwordx4 v16, s[8:11], s42 offen lds
    s_add_u32 m0, s43, 28672
    s_nop 0
    buffer_load_dwordx4 v17, s[8:11], s42 offen lds
    s_add_u32 m0, s43, 32768
    s_nop 0
    buffer_load_dwordx4 v18, s[12:15], s42 offen lds
    s_add_u32 m0, s43, 36864
    s_nop 0
    buffer_load_dwordx4 v19, s[12:15], s42 offen lds
    s_add_u32 m0, s43, 40960
    s_nop 0
    buffer_load_dwordx4 v20, s[12:15], s42 offen lds
    s_add_u32 m0, s43, 45056
    s_nop 0
    buffer_load_dwordx4 v21, s[12:15], s42 offen lds
    s_mov_b32 s42, 256
    s_add_u32 m0, s43, 49152
    s_nop 0
    buffer_load_dwordx4 v16, s[8:11], s42 offen lds
    s_add_u32 m0, s43, 53248
    s_nop 0
    buffer_load_dwordx4 v17, s[8:11], s42 offen lds
    s_add_u32 m0, s43, 57344
    s_nop 0
    buffer_load_dwordx4 v18, s[12:15], s42 offen lds
    s_add_u32 m0, s43, 61440
    s_nop 0
    buffer_load_dwordx4 v19, s[12:15], s42 offen lds
    s_add_u32 m0, s43, 65536
    s_nop 0
    buffer_load_dwordx4 v20, s[12:15], s42 offen lds
    s_add_u32 m0, s43, 69632
    s_nop 0
    buffer_load_dwordx4 v21, s[12:15], s42 offen lds
    s_mov_b32 s42, 384
    s_add_u32 m0, s43, 73728
    s_nop 0
    buffer_load_dwordx4 v16, s[8:11], s42 offen lds
    s_add_u32 m0, s43, 77824
    s_nop 0
    buffer_load_dwordx4 v17, s[8:11], s42 offen lds
    s_add_u32 m0, s43, 81920
    s_nop 0
    buffer_load_dwordx4 v18, s[12:15], s42 offen lds
    s_add_u32 m0, s43, 86016
    s_nop 0
    buffer_load_dwordx4 v19, s[12:15], s42 offen lds
    s_add_u32 m0, s43, 90112
    s_nop 0
    buffer_load_dwordx4 v20, s[12:15], s42 offen lds
    s_add_u32 m0, s43, 94208
    s_nop 0
    buffer_load_dwordx4 v21, s[12:15], s42 offen lds
    s_mov_b32 s42, 512
    s_add_u32 m0, s43, 98304
    s_nop 0
    buffer_load_dwordx4 v16, s[8:11], s42 offen lds
    s_add_u32 m0, s43, 102400
    s_nop 0
    buffer_load_dwordx4 v17, s[8:11], s42 offen lds
    s_add_u32 m0, s43, 106496
    s_nop 0
    buffer_load_dwordx4 v18, s[12:15], s42 offen lds
    s_add_u32 m0, s43, 110592
    s_nop 0
    buffer_load_dwordx4 v19, s[12:15], s42 offen lds
    s_add_u32 m0, s43, 114688
    s_nop 0
    buffer_load_dwordx4 v20, s[12:15], s42 offen lds
    s_add_u32 m0, s43, 118784
    s_nop 0
    buffer_load_dwordx4 v21, s[12:15], s42 offen lds
    s_waitcnt vmcnt(24)
    s_barrier
    s_mov_b32 s42, 640
    s_add_u32 m0, s43, 122880
    s_nop 0
    buffer_load_dwordx4 v16, s[8:11], s42 offen lds
    s_add_u32 m0, s43, 126976
    s_nop 0
    buffer_load_dwordx4 v17, s[8:11], s42 offen lds
    s_add_u32 m0, s43, 131072
    s_nop 0
    buffer_load_dwordx4 v18, s[12:15], s42 offen lds
    s_add_u32 m0, s43, 135168
    s_nop 0
    buffer_load_dwordx4 v19, s[12:15], s42 offen lds
    s_add_u32 m0, s43, 139264
    s_nop 0
    buffer_load_dwordx4 v20, s[12:15], s42 offen lds
    s_add_u32 m0, s43, 143360
    s_nop 0
    buffer_load_dwordx4 v21, s[12:15], s42 offen lds
    s_waitcnt vmcnt(24)
    s_barrier
    s_mov_b32 s42, 768
    s_add_u32 m0, s43, 0
    s_nop 0
    buffer_load_dwordx4 v16, s[8:11], s42 offen lds
    s_add_u32 m0, s43, 4096
    s_nop 0
    buffer_load_dwordx4 v17, s[8:11], s42 offen lds
    s_add_u32 m0, s43, 8192
    s_nop 0
    buffer_load_dwordx4 v18, s[12:15], s42 offen lds
    s_add_u32 m0, s43, 12288
    s_nop 0
    buffer_load_dwordx4 v19, s[12:15], s42 offen lds
    s_add_u32 m0, s43, 16384
    s_nop 0
    buffer_load_dwordx4 v20, s[12:15], s42 offen lds
    s_add_u32 m0, s43, 20480
    s_nop 0
    buffer_load_dwordx4 v21, s[12:15], s42 offen lds
    s_waitcnt vmcnt(24)
    s_barrier
    s_mov_b32 s42, 896
    s_add_u32 m0, s43, 24576
    s_nop 0
    buffer_load_dwordx4 v16, s[8:11], s42 offen lds
    s_add_u32 m0, s43, 28672
    s_nop 0
    buffer_load_dwordx4 v17, s[8:11], s42 offen lds
    s_add_u32 m0, s43, 32768
    s_nop 0
    buffer_load_dwordx4 v18, s[12:15], s42 offen lds
    s_add_u32 m0, s43, 36864
    s_nop 0
    buffer_load_dwordx4 v19, s[12:15], s42 offen lds
    s_add_u32 m0, s43, 40960
    s_nop 0
    buffer_load_dwordx4 v20, s[12:15], s42 offen lds
    s_add_u32 m0, s43, 45056
    s_nop 0
    buffer_load_dwordx4 v21, s[12:15], s42 offen lds
    s_waitcnt vmcnt(24)
    s_barrier
    s_mov_b32 s42, 1024
    s_add_u32 m0, s43, 49152
    s_nop 0
    buffer_load_dwordx4 v16, s[8:11], s42 offen lds
    s_add_u32 m0, s43, 53248
    s_nop 0
    buffer_load_dwordx4 v17, s[8:11], s42 offen lds
    s_add_u32 m0, s43, 57344
    s_nop 0
    buffer_load_dwordx4 v18, s[12:15], s42 offen lds
    s_add_u32 m0, s43, 61440
    s_nop 0
    buffer_load_dwordx4 v19, s[12:15], s42 offen lds
    s_add_u32 m0, s43, 65536
    s_nop 0
    buffer_load_dwordx4 v20, s[12:15], s42 offen lds
    s_add_u32 m0, s43, 69632
    s_nop 0
    buffer_load_dwordx4 v21, s[12:15], s42 offen lds
    s_waitcnt vmcnt(24)
    s_barrier
    s_mov_b32 s42, 1152
    s_add_u32 m0, s43, 73728
    s_nop 0
    buffer_load_dwordx4 v16, s[8:11], s42 offen lds
    s_add_u32 m0, s43, 77824
    s_nop 0
    buffer_load_dwordx4 v17, s[8:11], s42 offen lds
    s_add_u32 m0, s43, 81920
    s_nop 0
    buffer_load_dwordx4 v18, s[12:15], s42 offen lds
    s_add_u32 m0, s43, 86016
    s_nop 0
    buffer_load_dwordx4 v19, s[12:15], s42 offen lds
    s_add_u32 m0, s43, 90112
    s_nop 0
    buffer_load_dwordx4 v20, s[12:15], s42 offen lds
    s_add_u32 m0, s43, 94208
    s_nop 0
    buffer_load_dwordx4 v21, s[12:15], s42 offen lds
    s_waitcnt vmcnt(24)
    s_barrier
    s_mov_b32 s42, 1280
    s_add_u32 m0, s43, 98304
    s_nop 0
    buffer_load_dwordx4 v16, s[8:11], s42 offen lds
    s_add_u32 m0, s43, 102400
    s_nop 0
    buffer_load_dwordx4 v17, s[8:11], s42 offen lds
    s_add_u32 m0, s43, 106496
    s_nop 0
    buffer_load_dwordx4 v18, s[12:15], s42 offen lds
    s_add_u32 m0, s43, 110592
    s_nop 0
    buffer_load_dwordx4 v19, s[12:15], s42 offen lds
    s_add_u32 m0, s43, 114688
    s_nop 0
    buffer_load_dwordx4 v20, s[12:15], s42 offen lds
    s_add_u32 m0, s43, 118784
    s_nop 0
    buffer_load_dwordx4 v21, s[12:15], s42 offen lds
    s_waitcnt vmcnt(24)
    s_barrier
    s_mov_b32 s42, 1408
    s_add_u32 m0, s43, 122880
    s_nop 0
    buffer_load_dwordx4 v16, s[8:11], s42 offen lds
    s_add_u32 m0, s43, 126976
    s_nop 0
    buffer_load_dwordx4 v17, s[8:11], s42 offen lds
    s_add_u32 m0, s43, 131072
    s_nop 0
    buffer_load_dwordx4 v18, s[12:15], s42 offen lds
    s_add_u32 m0, s43, 135168
    s_nop 0
    buffer_load_dwordx4 v19, s[12:15], s42 offen lds
    s_add_u32 m0, s43, 139264
    s_nop 0
    buffer_load_dwordx4 v20, s[12:15], s42 offen lds
    s_add_u32 m0, s43, 143360
    s_nop 0
    buffer_load_dwordx4 v21, s[12:15], s42 offen lds
    s_waitcnt vmcnt(24)
    s_barrier
    s_mov_b32 s42, 1536
    s_add_u32 m0, s43, 0
    s_nop 0
    buffer_load_dwordx4 v16, s[8:11], s42 offen lds
    s_add_u32 m0, s43, 4096
    s_nop 0
    buffer_load_dwordx4 v17, s[8:11], s42 offen lds
    s_add_u32 m0, s43, 8192
    s_nop 0
    buffer_load_dwordx4 v18, s[12:15], s42 offen lds
    s_add_u32 m0, s43, 12288
    s_nop 0
    buffer_load_dwordx4 v19, s[12:15], s42 offen lds
    s_add_u32 m0, s43, 16384
    s_nop 0
    buffer_load_dwordx4 v20, s[12:15], s42 offen lds
    s_add_u32 m0, s43, 20480
    s_nop 0
    buffer_load_dwordx4 v21, s[12:15], s42 offen lds
    s_waitcnt vmcnt(24)
    s_barrier
    s_mov_b32 s42, 1664
    s_add_u32 m0, s43, 24576
    s_nop 0
    buffer_load_dwordx4 v16, s[8:11], s42 offen lds
    s_add_u32 m0, s43, 28672
    s_nop 0
    buffer_load_dwordx4 v17, s[8:11], s42 offen lds
    s_add_u32 m0, s43, 32768
    s_nop 0
    buffer_load_dwordx4 v18, s[12:15], s42 offen lds
    s_add_u32 m0, s43, 36864
    s_nop 0
    buffer_load_dwordx4 v19, s[12:15], s42 offen lds
    s_add_u32 m0, s43, 40960
    s_nop 0
    buffer_load_dwordx4 v20, s[12:15], s42 offen lds
    s_add_u32 m0, s43, 45056
    s_nop 0
    buffer_load_dwordx4 v21, s[12:15], s42 offen lds
    s_waitcnt vmcnt(24)
    s_barrier
    s_mov_b32 s42, 1792
    s_add_u32 m0, s43, 49152
    s_nop 0
    buffer_load_dwordx4 v16, s[8:11], s42 offen lds
    s_add_u32 m0, s43, 53248
    s_nop 0
    buffer_load_dwordx4 v17, s[8:11], s42 offen lds
    s_add_u32 m0, s43, 57344
    s_nop 0
    buffer_load_dwordx4 v18, s[12:15], s42 offen lds
    s_add_u32 m0, s43, 61440
    s_nop 0
    buffer_load_dwordx4 v19, s[12:15], s42 offen lds
    s_add_u32 m0, s43, 65536
    s_nop 0
    buffer_load_dwordx4 v20, s[12:15], s42 offen lds
    s_add_u32 m0, s43, 69632
    s_nop 0
    buffer_load_dwordx4 v21, s[12:15], s42 offen lds
    s_waitcnt vmcnt(24)
    s_barrier
    s_mov_b32 s42, 1920
    s_add_u32 m0, s43, 73728
    s_nop 0
    buffer_load_dwordx4 v16, s[8:11], s42 offen lds
    s_add_u32 m0, s43, 77824
    s_nop 0
    buffer_load_dwordx4 v17, s[8:11], s42 offen lds
    s_add_u32 m0, s43, 81920
    s_nop 0
    buffer_load_dwordx4 v18, s[12:15], s42 offen lds
    s_add_u32 m0, s43, 86016
    s_nop 0
    buffer_load_dwordx4 v19, s[12:15], s42 offen lds
    s_add_u32 m0, s43, 90112
    s_nop 0
    buffer_load_dwordx4 v20, s[12:15], s42 offen lds
    s_add_u32 m0, s43, 94208
    s_nop 0
    buffer_load_dwordx4 v21, s[12:15], s42 offen lds
    s_waitcnt vmcnt(24)
    s_barrier
    s_mov_b32 s42, 2048
    s_add_u32 m0, s43, 98304
    s_nop 0
    buffer_load_dwordx4 v16, s[8:11], s42 offen lds
    s_add_u32 m0, s43, 102400
    s_nop 0
    buffer_load_dwordx4 v17, s[8:11], s42 offen lds
    s_add_u32 m0, s43, 106496
    s_nop 0
    buffer_load_dwordx4 v18, s[12:15], s42 offen lds
    s_add_u32 m0, s43, 110592
    s_nop 0
    buffer_load_dwordx4 v19, s[12:15], s42 offen lds
    s_add_u32 m0, s43, 114688
    s_nop 0
    buffer_load_dwordx4 v20, s[12:15], s42 offen lds
    s_add_u32 m0, s43, 118784
    s_nop 0
    buffer_load_dwordx4 v21, s[12:15], s42 offen lds
    s_waitcnt vmcnt(24)
    s_barrier
    s_mov_b32 s42, 2176
    s_add_u32 m0, s43, 122880
    s_nop 0
    buffer_load_dwordx4 v16, s[8:11], s42 offen lds
    s_add_u32 m0, s43, 126976
    s_nop 0
    buffer_load_dwordx4 v17, s[8:11], s42 offen lds
    s_add_u32 m0, s43, 131072
    s_nop 0
    buffer_load_dwordx4 v18, s[12:15], s42 offen lds
    s_add_u32 m0, s43, 135168
    s_nop 0
    buffer_load_dwordx4 v19, s[12:15], s42 offen lds
    s_add_u32 m0, s43, 139264
    s_nop 0
    buffer_load_dwordx4 v20, s[12:15], s42 offen lds
    s_add_u32 m0, s43, 143360
    s_nop 0
    buffer_load_dwordx4 v21, s[12:15], s42 offen lds
    s_waitcnt vmcnt(24)
    s_barrier
    s_mov_b32 s42, 2304
    s_add_u32 m0, s43, 0
    s_nop 0
    buffer_load_dwordx4 v16, s[8:11], s42 offen lds
    s_add_u32 m0, s43, 4096
    s_nop 0
    buffer_load_dwordx4 v17, s[8:11], s42 offen lds
    s_add_u32 m0, s43, 8192
    s_nop 0
    buffer_load_dwordx4 v18, s[12:15], s42 offen lds
    s_add_u32 m0, s43, 12288
    s_nop 0
    buffer_load_dwordx4 v19, s[12:15], s42 offen lds
    s_add_u32 m0, s43, 16384
    s_nop 0
    buffer_load_dwordx4 v20, s[12:15], s42 offen lds
    s_add_u32 m0, s43, 20480
    s_nop 0
    buffer_load_dwordx4 v21, s[12:15], s42 offen lds
    s_waitcnt vmcnt(24)
    s_barrier
    s_mov_b32 s42, 2432
    s_add_u32 m0, s43, 24576
    s_nop 0
    buffer_load_dwordx4 v16, s[8:11], s42 offen lds
    s_add_u32 m0, s43, 28672
    s_nop 0
    buffer_load_dwordx4 v17, s[8:11], s42 offen lds
    s_add_u32 m0, s43, 32768
    s_nop 0
    buffer_load_dwordx4 v18, s[12:15], s42 offen lds
    s_add_u32 m0, s43, 36864
    s_nop 0
    buffer_load_dwordx4 v19, s[12:15], s42 offen lds
    s_add_u32 m0, s43, 40960
    s_nop 0
    buffer_load_dwordx4 v20, s[12:15], s42 offen lds
    s_add_u32 m0, s43, 45056
    s_nop 0
    buffer_load_dwordx4 v21, s[12:15], s42 offen lds
    s_waitcnt vmcnt(24)
    s_barrier
    s_mov_b32 s42, 2560
    s_add_u32 m0, s43, 49152
    s_nop 0
    buffer_load_dwordx4 v16, s[8:11], s42 offen lds
    s_add_u32 m0, s43, 53248
    s_nop 0
    buffer_load_dwordx4 v17, s[8:11], s42 offen lds
    s_add_u32 m0, s43, 57344
    s_nop 0
    buffer_load_dwordx4 v18, s[12:15], s42 offen lds
    s_add_u32 m0, s43, 61440
    s_nop 0
    buffer_load_dwordx4 v19, s[12:15], s42 offen lds
    s_add_u32 m0, s43, 65536
    s_nop 0
    buffer_load_dwordx4 v20, s[12:15], s42 offen lds
    s_add_u32 m0, s43, 69632
    s_nop 0
    buffer_load_dwordx4 v21, s[12:15], s42 offen lds
    s_waitcnt vmcnt(24)
    s_barrier
    s_mov_b32 s42, 2688
    s_add_u32 m0, s43, 73728
    s_nop 0
    buffer_load_dwordx4 v16, s[8:11], s42 offen lds
    s_add_u32 m0, s43, 77824
    s_nop 0
    buffer_load_dwordx4 v17, s[8:11], s42 offen lds
    s_add_u32 m0, s43, 81920
    s_nop 0
    buffer_load_dwordx4 v18, s[12:15], s42 offen lds
    s_add_u32 m0, s43, 86016
    s_nop 0
    buffer_load_dwordx4 v19, s[12:15], s42 offen lds
    s_add_u32 m0, s43, 90112
    s_nop 0
    buffer_load_dwordx4 v20, s[12:15], s42 offen lds
    s_add_u32 m0, s43, 94208
    s_nop 0
    buffer_load_dwordx4 v21, s[12:15], s42 offen lds
    s_waitcnt vmcnt(24)
    s_barrier
    s_mov_b32 s42, 2816
    s_add_u32 m0, s43, 98304
    s_nop 0
    buffer_load_dwordx4 v16, s[8:11], s42 offen lds
    s_add_u32 m0, s43, 102400
    s_nop 0
    buffer_load_dwordx4 v17, s[8:11], s42 offen lds
    s_add_u32 m0, s43, 106496
    s_nop 0
    buffer_load_dwordx4 v18, s[12:15], s42 offen lds
    s_add_u32 m0, s43, 110592
    s_nop 0
    buffer_load_dwordx4 v19, s[12:15], s42 offen lds
    s_add_u32 m0, s43, 114688
    s_nop 0
    buffer_load_dwordx4 v20, s[12:15], s42 offen lds
    s_add_u32 m0, s43, 118784
    s_nop 0
    buffer_load_dwordx4 v21, s[12:15], s42 offen lds
    s_waitcnt vmcnt(24)
    s_barrier
    s_mov_b32 s42, 2944
    s_add_u32 m0, s43, 122880
    s_nop 0
    buffer_load_dwordx4 v16, s[8:11], s42 offen lds
    s_add_u32 m0, s43, 126976
    s_nop 0
    buffer_load_dwordx4 v17, s[8:11], s42 offen lds
    s_add_u32 m0, s43, 131072
    s_nop 0
    buffer_load_dwordx4 v18, s[12:15], s42 offen lds
    s_add_u32 m0, s43, 135168
    s_nop 0
    buffer_load_dwordx4 v19, s[12:15], s42 offen lds
    s_add_u32 m0, s43, 139264
    s_nop 0
    buffer_load_dwordx4 v20, s[12:15], s42 offen lds
    s_add_u32 m0, s43, 143360
    s_nop 0
    buffer_load_dwordx4 v21, s[12:15], s42 offen lds
    s_waitcnt vmcnt(24)
    s_barrier
    s_mov_b32 s42, 3072
    s_add_u32 m0, s43, 0
    s_nop 0
    buffer_load_dwordx4 v16, s[8:11], s42 offen lds
    s_add_u32 m0, s43, 4096
    s_nop 0
    buffer_load_dwordx4 v17, s[8:11], s42 offen lds
    s_add_u32 m0, s43, 8192
    s_nop 0
    buffer_load_dwordx4 v18, s[12:15], s42 offen lds
    s_add_u32 m0, s43, 12288
    s_nop 0
    buffer_load_dwordx4 v19, s[12:15], s42 offen lds
    s_add_u32 m0, s43, 16384
    s_nop 0
    buffer_load_dwordx4 v20, s[12:15], s42 offen lds
    s_add_u32 m0, s43, 20480
    s_nop 0
    buffer_load_dwordx4 v21, s[12:15], s42 offen lds
    s_waitcnt vmcnt(24)
    s_barrier
    s_mov_b32 s42, 3200
    s_add_u32 m0, s43, 24576
    s_nop 0
    buffer_load_dwordx4 v16, s[8:11], s42 offen lds
    s_add_u32 m0, s43, 28672
    s_nop 0
    buffer_load_dwordx4 v17, s[8:11], s42 offen lds
    s_add_u32 m0, s43, 32768
    s_nop 0
    buffer_load_dwordx4 v18, s[12:15], s42 offen lds
    s_add_u32 m0, s43, 36864
    s_nop 0
    buffer_load_dwordx4 v19, s[12:15], s42 offen lds
    s_add_u32 m0, s43, 40960
    s_nop 0
    buffer_load_dwordx4 v20, s[12:15], s42 offen lds
    s_add_u32 m0, s43, 45056
    s_nop 0
    buffer_load_dwordx4 v21, s[12:15], s42 offen lds
    s_waitcnt vmcnt(24)
    s_barrier
    s_mov_b32 s42, 3328
    s_add_u32 m0, s43, 49152
    s_nop 0
    buffer_load_dwordx4 v16, s[8:11], s42 offen lds
    s_add_u32 m0, s43, 53248
    s_nop 0
    buffer_load_dwordx4 v17, s[8:11], s42 offen lds
    s_add_u32 m0, s43, 57344
    s_nop 0
    buffer_load_dwordx4 v18, s[12:15], s42 offen lds
    s_add_u32 m0, s43, 61440
    s_nop 0
    buffer_load_dwordx4 v19, s[12:15], s42 offen lds
    s_add_u32 m0, s43, 65536
    s_nop 0
    buffer_load_dwordx4 v20, s[12:15], s42 offen lds
    s_add_u32 m0, s43, 69632
    s_nop 0
    buffer_load_dwordx4 v21, s[12:15], s42 offen lds
    s_waitcnt vmcnt(24)
    s_barrier
    s_mov_b32 s42, 3456
    s_add_u32 m0, s43, 73728
    s_nop 0
    buffer_load_dwordx4 v16, s[8:11], s42 offen lds
    s_add_u32 m0, s43, 77824
    s_nop 0
    buffer_load_dwordx4 v17, s[8:11], s42 offen lds
    s_add_u32 m0, s43, 81920
    s_nop 0
    buffer_load_dwordx4 v18, s[12:15], s42 offen lds
    s_add_u32 m0, s43, 86016
    s_nop 0
    buffer_load_dwordx4 v19, s[12:15], s42 offen lds
    s_add_u32 m0, s43, 90112
    s_nop 0
    buffer_load_dwordx4 v20, s[12:15], s42 offen lds
    s_add_u32 m0, s43, 94208
    s_nop 0
    buffer_load_dwordx4 v21, s[12:15], s42 offen lds
    s_waitcnt vmcnt(24)
    s_barrier
    s_mov_b32 s42, 3584
    s_add_u32 m0, s43, 98304
    s_nop 0
    buffer_load_dwordx4 v16, s[8:11], s42 offen lds
    s_add_u32 m0, s43, 102400
    s_nop 0
    buffer_load_dwordx4 v17, s[8:11], s42 offen lds
    s_add_u32 m0, s43, 106496
    s_nop 0
    buffer_load_dwordx4 v18, s[12:15], s42 offen lds
    s_add_u32 m0, s43, 110592
    s_nop 0
    buffer_load_dwordx4 v19, s[12:15], s42 offen lds
    s_add_u32 m0, s43, 114688
    s_nop 0
    buffer_load_dwordx4 v20, s[12:15], s42 offen lds
    s_add_u32 m0, s43, 118784
    s_nop 0
    buffer_load_dwordx4 v21, s[12:15], s42 offen lds
    s_waitcnt vmcnt(24)
    s_barrier
    s_mov_b32 s42, 3712
    s_add_u32 m0, s43, 122880
    s_nop 0
    buffer_load_dwordx4 v16, s[8:11], s42 offen lds
    s_add_u32 m0, s43, 126976
    s_nop 0
    buffer_load_dwordx4 v17, s[8:11], s42 offen lds
    s_add_u32 m0, s43, 131072
    s_nop 0
    buffer_load_dwordx4 v18, s[12:15], s42 offen lds
    s_add_u32 m0, s43, 135168
    s_nop 0
    buffer_load_dwordx4 v19, s[12:15], s42 offen lds
    s_add_u32 m0, s43, 139264
    s_nop 0
    buffer_load_dwordx4 v20, s[12:15], s42 offen lds
    s_add_u32 m0, s43, 143360
    s_nop 0
    buffer_load_dwordx4 v21, s[12:15], s42 offen lds
    s_waitcnt vmcnt(24)
    s_barrier
    s_mov_b32 s42, 3840
    s_add_u32 m0, s43, 0
    s_nop 0
    buffer_load_dwordx4 v16, s[8:11], s42 offen lds
    s_add_u32 m0, s43, 4096
    s_nop 0
    buffer_load_dwordx4 v17, s[8:11], s42 offen lds
    s_add_u32 m0, s43, 8192
    s_nop 0
    buffer_load_dwordx4 v18, s[12:15], s42 offen lds
    s_add_u32 m0, s43, 12288
    s_nop 0
    buffer_load_dwordx4 v19, s[12:15], s42 offen lds
    s_add_u32 m0, s43, 16384
    s_nop 0
    buffer_load_dwordx4 v20, s[12:15], s42 offen lds
    s_add_u32 m0, s43, 20480
    s_nop 0
    buffer_load_dwordx4 v21, s[12:15], s42 offen lds
    s_waitcnt vmcnt(24)
    s_barrier
    s_mov_b32 s42, 3968
    s_add_u32 m0, s43, 24576
    s_nop 0
    buffer_load_dwordx4 v16, s[8:11], s42 offen lds
    s_add_u32 m0, s43, 28672
    s_nop 0
    buffer_load_dwordx4 v17, s[8:11], s42 offen lds
    s_add_u32 m0, s43, 32768
    s_nop 0
    buffer_load_dwordx4 v18, s[12:15], s42 offen lds
    s_add_u32 m0, s43, 36864
    s_nop 0
    buffer_load_dwordx4 v19, s[12:15], s42 offen lds
    s_add_u32 m0, s43, 40960
    s_nop 0
    buffer_load_dwordx4 v20, s[12:15], s42 offen lds
    s_add_u32 m0, s43, 45056
    s_nop 0
    buffer_load_dwordx4 v21, s[12:15], s42 offen lds
    s_waitcnt vmcnt(24)
    s_barrier
    s_waitcnt vmcnt(18)
    s_barrier
    s_waitcnt vmcnt(12)
    s_barrier
    s_waitcnt vmcnt(6)
    s_barrier
    s_waitcnt vmcnt(0)
    s_barrier
    s_endpgm
gemm2_comp:
    v_and_b32 v8, 31, v0
    v_bfe_u32 v9, v0, 5, 1
    s_lshr_b32 s29, s28, 1
    s_and_b32 s35, s28, 1
    v_and_b32 v10, 7, v0
    v_lshlrev_b32 v11, 7, v8
    s_mul_i32 s44, s29, 4096
    s_mul_i32 s45, s35, 8192
    s_add_u32 s45, s45, 8192
    v_lshl_add_u32 v12, v9, 2, 0
    v_xor_b32 v12, v12, v10
    v_lshl_add_u32 v12, v12, 4, v11
    v_add_u32 v32, s44, v12
    v_add_u32 v36, s45, v12
    v_add_u32 v40, 49152, v32
    v_add_u32 v44, 49152, v36
    v_add_u32 v48, 98304, v32
    v_add_u32 v52, 98304, v36
    v_lshl_add_u32 v12, v9, 2, 1
    v_xor_b32 v12, v12, v10
    v_lshl_add_u32 v12, v12, 4, v11
    v_add_u32 v33, s44, v12
    v_add_u32 v37, s45, v12
    v_add_u32 v41, 49152, v33
    v_add_u32 v45, 49152, v37
    v_add_u32 v49, 98304, v33
    v_add_u32 v53, 98304, v37
    v_lshl_add_u32 v12, v9, 2, 2
    v_xor_b32 v12, v12, v10
    v_lshl_add_u32 v12, v12, 4, v11
    v_add_u32 v34, s44, v12
    v_add_u32 v38, s45, v12
    v_add_u32 v42, 49152, v34
    v_add_u32 v46, 49152, v38
    v_add_u32 v50, 98304, v34
    v_add_u32 v54, 98304, v38
    v_lshl_add_u32 v12, v9, 2, 3
    v_xor_b32 v12, v12, v10
    v_lshl_add_u32 v12, v12, 4, v11
    v_add_u32 v35, s44, v12
    v_add_u32 v39, s45, v12
    v_add_u32 v43, 49152, v35
    v_add_u32 v47, 49152, v39
    v_add_u32 v51, 98304, v35
    v_add_u32 v55, 98304, v39
    v_mov_b32 v64, 0
    v_mov_b32 v65, 0
    v_mov_b32 v66, 0
    v_mov_b32 v67, 0
    v_mov_b32 v68, 0
    v_mov_b32 v69, 0
    v_mov_b32 v70, 0
    v_mov_b32 v71, 0
    v_mov_b32 v72, 0
    v_mov_b32 v73, 0
    v_mov_b32 v74, 0
    v_mov_b32 v75, 0
    v_mov_b32 v76, 0
    v_mov_b32 v77, 0
    v_mov_b32 v78, 0
    v_mov_b32 v79, 0
    v_mov_b32 v80, 0
    v_mov_b32 v81, 0
    v_mov_b32 v82, 0
    v_mov_b32 v83, 0
    v_mov_b32 v84, 0
    v_mov_b32 v85, 0
    v_mov_b32 v86, 0
    v_mov_b32 v87, 0
    v_mov_b32 v88, 0
    v_mov_b32 v89, 0
    v_mov_b32 v90, 0
    v_mov_b32 v91, 0
    v_mov_b32 v92, 0
    v_mov_b32 v93, 0
    v_mov_b32 v94, 0
    v_mov_b32 v95, 0
    s_barrier
    ds_read_b128 v[128:131], v32 offset:0
    ds_read_b128 v[144:147], v36 offset:0
    ds_read_b128 v[148:151], v36 offset:4096
    ds_read_b128 v[132:135], v33 offset:0
    ds_read_b128 v[152:155], v37 offset:0
    ds_read_b128 v[156:159], v37 offset:4096
    ds_read_b128 v[136:139], v34 offset:0
    ds_read_b128 v[160:163], v38 offset:0
    ds_read_b128 v[164:167], v38 offset:4096
    ds_read_b128 v[140:143], v35 offset:0
    ds_read_b128 v[168:171], v39 offset:0
    ds_read_b128 v[172:175], v39 offset:4096
    s_waitcnt lgkmcnt(9)
    v_mfma_f32_32x32x16_bf16 v[64:79], v[128:131], v[144:147], v[64:79]
    v_mfma_f32_32x32x16_bf16 v[80:95], v[128:131], v[148:151], v[80:95]
    s_waitcnt lgkmcnt(6)
    v_mfma_f32_32x32x16_bf16 v[64:79], v[132:135], v[152:155], v[64:79]
    v_mfma_f32_32x32x16_bf16 v[80:95], v[132:135], v[156:159], v[80:95]
    s_waitcnt lgkmcnt(3)
    v_mfma_f32_32x32x16_bf16 v[64:79], v[136:139], v[160:163], v[64:79]
    v_mfma_f32_32x32x16_bf16 v[80:95], v[136:139], v[164:167], v[80:95]
    s_waitcnt lgkmcnt(0)
    v_mfma_f32_32x32x16_bf16 v[64:79], v[140:143], v[168:171], v[64:79]
    v_mfma_f32_32x32x16_bf16 v[80:95], v[140:143], v[172:175], v[80:95]
    s_barrier
    ds_read_b128 v[128:131], v32 offset:24576
    ds_read_b128 v[144:147], v36 offset:24576
    ds_read_b128 v[148:151], v36 offset:28672
    ds_read_b128 v[132:135], v33 offset:24576
    ds_read_b128 v[152:155], v37 offset:24576
    ds_read_b128 v[156:159], v37 offset:28672
    ds_read_b128 v[136:139], v34 offset:24576
    ds_read_b128 v[160:163], v38 offset:24576
    ds_read_b128 v[164:167], v38 offset:28672
    ds_read_b128 v[140:143], v35 offset:24576
    ds_read_b128 v[168:171], v39 offset:24576
    ds_read_b128 v[172:175], v39 offset:28672
    s_waitcnt lgkmcnt(9)
    v_mfma_f32_32x32x16_bf16 v[64:79], v[128:131], v[144:147], v[64:79]
    v_mfma_f32_32x32x16_bf16 v[80:95], v[128:131], v[148:151], v[80:95]
    s_waitcnt lgkmcnt(6)
    v_mfma_f32_32x32x16_bf16 v[64:79], v[132:135], v[152:155], v[64:79]
    v_mfma_f32_32x32x16_bf16 v[80:95], v[132:135], v[156:159], v[80:95]
    s_waitcnt lgkmcnt(3)
    v_mfma_f32_32x32x16_bf16 v[64:79], v[136:139], v[160:163], v[64:79]
    v_mfma_f32_32x32x16_bf16 v[80:95], v[136:139], v[164:167], v[80:95]
    s_waitcnt lgkmcnt(0)
    v_mfma_f32_32x32x16_bf16 v[64:79], v[140:143], v[168:171], v[64:79]
    v_mfma_f32_32x32x16_bf16 v[80:95], v[140:143], v[172:175], v[80:95]
    s_barrier
    ds_read_b128 v[128:131], v40 offset:0
    ds_read_b128 v[144:147], v44 offset:0
    ds_read_b128 v[148:151], v44 offset:4096
    ds_read_b128 v[132:135], v41 offset:0
    ds_read_b128 v[152:155], v45 offset:0
    ds_read_b128 v[156:159], v45 offset:4096
    ds_read_b128 v[136:139], v42 offset:0
    ds_read_b128 v[160:163], v46 offset:0
    ds_read_b128 v[164:167], v46 offset:4096
    ds_read_b128 v[140:143], v43 offset:0
    ds_read_b128 v[168:171], v47 offset:0
    ds_read_b128 v[172:175], v47 offset:4096
    s_waitcnt lgkmcnt(9)
    v_mfma_f32_32x32x16_bf16 v[64:79], v[128:131], v[144:147], v[64:79]
    v_mfma_f32_32x32x16_bf16 v[80:95], v[128:131], v[148:151], v[80:95]
    s_waitcnt lgkmcnt(6)
    v_mfma_f32_32x32x16_bf16 v[64:79], v[132:135], v[152:155], v[64:79]
    v_mfma_f32_32x32x16_bf16 v[80:95], v[132:135], v[156:159], v[80:95]
    s_waitcnt lgkmcnt(3)
    v_mfma_f32_32x32x16_bf16 v[64:79], v[136:139], v[160:163], v[64:79]
    v_mfma_f32_32x32x16_bf16 v[80:95], v[136:139], v[164:167], v[80:95]
    s_waitcnt lgkmcnt(0)
    v_mfma_f32_32x32x16_bf16 v[64:79], v[140:143], v[168:171], v[64:79]
    v_mfma_f32_32x32x16_bf16 v[80:95], v[140:143], v[172:175], v[80:95]
    s_barrier
    ds_read_b128 v[128:131], v40 offset:24576
    ds_read_b128 v[144:147], v44 offset:24576
    ds_read_b128 v[148:151], v44 offset:28672
    ds_read_b128 v[132:135], v41 offset:24576
    ds_read_b128 v[152:155], v45 offset:24576
    ds_read_b128 v[156:159], v45 offset:28672
    ds_read_b128 v[136:139], v42 offset:24576
    ds_read_b128 v[160:163], v46 offset:24576
    ds_read_b128 v[164:167], v46 offset:28672
    ds_read_b128 v[140:143], v43 offset:24576
    ds_read_b128 v[168:171], v47 offset:24576
    ds_read_b128 v[172:175], v47 offset:28672
    s_waitcnt lgkmcnt(9)
    v_mfma_f32_32x32x16_bf16 v[64:79], v[128:131], v[144:147], v[64:79]
    v_mfma_f32_32x32x16_bf16 v[80:95], v[128:131], v[148:151], v[80:95]
    s_waitcnt lgkmcnt(6)
    v_mfma_f32_32x32x16_bf16 v[64:79], v[132:135], v[152:155], v[64:79]
    v_mfma_f32_32x32x16_bf16 v[80:95], v[132:135], v[156:159], v[80:95]
    s_waitcnt lgkmcnt(3)
    v_mfma_f32_32x32x16_bf16 v[64:79], v[136:139], v[160:163], v[64:79]
    v_mfma_f32_32x32x16_bf16 v[80:95], v[136:139], v[164:167], v[80:95]
    s_waitcnt lgkmcnt(0)
    v_mfma_f32_32x32x16_bf16 v[64:79], v[140:143], v[168:171], v[64:79]
    v_mfma_f32_32x32x16_bf16 v[80:95], v[140:143], v[172:175], v[80:95]
    s_barrier
    ds_read_b128 v[128:131], v48 offset:0
    ds_read_b128 v[144:147], v52 offset:0
    ds_read_b128 v[148:151], v52 offset:4096
    ds_read_b128 v[132:135], v49 offset:0
    ds_read_b128 v[152:155], v53 offset:0
    ds_read_b128 v[156:159], v53 offset:4096
    ds_read_b128 v[136:139], v50 offset:0
    ds_read_b128 v[160:163], v54 offset:0
    ds_read_b128 v[164:167], v54 offset:4096
    ds_read_b128 v[140:143], v51 offset:0
    ds_read_b128 v[168:171], v55 offset:0
    ds_read_b128 v[172:175], v55 offset:4096
    s_waitcnt lgkmcnt(9)
    v_mfma_f32_32x32x16_bf16 v[64:79], v[128:131], v[144:147], v[64:79]
    v_mfma_f32_32x32x16_bf16 v[80:95], v[128:131], v[148:151], v[80:95]
    s_waitcnt lgkmcnt(6)
    v_mfma_f32_32x32x16_bf16 v[64:79], v[132:135], v[152:155], v[64:79]
    v_mfma_f32_32x32x16_bf16 v[80:95], v[132:135], v[156:159], v[80:95]
    s_waitcnt lgkmcnt(3)
    v_mfma_f32_32x32x16_bf16 v[64:79], v[136:139], v[160:163], v[64:79]
    v_mfma_f32_32x32x16_bf16 v[80:95], v[136:139], v[164:167], v[80:95]
    s_waitcnt lgkmcnt(0)
    v_mfma_f32_32x32x16_bf16 v[64:79], v[140:143], v[168:171], v[64:79]
    v_mfma_f32_32x32x16_bf16 v[80:95], v[140:143], v[172:175], v[80:95]
    s_barrier
    ds_read_b128 v[128:131], v48 offset:24576
    ds_read_b128 v[144:147], v52 offset:24576
    ds_read_b128 v[148:151], v52 offset:28672
    ds_read_b128 v[132:135], v49 offset:24576
    ds_read_b128 v[152:155], v53 offset:24576
    ds_read_b128 v[156:159], v53 offset:28672
    ds_read_b128 v[136:139], v50 offset:24576
    ds_read_b128 v[160:163], v54 offset:24576
    ds_read_b128 v[164:167], v54 offset:28672
    ds_read_b128 v[140:143], v51 offset:24576
    ds_read_b128 v[168:171], v55 offset:24576
    ds_read_b128 v[172:175], v55 offset:28672
    s_waitcnt lgkmcnt(9)
    v_mfma_f32_32x32x16_bf16 v[64:79], v[128:131], v[144:147], v[64:79]
    v_mfma_f32_32x32x16_bf16 v[80:95], v[128:131], v[148:151], v[80:95]
    s_waitcnt lgkmcnt(6)
    v_mfma_f32_32x32x16_bf16 v[64:79], v[132:135], v[152:155], v[64:79]
    v_mfma_f32_32x32x16_bf16 v[80:95], v[132:135], v[156:159], v[80:95]
    s_waitcnt lgkmcnt(3)
    v_mfma_f32_32x32x16_bf16 v[64:79], v[136:139], v[160:163], v[64:79]
    v_mfma_f32_32x32x16_bf16 v[80:95], v[136:139], v[164:167], v[80:95]
    s_waitcnt lgkmcnt(0)
    v_mfma_f32_32x32x16_bf16 v[64:79], v[140:143], v[168:171], v[64:79]
    v_mfma_f32_32x32x16_bf16 v[80:95], v[140:143], v[172:175], v[80:95]
    s_barrier
    ds_read_b128 v[128:131], v32 offset:0
    ds_read_b128 v[144:147], v36 offset:0
    ds_read_b128 v[148:151], v36 offset:4096
    ds_read_b128 v[132:135], v33 offset:0
    ds_read_b128 v[152:155], v37 offset:0
    ds_read_b128 v[156:159], v37 offset:4096
    ds_read_b128 v[136:139], v34 offset:0
    ds_read_b128 v[160:163], v38 offset:0
    ds_read_b128 v[164:167], v38 offset:4096
    ds_read_b128 v[140:143], v35 offset:0
    ds_read_b128 v[168:171], v39 offset:0
    ds_read_b128 v[172:175], v39 offset:4096
    s_waitcnt lgkmcnt(9)
    v_mfma_f32_32x32x16_bf16 v[64:79], v[128:131], v[144:147], v[64:79]
    v_mfma_f32_32x32x16_bf16 v[80:95], v[128:131], v[148:151], v[80:95]
    s_waitcnt lgkmcnt(6)
    v_mfma_f32_32x32x16_bf16 v[64:79], v[132:135], v[152:155], v[64:79]
    v_mfma_f32_32x32x16_bf16 v[80:95], v[132:135], v[156:159], v[80:95]
    s_waitcnt lgkmcnt(3)
    v_mfma_f32_32x32x16_bf16 v[64:79], v[136:139], v[160:163], v[64:79]
    v_mfma_f32_32x32x16_bf16 v[80:95], v[136:139], v[164:167], v[80:95]
    s_waitcnt lgkmcnt(0)
    v_mfma_f32_32x32x16_bf16 v[64:79], v[140:143], v[168:171], v[64:79]
    v_mfma_f32_32x32x16_bf16 v[80:95], v[140:143], v[172:175], v[80:95]
    s_barrier
    ds_read_b128 v[128:131], v32 offset:24576
    ds_read_b128 v[144:147], v36 offset:24576
    ds_read_b128 v[148:151], v36 offset:28672
    ds_read_b128 v[132:135], v33 offset:24576
    ds_read_b128 v[152:155], v37 offset:24576
    ds_read_b128 v[156:159], v37 offset:28672
    ds_read_b128 v[136:139], v34 offset:24576
    ds_read_b128 v[160:163], v38 offset:24576
    ds_read_b128 v[164:167], v38 offset:28672
    ds_read_b128 v[140:143], v35 offset:24576
    ds_read_b128 v[168:171], v39 offset:24576
    ds_read_b128 v[172:175], v39 offset:28672
    s_waitcnt lgkmcnt(9)
    v_mfma_f32_32x32x16_bf16 v[64:79], v[128:131], v[144:147], v[64:79]
    v_mfma_f32_32x32x16_bf16 v[80:95], v[128:131], v[148:151], v[80:95]
    s_waitcnt lgkmcnt(6)
    v_mfma_f32_32x32x16_bf16 v[64:79], v[132:135], v[152:155], v[64:79]
    v_mfma_f32_32x32x16_bf16 v[80:95], v[132:135], v[156:159], v[80:95]
    s_waitcnt lgkmcnt(3)
    v_mfma_f32_32x32x16_bf16 v[64:79], v[136:139], v[160:163], v[64:79]
    v_mfma_f32_32x32x16_bf16 v[80:95], v[136:139], v[164:167], v[80:95]
    s_waitcnt lgkmcnt(0)
    v_mfma_f32_32x32x16_bf16 v[64:79], v[140:143], v[168:171], v[64:79]
    v_mfma_f32_32x32x16_bf16 v[80:95], v[140:143], v[172:175], v[80:95]
    s_barrier
    ds_read_b128 v[128:131], v40 offset:0
    ds_read_b128 v[144:147], v44 offset:0
    ds_read_b128 v[148:151], v44 offset:4096
    ds_read_b128 v[132:135], v41 offset:0
    ds_read_b128 v[152:155], v45 offset:0
    ds_read_b128 v[156:159], v45 offset:4096
    ds_read_b128 v[136:139], v42 offset:0
    ds_read_b128 v[160:163], v46 offset:0
    ds_read_b128 v[164:167], v46 offset:4096
    ds_read_b128 v[140:143], v43 offset:0
    ds_read_b128 v[168:171], v47 offset:0
    ds_read_b128 v[172:175], v47 offset:4096
    s_waitcnt lgkmcnt(9)
    v_mfma_f32_32x32x16_bf16 v[64:79], v[128:131], v[144:147], v[64:79]
    v_mfma_f32_32x32x16_bf16 v[80:95], v[128:131], v[148:151], v[80:95]
    s_waitcnt lgkmcnt(6)
    v_mfma_f32_32x32x16_bf16 v[64:79], v[132:135], v[152:155], v[64:79]
    v_mfma_f32_32x32x16_bf16 v[80:95], v[132:135], v[156:159], v[80:95]
    s_waitcnt lgkmcnt(3)
    v_mfma_f32_32x32x16_bf16 v[64:79], v[136:139], v[160:163], v[64:79]
    v_mfma_f32_32x32x16_bf16 v[80:95], v[136:139], v[164:167], v[80:95]
    s_waitcnt lgkmcnt(0)
    v_mfma_f32_32x32x16_bf16 v[64:79], v[140:143], v[168:171], v[64:79]
    v_mfma_f32_32x32x16_bf16 v[80:95], v[140:143], v[172:175], v[80:95]
    s_barrier
    ds_read_b128 v[128:131], v40 offset:24576
    ds_read_b128 v[144:147], v44 offset:24576
    ds_read_b128 v[148:151], v44 offset:28672
    ds_read_b128 v[132:135], v41 offset:24576
    ds_read_b128 v[152:155], v45 offset:24576
    ds_read_b128 v[156:159], v45 offset:28672
    ds_read_b128 v[136:139], v42 offset:24576
    ds_read_b128 v[160:163], v46 offset:24576
    ds_read_b128 v[164:167], v46 offset:28672
    ds_read_b128 v[140:143], v43 offset:24576
    ds_read_b128 v[168:171], v47 offset:24576
    ds_read_b128 v[172:175], v47 offset:28672
    s_waitcnt lgkmcnt(9)
    v_mfma_f32_32x32x16_bf16 v[64:79], v[128:131], v[144:147], v[64:79]
    v_mfma_f32_32x32x16_bf16 v[80:95], v[128:131], v[148:151], v[80:95]
    s_waitcnt lgkmcnt(6)
    v_mfma_f32_32x32x16_bf16 v[64:79], v[132:135], v[152:155], v[64:79]
    v_mfma_f32_32x32x16_bf16 v[80:95], v[132:135], v[156:159], v[80:95]
    s_waitcnt lgkmcnt(3)
    v_mfma_f32_32x32x16_bf16 v[64:79], v[136:139], v[160:163], v[64:79]
    v_mfma_f32_32x32x16_bf16 v[80:95], v[136:139], v[164:167], v[80:95]
    s_waitcnt lgkmcnt(0)
    v_mfma_f32_32x32x16_bf16 v[64:79], v[140:143], v[168:171], v[64:79]
    v_mfma_f32_32x32x16_bf16 v[80:95], v[140:143], v[172:175], v[80:95]
    s_barrier
    ds_read_b128 v[128:131], v48 offset:0
    ds_read_b128 v[144:147], v52 offset:0
    ds_read_b128 v[148:151], v52 offset:4096
    ds_read_b128 v[132:135], v49 offset:0
    ds_read_b128 v[152:155], v53 offset:0
    ds_read_b128 v[156:159], v53 offset:4096
    ds_read_b128 v[136:139], v50 offset:0
    ds_read_b128 v[160:163], v54 offset:0
    ds_read_b128 v[164:167], v54 offset:4096
    ds_read_b128 v[140:143], v51 offset:0
    ds_read_b128 v[168:171], v55 offset:0
    ds_read_b128 v[172:175], v55 offset:4096
    s_waitcnt lgkmcnt(9)
    v_mfma_f32_32x32x16_bf16 v[64:79], v[128:131], v[144:147], v[64:79]
    v_mfma_f32_32x32x16_bf16 v[80:95], v[128:131], v[148:151], v[80:95]
    s_waitcnt lgkmcnt(6)
    v_mfma_f32_32x32x16_bf16 v[64:79], v[132:135], v[152:155], v[64:79]
    v_mfma_f32_32x32x16_bf16 v[80:95], v[132:135], v[156:159], v[80:95]
    s_waitcnt lgkmcnt(3)
    v_mfma_f32_32x32x16_bf16 v[64:79], v[136:139], v[160:163], v[64:79]
    v_mfma_f32_32x32x16_bf16 v[80:95], v[136:139], v[164:167], v[80:95]
    s_waitcnt lgkmcnt(0)
    v_mfma_f32_32x32x16_bf16 v[64:79], v[140:143], v[168:171], v[64:79]
    v_mfma_f32_32x32x16_bf16 v[80:95], v[140:143], v[172:175], v[80:95]
    s_barrier
    ds_read_b128 v[128:131], v48 offset:24576
    ds_read_b128 v[144:147], v52 offset:24576
    ds_read_b128 v[148:151], v52 offset:28672
    ds_read_b128 v[132:135], v49 offset:24576
    ds_read_b128 v[152:155], v53 offset:24576
    ds_read_b128 v[156:159], v53 offset:28672
    ds_read_b128 v[136:139], v50 offset:24576
    ds_read_b128 v[160:163], v54 offset:24576
    ds_read_b128 v[164:167], v54 offset:28672
    ds_read_b128 v[140:143], v51 offset:24576
    ds_read_b128 v[168:171], v55 offset:24576
    ds_read_b128 v[172:175], v55 offset:28672
    s_waitcnt lgkmcnt(9)
    v_mfma_f32_32x32x16_bf16 v[64:79], v[128:131], v[144:147], v[64:79]
    v_mfma_f32_32x32x16_bf16 v[80:95], v[128:131], v[148:151], v[80:95]
    s_waitcnt lgkmcnt(6)
    v_mfma_f32_32x32x16_bf16 v[64:79], v[132:135], v[152:155], v[64:79]
    v_mfma_f32_32x32x16_bf16 v[80:95], v[132:135], v[156:159], v[80:95]
    s_waitcnt lgkmcnt(3)
    v_mfma_f32_32x32x16_bf16 v[64:79], v[136:139], v[160:163], v[64:79]
    v_mfma_f32_32x32x16_bf16 v[80:95], v[136:139], v[164:167], v[80:95]
    s_waitcnt lgkmcnt(0)
    v_mfma_f32_32x32x16_bf16 v[64:79], v[140:143], v[168:171], v[64:79]
    v_mfma_f32_32x32x16_bf16 v[80:95], v[140:143], v[172:175], v[80:95]
    s_barrier
    ds_read_b128 v[128:131], v32 offset:0
    ds_read_b128 v[144:147], v36 offset:0
    ds_read_b128 v[148:151], v36 offset:4096
    ds_read_b128 v[132:135], v33 offset:0
    ds_read_b128 v[152:155], v37 offset:0
    ds_read_b128 v[156:159], v37 offset:4096
    ds_read_b128 v[136:139], v34 offset:0
    ds_read_b128 v[160:163], v38 offset:0
    ds_read_b128 v[164:167], v38 offset:4096
    ds_read_b128 v[140:143], v35 offset:0
    ds_read_b128 v[168:171], v39 offset:0
    ds_read_b128 v[172:175], v39 offset:4096
    s_waitcnt lgkmcnt(9)
    v_mfma_f32_32x32x16_bf16 v[64:79], v[128:131], v[144:147], v[64:79]
    v_mfma_f32_32x32x16_bf16 v[80:95], v[128:131], v[148:151], v[80:95]
    s_waitcnt lgkmcnt(6)
    v_mfma_f32_32x32x16_bf16 v[64:79], v[132:135], v[152:155], v[64:79]
    v_mfma_f32_32x32x16_bf16 v[80:95], v[132:135], v[156:159], v[80:95]
    s_waitcnt lgkmcnt(3)
    v_mfma_f32_32x32x16_bf16 v[64:79], v[136:139], v[160:163], v[64:79]
    v_mfma_f32_32x32x16_bf16 v[80:95], v[136:139], v[164:167], v[80:95]
    s_waitcnt lgkmcnt(0)
    v_mfma_f32_32x32x16_bf16 v[64:79], v[140:143], v[168:171], v[64:79]
    v_mfma_f32_32x32x16_bf16 v[80:95], v[140:143], v[172:175], v[80:95]
    s_barrier
    ds_read_b128 v[128:131], v32 offset:24576
    ds_read_b128 v[144:147], v36 offset:24576
    ds_read_b128 v[148:151], v36 offset:28672
    ds_read_b128 v[132:135], v33 offset:24576
    ds_read_b128 v[152:155], v37 offset:24576
    ds_read_b128 v[156:159], v37 offset:28672
    ds_read_b128 v[136:139], v34 offset:24576
    ds_read_b128 v[160:163], v38 offset:24576
    ds_read_b128 v[164:167], v38 offset:28672
    ds_read_b128 v[140:143], v35 offset:24576
    ds_read_b128 v[168:171], v39 offset:24576
    ds_read_b128 v[172:175], v39 offset:28672
    s_waitcnt lgkmcnt(9)
    v_mfma_f32_32x32x16_bf16 v[64:79], v[128:131], v[144:147], v[64:79]
    v_mfma_f32_32x32x16_bf16 v[80:95], v[128:131], v[148:151], v[80:95]
    s_waitcnt lgkmcnt(6)
    v_mfma_f32_32x32x16_bf16 v[64:79], v[132:135], v[152:155], v[64:79]
    v_mfma_f32_32x32x16_bf16 v[80:95], v[132:135], v[156:159], v[80:95]
    s_waitcnt lgkmcnt(3)
    v_mfma_f32_32x32x16_bf16 v[64:79], v[136:139], v[160:163], v[64:79]
    v_mfma_f32_32x32x16_bf16 v[80:95], v[136:139], v[164:167], v[80:95]
    s_waitcnt lgkmcnt(0)
    v_mfma_f32_32x32x16_bf16 v[64:79], v[140:143], v[168:171], v[64:79]
    v_mfma_f32_32x32x16_bf16 v[80:95], v[140:143], v[172:175], v[80:95]
    s_barrier
    ds_read_b128 v[128:131], v40 offset:0
    ds_read_b128 v[144:147], v44 offset:0
    ds_read_b128 v[148:151], v44 offset:4096
    ds_read_b128 v[132:135], v41 offset:0
    ds_read_b128 v[152:155], v45 offset:0
    ds_read_b128 v[156:159], v45 offset:4096
    ds_read_b128 v[136:139], v42 offset:0
    ds_read_b128 v[160:163], v46 offset:0
    ds_read_b128 v[164:167], v46 offset:4096
    ds_read_b128 v[140:143], v43 offset:0
    ds_read_b128 v[168:171], v47 offset:0
    ds_read_b128 v[172:175], v47 offset:4096
    s_waitcnt lgkmcnt(9)
    v_mfma_f32_32x32x16_bf16 v[64:79], v[128:131], v[144:147], v[64:79]
    v_mfma_f32_32x32x16_bf16 v[80:95], v[128:131], v[148:151], v[80:95]
    s_waitcnt lgkmcnt(6)
    v_mfma_f32_32x32x16_bf16 v[64:79], v[132:135], v[152:155], v[64:79]
    v_mfma_f32_32x32x16_bf16 v[80:95], v[132:135], v[156:159], v[80:95]
    s_waitcnt lgkmcnt(3)
    v_mfma_f32_32x32x16_bf16 v[64:79], v[136:139], v[160:163], v[64:79]
    v_mfma_f32_32x32x16_bf16 v[80:95], v[136:139], v[164:167], v[80:95]
    s_waitcnt lgkmcnt(0)
    v_mfma_f32_32x32x16_bf16 v[64:79], v[140:143], v[168:171], v[64:79]
    v_mfma_f32_32x32x16_bf16 v[80:95], v[140:143], v[172:175], v[80:95]
    s_barrier
    ds_read_b128 v[128:131], v40 offset:24576
    ds_read_b128 v[144:147], v44 offset:24576
    ds_read_b128 v[148:151], v44 offset:28672
    ds_read_b128 v[132:135], v41 offset:24576
    ds_read_b128 v[152:155], v45 offset:24576
    ds_read_b128 v[156:159], v45 offset:28672
    ds_read_b128 v[136:139], v42 offset:24576
    ds_read_b128 v[160:163], v46 offset:24576
    ds_read_b128 v[164:167], v46 offset:28672
    ds_read_b128 v[140:143], v43 offset:24576
    ds_read_b128 v[168:171], v47 offset:24576
    ds_read_b128 v[172:175], v47 offset:28672
    s_waitcnt lgkmcnt(9)
    v_mfma_f32_32x32x16_bf16 v[64:79], v[128:131], v[144:147], v[64:79]
    v_mfma_f32_32x32x16_bf16 v[80:95], v[128:131], v[148:151], v[80:95]
    s_waitcnt lgkmcnt(6)
    v_mfma_f32_32x32x16_bf16 v[64:79], v[132:135], v[152:155], v[64:79]
    v_mfma_f32_32x32x16_bf16 v[80:95], v[132:135], v[156:159], v[80:95]
    s_waitcnt lgkmcnt(3)
    v_mfma_f32_32x32x16_bf16 v[64:79], v[136:139], v[160:163], v[64:79]
    v_mfma_f32_32x32x16_bf16 v[80:95], v[136:139], v[164:167], v[80:95]
    s_waitcnt lgkmcnt(0)
    v_mfma_f32_32x32x16_bf16 v[64:79], v[140:143], v[168:171], v[64:79]
    v_mfma_f32_32x32x16_bf16 v[80:95], v[140:143], v[172:175], v[80:95]
    s_barrier
    ds_read_b128 v[128:131], v48 offset:0
    ds_read_b128 v[144:147], v52 offset:0
    ds_read_b128 v[148:151], v52 offset:4096
    ds_read_b128 v[132:135], v49 offset:0
    ds_read_b128 v[152:155], v53 offset:0
    ds_read_b128 v[156:159], v53 offset:4096
    ds_read_b128 v[136:139], v50 offset:0
    ds_read_b128 v[160:163], v54 offset:0
    ds_read_b128 v[164:167], v54 offset:4096
    ds_read_b128 v[140:143], v51 offset:0
    ds_read_b128 v[168:171], v55 offset:0
    ds_read_b128 v[172:175], v55 offset:4096
    s_waitcnt lgkmcnt(9)
    v_mfma_f32_32x32x16_bf16 v[64:79], v[128:131], v[144:147], v[64:79]
    v_mfma_f32_32x32x16_bf16 v[80:95], v[128:131], v[148:151], v[80:95]
    s_waitcnt lgkmcnt(6)
    v_mfma_f32_32x32x16_bf16 v[64:79], v[132:135], v[152:155], v[64:79]
    v_mfma_f32_32x32x16_bf16 v[80:95], v[132:135], v[156:159], v[80:95]
    s_waitcnt lgkmcnt(3)
    v_mfma_f32_32x32x16_bf16 v[64:79], v[136:139], v[160:163], v[64:79]
    v_mfma_f32_32x32x16_bf16 v[80:95], v[136:139], v[164:167], v[80:95]
    s_waitcnt lgkmcnt(0)
    v_mfma_f32_32x32x16_bf16 v[64:79], v[140:143], v[168:171], v[64:79]
    v_mfma_f32_32x32x16_bf16 v[80:95], v[140:143], v[172:175], v[80:95]
    s_barrier
    ds_read_b128 v[128:131], v48 offset:24576
    ds_read_b128 v[144:147], v52 offset:24576
    ds_read_b128 v[148:151], v52 offset:28672
    ds_read_b128 v[132:135], v49 offset:24576
    ds_read_b128 v[152:155], v53 offset:24576
    ds_read_b128 v[156:159], v53 offset:28672
    ds_read_b128 v[136:139], v50 offset:24576
    ds_read_b128 v[160:163], v54 offset:24576
    ds_read_b128 v[164:167], v54 offset:28672
    ds_read_b128 v[140:143], v51 offset:24576
    ds_read_b128 v[168:171], v55 offset:24576
    ds_read_b128 v[172:175], v55 offset:28672
    s_waitcnt lgkmcnt(9)
    v_mfma_f32_32x32x16_bf16 v[64:79], v[128:131], v[144:147], v[64:79]
    v_mfma_f32_32x32x16_bf16 v[80:95], v[128:131], v[148:151], v[80:95]
    s_waitcnt lgkmcnt(6)
    v_mfma_f32_32x32x16_bf16 v[64:79], v[132:135], v[152:155], v[64:79]
    v_mfma_f32_32x32x16_bf16 v[80:95], v[132:135], v[156:159], v[80:95]
    s_waitcnt lgkmcnt(3)
    v_mfma_f32_32x32x16_bf16 v[64:79], v[136:139], v[160:163], v[64:79]
    v_mfma_f32_32x32x16_bf16 v[80:95], v[136:139], v[164:167], v[80:95]
    s_waitcnt lgkmcnt(0)
    v_mfma_f32_32x32x16_bf16 v[64:79], v[140:143], v[168:171], v[64:79]
    v_mfma_f32_32x32x16_bf16 v[80:95], v[140:143], v[172:175], v[80:95]
    s_barrier
    ds_read_b128 v[128:131], v32 offset:0
    ds_read_b128 v[144:147], v36 offset:0
    ds_read_b128 v[148:151], v36 offset:4096
    ds_read_b128 v[132:135], v33 offset:0
    ds_read_b128 v[152:155], v37 offset:0
    ds_read_b128 v[156:159], v37 offset:4096
    ds_read_b128 v[136:139], v34 offset:0
    ds_read_b128 v[160:163], v38 offset:0
    ds_read_b128 v[164:167], v38 offset:4096
    ds_read_b128 v[140:143], v35 offset:0
    ds_read_b128 v[168:171], v39 offset:0
    ds_read_b128 v[172:175], v39 offset:4096
    s_waitcnt lgkmcnt(9)
    v_mfma_f32_32x32x16_bf16 v[64:79], v[128:131], v[144:147], v[64:79]
    v_mfma_f32_32x32x16_bf16 v[80:95], v[128:131], v[148:151], v[80:95]
    s_waitcnt lgkmcnt(6)
    v_mfma_f32_32x32x16_bf16 v[64:79], v[132:135], v[152:155], v[64:79]
    v_mfma_f32_32x32x16_bf16 v[80:95], v[132:135], v[156:159], v[80:95]
    s_waitcnt lgkmcnt(3)
    v_mfma_f32_32x32x16_bf16 v[64:79], v[136:139], v[160:163], v[64:79]
    v_mfma_f32_32x32x16_bf16 v[80:95], v[136:139], v[164:167], v[80:95]
    s_waitcnt lgkmcnt(0)
    v_mfma_f32_32x32x16_bf16 v[64:79], v[140:143], v[168:171], v[64:79]
    v_mfma_f32_32x32x16_bf16 v[80:95], v[140:143], v[172:175], v[80:95]
    s_barrier
    ds_read_b128 v[128:131], v32 offset:24576
    ds_read_b128 v[144:147], v36 offset:24576
    ds_read_b128 v[148:151], v36 offset:28672
    ds_read_b128 v[132:135], v33 offset:24576
    ds_read_b128 v[152:155], v37 offset:24576
    ds_read_b128 v[156:159], v37 offset:28672
    ds_read_b128 v[136:139], v34 offset:24576
    ds_read_b128 v[160:163], v38 offset:24576
    ds_read_b128 v[164:167], v38 offset:28672
    ds_read_b128 v[140:143], v35 offset:24576
    ds_read_b128 v[168:171], v39 offset:24576
    ds_read_b128 v[172:175], v39 offset:28672
    s_waitcnt lgkmcnt(9)
    v_mfma_f32_32x32x16_bf16 v[64:79], v[128:131], v[144:147], v[64:79]
    v_mfma_f32_32x32x16_bf16 v[80:95], v[128:131], v[148:151], v[80:95]
    s_waitcnt lgkmcnt(6)
    v_mfma_f32_32x32x16_bf16 v[64:79], v[132:135], v[152:155], v[64:79]
    v_mfma_f32_32x32x16_bf16 v[80:95], v[132:135], v[156:159], v[80:95]
    s_waitcnt lgkmcnt(3)
    v_mfma_f32_32x32x16_bf16 v[64:79], v[136:139], v[160:163], v[64:79]
    v_mfma_f32_32x32x16_bf16 v[80:95], v[136:139], v[164:167], v[80:95]
    s_waitcnt lgkmcnt(0)
    v_mfma_f32_32x32x16_bf16 v[64:79], v[140:143], v[168:171], v[64:79]
    v_mfma_f32_32x32x16_bf16 v[80:95], v[140:143], v[172:175], v[80:95]
    s_barrier
    ds_read_b128 v[128:131], v40 offset:0
    ds_read_b128 v[144:147], v44 offset:0
    ds_read_b128 v[148:151], v44 offset:4096
    ds_read_b128 v[132:135], v41 offset:0
    ds_read_b128 v[152:155], v45 offset:0
    ds_read_b128 v[156:159], v45 offset:4096
    ds_read_b128 v[136:139], v42 offset:0
    ds_read_b128 v[160:163], v46 offset:0
    ds_read_b128 v[164:167], v46 offset:4096
    ds_read_b128 v[140:143], v43 offset:0
    ds_read_b128 v[168:171], v47 offset:0
    ds_read_b128 v[172:175], v47 offset:4096
    s_waitcnt lgkmcnt(9)
    v_mfma_f32_32x32x16_bf16 v[64:79], v[128:131], v[144:147], v[64:79]
    v_mfma_f32_32x32x16_bf16 v[80:95], v[128:131], v[148:151], v[80:95]
    s_waitcnt lgkmcnt(6)
    v_mfma_f32_32x32x16_bf16 v[64:79], v[132:135], v[152:155], v[64:79]
    v_mfma_f32_32x32x16_bf16 v[80:95], v[132:135], v[156:159], v[80:95]
    s_waitcnt lgkmcnt(3)
    v_mfma_f32_32x32x16_bf16 v[64:79], v[136:139], v[160:163], v[64:79]
    v_mfma_f32_32x32x16_bf16 v[80:95], v[136:139], v[164:167], v[80:95]
    s_waitcnt lgkmcnt(0)
    v_mfma_f32_32x32x16_bf16 v[64:79], v[140:143], v[168:171], v[64:79]
    v_mfma_f32_32x32x16_bf16 v[80:95], v[140:143], v[172:175], v[80:95]
    s_barrier
    ds_read_b128 v[128:131], v40 offset:24576
    ds_read_b128 v[144:147], v44 offset:24576
    ds_read_b128 v[148:151], v44 offset:28672
    ds_read_b128 v[132:135], v41 offset:24576
    ds_read_b128 v[152:155], v45 offset:24576
    ds_read_b128 v[156:159], v45 offset:28672
    ds_read_b128 v[136:139], v42 offset:24576
    ds_read_b128 v[160:163], v46 offset:24576
    ds_read_b128 v[164:167], v46 offset:28672
    ds_read_b128 v[140:143], v43 offset:24576
    ds_read_b128 v[168:171], v47 offset:24576
    ds_read_b128 v[172:175], v47 offset:28672
    s_waitcnt lgkmcnt(9)
    v_mfma_f32_32x32x16_bf16 v[64:79], v[128:131], v[144:147], v[64:79]
    v_mfma_f32_32x32x16_bf16 v[80:95], v[128:131], v[148:151], v[80:95]
    s_waitcnt lgkmcnt(6)
    v_mfma_f32_32x32x16_bf16 v[64:79], v[132:135], v[152:155], v[64:79]
    v_mfma_f32_32x32x16_bf16 v[80:95], v[132:135], v[156:159], v[80:95]
    s_waitcnt lgkmcnt(3)
    v_mfma_f32_32x32x16_bf16 v[64:79], v[136:139], v[160:163], v[64:79]
    v_mfma_f32_32x32x16_bf16 v[80:95], v[136:139], v[164:167], v[80:95]
    s_waitcnt lgkmcnt(0)
    v_mfma_f32_32x32x16_bf16 v[64:79], v[140:143], v[168:171], v[64:79]
    v_mfma_f32_32x32x16_bf16 v[80:95], v[140:143], v[172:175], v[80:95]
    s_barrier
    ds_read_b128 v[128:131], v48 offset:0
    ds_read_b128 v[144:147], v52 offset:0
    ds_read_b128 v[148:151], v52 offset:4096
    ds_read_b128 v[132:135], v49 offset:0
    ds_read_b128 v[152:155], v53 offset:0
    ds_read_b128 v[156:159], v53 offset:4096
    ds_read_b128 v[136:139], v50 offset:0
    ds_read_b128 v[160:163], v54 offset:0
    ds_read_b128 v[164:167], v54 offset:4096
    ds_read_b128 v[140:143], v51 offset:0
    ds_read_b128 v[168:171], v55 offset:0
    ds_read_b128 v[172:175], v55 offset:4096
    s_waitcnt lgkmcnt(9)
    v_mfma_f32_32x32x16_bf16 v[64:79], v[128:131], v[144:147], v[64:79]
    v_mfma_f32_32x32x16_bf16 v[80:95], v[128:131], v[148:151], v[80:95]
    s_waitcnt lgkmcnt(6)
    v_mfma_f32_32x32x16_bf16 v[64:79], v[132:135], v[152:155], v[64:79]
    v_mfma_f32_32x32x16_bf16 v[80:95], v[132:135], v[156:159], v[80:95]
    s_waitcnt lgkmcnt(3)
    v_mfma_f32_32x32x16_bf16 v[64:79], v[136:139], v[160:163], v[64:79]
    v_mfma_f32_32x32x16_bf16 v[80:95], v[136:139], v[164:167], v[80:95]
    s_waitcnt lgkmcnt(0)
    v_mfma_f32_32x32x16_bf16 v[64:79], v[140:143], v[168:171], v[64:79]
    v_mfma_f32_32x32x16_bf16 v[80:95], v[140:143], v[172:175], v[80:95]
    s_barrier
    ds_read_b128 v[128:131], v48 offset:24576
    ds_read_b128 v[144:147], v52 offset:24576
    ds_read_b128 v[148:151], v52 offset:28672
    ds_read_b128 v[132:135], v49 offset:24576
    ds_read_b128 v[152:155], v53 offset:24576
    ds_read_b128 v[156:159], v53 offset:28672
    ds_read_b128 v[136:139], v50 offset:24576
    ds_read_b128 v[160:163], v54 offset:24576
    ds_read_b128 v[164:167], v54 offset:28672
    ds_read_b128 v[140:143], v51 offset:24576
    ds_read_b128 v[168:171], v55 offset:24576
    ds_read_b128 v[172:175], v55 offset:28672
    s_waitcnt lgkmcnt(9)
    v_mfma_f32_32x32x16_bf16 v[64:79], v[128:131], v[144:147], v[64:79]
    v_mfma_f32_32x32x16_bf16 v[80:95], v[128:131], v[148:151], v[80:95]
    s_waitcnt lgkmcnt(6)
    v_mfma_f32_32x32x16_bf16 v[64:79], v[132:135], v[152:155], v[64:79]
    v_mfma_f32_32x32x16_bf16 v[80:95], v[132:135], v[156:159], v[80:95]
    s_waitcnt lgkmcnt(3)
    v_mfma_f32_32x32x16_bf16 v[64:79], v[136:139], v[160:163], v[64:79]
    v_mfma_f32_32x32x16_bf16 v[80:95], v[136:139], v[164:167], v[80:95]
    s_waitcnt lgkmcnt(0)
    v_mfma_f32_32x32x16_bf16 v[64:79], v[140:143], v[168:171], v[64:79]
    v_mfma_f32_32x32x16_bf16 v[80:95], v[140:143], v[172:175], v[80:95]
    s_barrier
    ds_read_b128 v[128:131], v32 offset:0
    ds_read_b128 v[144:147], v36 offset:0
    ds_read_b128 v[148:151], v36 offset:4096
    ds_read_b128 v[132:135], v33 offset:0
    ds_read_b128 v[152:155], v37 offset:0
    ds_read_b128 v[156:159], v37 offset:4096
    ds_read_b128 v[136:139], v34 offset:0
    ds_read_b128 v[160:163], v38 offset:0
    ds_read_b128 v[164:167], v38 offset:4096
    ds_read_b128 v[140:143], v35 offset:0
    ds_read_b128 v[168:171], v39 offset:0
    ds_read_b128 v[172:175], v39 offset:4096
    s_waitcnt lgkmcnt(9)
    v_mfma_f32_32x32x16_bf16 v[64:79], v[128:131], v[144:147], v[64:79]
    v_mfma_f32_32x32x16_bf16 v[80:95], v[128:131], v[148:151], v[80:95]
    s_waitcnt lgkmcnt(6)
    v_mfma_f32_32x32x16_bf16 v[64:79], v[132:135], v[152:155], v[64:79]
    v_mfma_f32_32x32x16_bf16 v[80:95], v[132:135], v[156:159], v[80:95]
    s_waitcnt lgkmcnt(3)
    v_mfma_f32_32x32x16_bf16 v[64:79], v[136:139], v[160:163], v[64:79]
    v_mfma_f32_32x32x16_bf16 v[80:95], v[136:139], v[164:167], v[80:95]
    s_waitcnt lgkmcnt(0)
    v_mfma_f32_32x32x16_bf16 v[64:79], v[140:143], v[168:171], v[64:79]
    v_mfma_f32_32x32x16_bf16 v[80:95], v[140:143], v[172:175], v[80:95]
    s_barrier
    ds_read_b128 v[128:131], v32 offset:24576
    ds_read_b128 v[144:147], v36 offset:24576
    ds_read_b128 v[148:151], v36 offset:28672
    ds_read_b128 v[132:135], v33 offset:24576
    ds_read_b128 v[152:155], v37 offset:24576
    ds_read_b128 v[156:159], v37 offset:28672
    ds_read_b128 v[136:139], v34 offset:24576
    ds_read_b128 v[160:163], v38 offset:24576
    ds_read_b128 v[164:167], v38 offset:28672
    ds_read_b128 v[140:143], v35 offset:24576
    ds_read_b128 v[168:171], v39 offset:24576
    ds_read_b128 v[172:175], v39 offset:28672
    s_waitcnt lgkmcnt(9)
    v_mfma_f32_32x32x16_bf16 v[64:79], v[128:131], v[144:147], v[64:79]
    v_mfma_f32_32x32x16_bf16 v[80:95], v[128:131], v[148:151], v[80:95]
    s_waitcnt lgkmcnt(6)
    v_mfma_f32_32x32x16_bf16 v[64:79], v[132:135], v[152:155], v[64:79]
    v_mfma_f32_32x32x16_bf16 v[80:95], v[132:135], v[156:159], v[80:95]
    s_waitcnt lgkmcnt(3)
    v_mfma_f32_32x32x16_bf16 v[64:79], v[136:139], v[160:163], v[64:79]
    v_mfma_f32_32x32x16_bf16 v[80:95], v[136:139], v[164:167], v[80:95]
    s_waitcnt lgkmcnt(0)
    v_mfma_f32_32x32x16_bf16 v[64:79], v[140:143], v[168:171], v[64:79]
    v_mfma_f32_32x32x16_bf16 v[80:95], v[140:143], v[172:175], v[80:95]
    s_barrier
    ds_read_b128 v[128:131], v40 offset:0
    ds_read_b128 v[144:147], v44 offset:0
    ds_read_b128 v[148:151], v44 offset:4096
    ds_read_b128 v[132:135], v41 offset:0
    ds_read_b128 v[152:155], v45 offset:0
    ds_read_b128 v[156:159], v45 offset:4096
    ds_read_b128 v[136:139], v42 offset:0
    ds_read_b128 v[160:163], v46 offset:0
    ds_read_b128 v[164:167], v46 offset:4096
    ds_read_b128 v[140:143], v43 offset:0
    ds_read_b128 v[168:171], v47 offset:0
    ds_read_b128 v[172:175], v47 offset:4096
    s_waitcnt lgkmcnt(9)
    v_mfma_f32_32x32x16_bf16 v[64:79], v[128:131], v[144:147], v[64:79]
    v_mfma_f32_32x32x16_bf16 v[80:95], v[128:131], v[148:151], v[80:95]
    s_waitcnt lgkmcnt(6)
    v_mfma_f32_32x32x16_bf16 v[64:79], v[132:135], v[152:155], v[64:79]
    v_mfma_f32_32x32x16_bf16 v[80:95], v[132:135], v[156:159], v[80:95]
    s_waitcnt lgkmcnt(3)
    v_mfma_f32_32x32x16_bf16 v[64:79], v[136:139], v[160:163], v[64:79]
    v_mfma_f32_32x32x16_bf16 v[80:95], v[136:139], v[164:167], v[80:95]
    s_waitcnt lgkmcnt(0)
    v_mfma_f32_32x32x16_bf16 v[64:79], v[140:143], v[168:171], v[64:79]
    v_mfma_f32_32x32x16_bf16 v[80:95], v[140:143], v[172:175], v[80:95]
    s_barrier
    ds_read_b128 v[128:131], v40 offset:24576
    ds_read_b128 v[144:147], v44 offset:24576
    ds_read_b128 v[148:151], v44 offset:28672
    ds_read_b128 v[132:135], v41 offset:24576
    ds_read_b128 v[152:155], v45 offset:24576
    ds_read_b128 v[156:159], v45 offset:28672
    ds_read_b128 v[136:139], v42 offset:24576
    ds_read_b128 v[160:163], v46 offset:24576
    ds_read_b128 v[164:167], v46 offset:28672
    ds_read_b128 v[140:143], v43 offset:24576
    ds_read_b128 v[168:171], v47 offset:24576
    ds_read_b128 v[172:175], v47 offset:28672
    s_waitcnt lgkmcnt(9)
    v_mfma_f32_32x32x16_bf16 v[64:79], v[128:131], v[144:147], v[64:79]
    v_mfma_f32_32x32x16_bf16 v[80:95], v[128:131], v[148:151], v[80:95]
    s_waitcnt lgkmcnt(6)
    v_mfma_f32_32x32x16_bf16 v[64:79], v[132:135], v[152:155], v[64:79]
    v_mfma_f32_32x32x16_bf16 v[80:95], v[132:135], v[156:159], v[80:95]
    s_waitcnt lgkmcnt(3)
    v_mfma_f32_32x32x16_bf16 v[64:79], v[136:139], v[160:163], v[64:79]
    v_mfma_f32_32x32x16_bf16 v[80:95], v[136:139], v[164:167], v[80:95]
    s_waitcnt lgkmcnt(0)
    v_mfma_f32_32x32x16_bf16 v[64:79], v[140:143], v[168:171], v[64:79]
    v_mfma_f32_32x32x16_bf16 v[80:95], v[140:143], v[172:175], v[80:95]
    s_barrier
    ds_read_b128 v[128:131], v48 offset:0
    ds_read_b128 v[144:147], v52 offset:0
    ds_read_b128 v[148:151], v52 offset:4096
    ds_read_b128 v[132:135], v49 offset:0
    ds_read_b128 v[152:155], v53 offset:0
    ds_read_b128 v[156:159], v53 offset:4096
    ds_read_b128 v[136:139], v50 offset:0
    ds_read_b128 v[160:163], v54 offset:0
    ds_read_b128 v[164:167], v54 offset:4096
    ds_read_b128 v[140:143], v51 offset:0
    ds_read_b128 v[168:171], v55 offset:0
    ds_read_b128 v[172:175], v55 offset:4096
    s_waitcnt lgkmcnt(9)
    v_mfma_f32_32x32x16_bf16 v[64:79], v[128:131], v[144:147], v[64:79]
    v_mfma_f32_32x32x16_bf16 v[80:95], v[128:131], v[148:151], v[80:95]
    s_waitcnt lgkmcnt(6)
    v_mfma_f32_32x32x16_bf16 v[64:79], v[132:135], v[152:155], v[64:79]
    v_mfma_f32_32x32x16_bf16 v[80:95], v[132:135], v[156:159], v[80:95]
    s_waitcnt lgkmcnt(3)
    v_mfma_f32_32x32x16_bf16 v[64:79], v[136:139], v[160:163], v[64:79]
    v_mfma_f32_32x32x16_bf16 v[80:95], v[136:139], v[164:167], v[80:95]
    s_waitcnt lgkmcnt(0)
    v_mfma_f32_32x32x16_bf16 v[64:79], v[140:143], v[168:171], v[64:79]
    v_mfma_f32_32x32x16_bf16 v[80:95], v[140:143], v[172:175], v[80:95]
    s_barrier
    ds_read_b128 v[128:131], v48 offset:24576
    ds_read_b128 v[144:147], v52 offset:24576
    ds_read_b128 v[148:151], v52 offset:28672
    ds_read_b128 v[132:135], v49 offset:24576
    ds_read_b128 v[152:155], v53 offset:24576
    ds_read_b128 v[156:159], v53 offset:28672
    ds_read_b128 v[136:139], v50 offset:24576
    ds_read_b128 v[160:163], v54 offset:24576
    ds_read_b128 v[164:167], v54 offset:28672
    ds_read_b128 v[140:143], v51 offset:24576
    ds_read_b128 v[168:171], v55 offset:24576
    ds_read_b128 v[172:175], v55 offset:28672
    s_waitcnt lgkmcnt(9)
    v_mfma_f32_32x32x16_bf16 v[64:79], v[128:131], v[144:147], v[64:79]
    v_mfma_f32_32x32x16_bf16 v[80:95], v[128:131], v[148:151], v[80:95]
    s_waitcnt lgkmcnt(6)
    v_mfma_f32_32x32x16_bf16 v[64:79], v[132:135], v[152:155], v[64:79]
    v_mfma_f32_32x32x16_bf16 v[80:95], v[132:135], v[156:159], v[80:95]
    s_waitcnt lgkmcnt(3)
    v_mfma_f32_32x32x16_bf16 v[64:79], v[136:139], v[160:163], v[64:79]
    v_mfma_f32_32x32x16_bf16 v[80:95], v[136:139], v[164:167], v[80:95]
    s_waitcnt lgkmcnt(0)
    v_mfma_f32_32x32x16_bf16 v[64:79], v[140:143], v[168:171], v[64:79]
    v_mfma_f32_32x32x16_bf16 v[80:95], v[140:143], v[172:175], v[80:95]
    s_barrier
    ds_read_b128 v[128:131], v32 offset:0
    ds_read_b128 v[144:147], v36 offset:0
    ds_read_b128 v[148:151], v36 offset:4096
    ds_read_b128 v[132:135], v33 offset:0
    ds_read_b128 v[152:155], v37 offset:0
    ds_read_b128 v[156:159], v37 offset:4096
    ds_read_b128 v[136:139], v34 offset:0
    ds_read_b128 v[160:163], v38 offset:0
    ds_read_b128 v[164:167], v38 offset:4096
    ds_read_b128 v[140:143], v35 offset:0
    ds_read_b128 v[168:171], v39 offset:0
    ds_read_b128 v[172:175], v39 offset:4096
    s_waitcnt lgkmcnt(9)
    v_mfma_f32_32x32x16_bf16 v[64:79], v[128:131], v[144:147], v[64:79]
    v_mfma_f32_32x32x16_bf16 v[80:95], v[128:131], v[148:151], v[80:95]
    s_waitcnt lgkmcnt(6)
    v_mfma_f32_32x32x16_bf16 v[64:79], v[132:135], v[152:155], v[64:79]
    v_mfma_f32_32x32x16_bf16 v[80:95], v[132:135], v[156:159], v[80:95]
    s_waitcnt lgkmcnt(3)
    v_mfma_f32_32x32x16_bf16 v[64:79], v[136:139], v[160:163], v[64:79]
    v_mfma_f32_32x32x16_bf16 v[80:95], v[136:139], v[164:167], v[80:95]
    s_waitcnt lgkmcnt(0)
    v_mfma_f32_32x32x16_bf16 v[64:79], v[140:143], v[168:171], v[64:79]
    v_mfma_f32_32x32x16_bf16 v[80:95], v[140:143], v[172:175], v[80:95]
    s_barrier
    ds_read_b128 v[128:131], v32 offset:24576
    ds_read_b128 v[144:147], v36 offset:24576
    ds_read_b128 v[148:151], v36 offset:28672
    ds_read_b128 v[132:135], v33 offset:24576
    ds_read_b128 v[152:155], v37 offset:24576
    ds_read_b128 v[156:159], v37 offset:28672
    ds_read_b128 v[136:139], v34 offset:24576
    ds_read_b128 v[160:163], v38 offset:24576
    ds_read_b128 v[164:167], v38 offset:28672
    ds_read_b128 v[140:143], v35 offset:24576
    ds_read_b128 v[168:171], v39 offset:24576
    ds_read_b128 v[172:175], v39 offset:28672
    s_waitcnt lgkmcnt(9)
    v_mfma_f32_32x32x16_bf16 v[64:79], v[128:131], v[144:147], v[64:79]
    v_mfma_f32_32x32x16_bf16 v[80:95], v[128:131], v[148:151], v[80:95]
    s_waitcnt lgkmcnt(6)
    v_mfma_f32_32x32x16_bf16 v[64:79], v[132:135], v[152:155], v[64:79]
    v_mfma_f32_32x32x16_bf16 v[80:95], v[132:135], v[156:159], v[80:95]
    s_waitcnt lgkmcnt(3)
    v_mfma_f32_32x32x16_bf16 v[64:79], v[136:139], v[160:163], v[64:79]
    v_mfma_f32_32x32x16_bf16 v[80:95], v[136:139], v[164:167], v[80:95]
    s_waitcnt lgkmcnt(0)
    v_mfma_f32_32x32x16_bf16 v[64:79], v[140:143], v[168:171], v[64:79]
    v_mfma_f32_32x32x16_bf16 v[80:95], v[140:143], v[172:175], v[80:95]
    s_nop 15
    s_nop 7
    s_add_u32 s16, s36, 0xa00000
    s_addc_u32 s17, s37, 0
    s_mov_b32 s18, 0x380000
    s_mov_b32 s19, 0x00020000
    s_add_u32 s20, s36, 0x1800000
    s_addc_u32 s21, s37, 0
    s_mov_b32 s22, 0x380000
    s_mov_b32 s23, 0x00020000
    s_mov_b32 s24, s6
    s_mov_b32 s25, s7
    s_mov_b32 s26, 0x1000
    s_mov_b32 s27, 0x00020000
    s_mul_i32 s40, s35, 64
    s_add_u32 s40, s40, s33
    v_add_u32 v13, s40, v8
    s_mul_i32 s41, s29, 32
    s_add_u32 s41, s41, s32
    s_lshl_b32 s41, s41, 1
    v_mul_u32_u24 v14, 1792, v13
    v_lshl_add_u32 v14, v9, 3, v14
    v_add_u32 v14, s41, v14
    v_lshlrev_b32 v15, 1, v13
    buffer_load_ushort v16, v15, s[24:27], 0 offen offset:0
    v_add_u32 v6, 0, v14
    buffer_load_dwordx2 v[128:129], v6, s[16:19], 0 offen
    v_add_u32 v6, 16, v14
    buffer_load_dwordx2 v[130:131], v6, s[16:19], 0 offen
    v_add_u32 v6, 32, v14
    buffer_load_dwordx2 v[132:133], v6, s[16:19], 0 offen
    v_add_u32 v6, 48, v14
    buffer_load_dwordx2 v[134:135], v6, s[16:19], 0 offen
    buffer_load_ushort v17, v15, s[24:27], 0 offen offset:64
    v_add_u32 v6, 57344, v14
    buffer_load_dwordx2 v[136:137], v6, s[16:19], 0 offen
    v_add_u32 v6, 57360, v14
    buffer_load_dwordx2 v[138:139], v6, s[16:19], 0 offen
    v_add_u32 v6, 57376, v14
    buffer_load_dwordx2 v[140:141], v6, s[16:19], 0 offen
    v_add_u32 v6, 57392, v14
    buffer_load_dwordx2 v[142:143], v6, s[16:19], 0 offen
    s_waitcnt vmcnt(0)
    v_lshlrev_b32 v16, 16, v16
    v_add_f32 v64, v64, v16
    v_add_f32 v65, v65, v16
    v_lshlrev_b32 v6, 16, v128
    v_and_b32 v7, 0xffff0000, v128
    v_mul_f32 v64, v64, v6
    v_mul_f32 v65, v65, v7
    v_cvt_pk_bf16_f32 v128, v64, v65
    v_add_f32 v66, v66, v16
    v_add_f32 v67, v67, v16
    v_lshlrev_b32 v6, 16, v129
    v_and_b32 v7, 0xffff0000, v129
    v_mul_f32 v66, v66, v6
    v_mul_f32 v67, v67, v7
    v_cvt_pk_bf16_f32 v129, v66, v67
    v_add_u32 v6, 0, v14
    buffer_store_dwordx2 v[128:129], v6, s[20:23], 0 offen
    v_add_f32 v68, v68, v16
    v_add_f32 v69, v69, v16
    v_lshlrev_b32 v6, 16, v130
    v_and_b32 v7, 0xffff0000, v130
    v_mul_f32 v68, v68, v6
    v_mul_f32 v69, v69, v7
    v_cvt_pk_bf16_f32 v130, v68, v69
    v_add_f32 v70, v70, v16
    v_add_f32 v71, v71, v16
    v_lshlrev_b32 v6, 16, v131
    v_and_b32 v7, 0xffff0000, v131
    v_mul_f32 v70, v70, v6
    v_mul_f32 v71, v71, v7
    v_cvt_pk_bf16_f32 v131, v70, v71
    v_add_u32 v6, 16, v14
    buffer_store_dwordx2 v[130:131], v6, s[20:23], 0 offen
    v_add_f32 v72, v72, v16
    v_add_f32 v73, v73, v16
    v_lshlrev_b32 v6, 16, v132
    v_and_b32 v7, 0xffff0000, v132
    v_mul_f32 v72, v72, v6
    v_mul_f32 v73, v73, v7
    v_cvt_pk_bf16_f32 v132, v72, v73
    v_add_f32 v74, v74, v16
    v_add_f32 v75, v75, v16
    v_lshlrev_b32 v6, 16, v133
    v_and_b32 v7, 0xffff0000, v133
    v_mul_f32 v74, v74, v6
    v_mul_f32 v75, v75, v7
    v_cvt_pk_bf16_f32 v133, v74, v75
    v_add_u32 v6, 32, v14
    buffer_store_dwordx2 v[132:133], v6, s[20:23], 0 offen
    v_add_f32 v76, v76, v16
    v_add_f32 v77, v77, v16
    v_lshlrev_b32 v6, 16, v134
    v_and_b32 v7, 0xffff0000, v134
    v_mul_f32 v76, v76, v6
    v_mul_f32 v77, v77, v7
    v_cvt_pk_bf16_f32 v134, v76, v77
    v_add_f32 v78, v78, v16
    v_add_f32 v79, v79, v16
    v_lshlrev_b32 v6, 16, v135
    v_and_b32 v7, 0xffff0000, v135
    v_mul_f32 v78, v78, v6
    v_mul_f32 v79, v79, v7
    v_cvt_pk_bf16_f32 v135, v78, v79
    v_add_u32 v6, 48, v14
    buffer_store_dwordx2 v[134:135], v6, s[20:23], 0 offen
    v_lshlrev_b32 v17, 16, v17
    v_add_f32 v80, v80, v17
    v_add_f32 v81, v81, v17
    v_lshlrev_b32 v6, 16, v136
    v_and_b32 v7, 0xffff0000, v136
    v_mul_f32 v80, v80, v6
    v_mul_f32 v81, v81, v7
    v_cvt_pk_bf16_f32 v136, v80, v81
    v_add_f32 v82, v82, v17
    v_add_f32 v83, v83, v17
    v_lshlrev_b32 v6, 16, v137
    v_and_b32 v7, 0xffff0000, v137
    v_mul_f32 v82, v82, v6
    v_mul_f32 v83, v83, v7
    v_cvt_pk_bf16_f32 v137, v82, v83
    v_add_u32 v6, 57344, v14
    buffer_store_dwordx2 v[136:137], v6, s[20:23], 0 offen
    v_add_f32 v84, v84, v17
    v_add_f32 v85, v85, v17
    v_lshlrev_b32 v6, 16, v138
    v_and_b32 v7, 0xffff0000, v138
    v_mul_f32 v84, v84, v6
    v_mul_f32 v85, v85, v7
    v_cvt_pk_bf16_f32 v138, v84, v85
    v_add_f32 v86, v86, v17
    v_add_f32 v87, v87, v17
    v_lshlrev_b32 v6, 16, v139
    v_and_b32 v7, 0xffff0000, v139
    v_mul_f32 v86, v86, v6
    v_mul_f32 v87, v87, v7
    v_cvt_pk_bf16_f32 v139, v86, v87
    v_add_u32 v6, 57360, v14
    buffer_store_dwordx2 v[138:139], v6, s[20:23], 0 offen
    v_add_f32 v88, v88, v17
    v_add_f32 v89, v89, v17
    v_lshlrev_b32 v6, 16, v140
    v_and_b32 v7, 0xffff0000, v140
    v_mul_f32 v88, v88, v6
    v_mul_f32 v89, v89, v7
    v_cvt_pk_bf16_f32 v140, v88, v89
    v_add_f32 v90, v90, v17
    v_add_f32 v91, v91, v17
    v_lshlrev_b32 v6, 16, v141
    v_and_b32 v7, 0xffff0000, v141
    v_mul_f32 v90, v90, v6
    v_mul_f32 v91, v91, v7
    v_cvt_pk_bf16_f32 v141, v90, v91
    v_add_u32 v6, 57376, v14
    buffer_store_dwordx2 v[140:141], v6, s[20:23], 0 offen
    v_add_f32 v92, v92, v17
    v_add_f32 v93, v93, v17
    v_lshlrev_b32 v6, 16, v142
    v_and_b32 v7, 0xffff0000, v142
    v_mul_f32 v92, v92, v6
    v_mul_f32 v93, v93, v7
    v_cvt_pk_bf16_f32 v142, v92, v93
    v_add_f32 v94, v94, v17
    v_add_f32 v95, v95, v17
    v_lshlrev_b32 v6, 16, v143
    v_and_b32 v7, 0xffff0000, v143
    v_mul_f32 v94, v94, v6
    v_mul_f32 v95, v95, v7
    v_cvt_pk_bf16_f32 v143, v94, v95
    v_add_u32 v6, 57392, v14
    buffer_store_dwordx2 v[142:143], v6, s[20:23], 0 offen
gemm2_done:
    s_endpgm
.globl gemm3_kernel
.p2align 8
.type gemm3_kernel,@function
gemm3_kernel:
    s_cmp_ge_u32 s2, 224
    s_cbranch_scc1 gemm3_done
    s_load_dwordx2 s[36:37], s[0:1], 104
    s_load_dwordx2 s[4:5], s[0:1], 64
    s_load_dwordx2 s[6:7], s[0:1], 72
    s_load_dwordx2 s[38:39], s[0:1], 88
    s_mul_hi_u32 s30, s2, 0x24924925
    s_mul_i32 s31, s30, 7
    s_sub_u32 s31, s2, s31
    s_mov_b32 s40, 0x3d372713
    s_mov_b32 s41, 0xc0135761
    v_lshrrev_b32 v7, 6, v0
    s_nop 0
    v_readfirstlane_b32 s27, v7
    s_nop 3
    s_and_b32 s28, s27, 3
    s_waitcnt lgkmcnt(0)
    s_add_u32 s8, s36, 0x600000
    s_addc_u32 s9, s37, 0
    s_mov_b32 s10, 0xc4000
    s_mov_b32 s11, 0x00020000
    s_add_u32 s12, s36, 0x1800000
    s_addc_u32 s13, s37, 0
    s_mov_b32 s14, 0x380000
    s_mov_b32 s15, 0x00020000
    s_mul_i32 s32, s31, 64
    s_mul_i32 s33, s30, 64
    v_and_b32 v1, 63, v0
    v_lshrrev_b32 v2, 3, v1
    v_and_b32 v3, 7, v1
    v_xor_b32 v3, v3, v2
    s_lshl_b32 s34, s28, 3
    v_add_u32 v2, s34, v2
    v_add_u32 v16, s32, v2
    v_add_u32 v16, 0, v16
    s_mov_b32 s35, 1792
    v_mul_lo_u32 v16, v16, s35
    v_lshl_add_u32 v16, v3, 4, v16
    v_add_u32 v17, s32, v2
    v_add_u32 v17, 32, v17
    s_mov_b32 s35, 1792
    v_mul_lo_u32 v17, v17, s35
    v_lshl_add_u32 v17, v3, 4, v17
    v_add_u32 v18, s33, v2
    v_add_u32 v18, 0, v18
    s_mov_b32 s35, 1792
    v_mul_lo_u32 v18, v18, s35
    v_lshl_add_u32 v18, v3, 4, v18
    v_add_u32 v19, s33, v2
    v_add_u32 v19, 32, v19
    s_mov_b32 s35, 1792
    v_mul_lo_u32 v19, v19, s35
    v_lshl_add_u32 v19, v3, 4, v19
    s_lshl_b32 s43, s28, 10
    s_cmp_lt_u32 s27, 4
    s_cbranch_scc1 gemm3_comp
    s_mov_b32 s42, 0
    s_add_u32 m0, s43, 0
    s_nop 0
    buffer_load_dwordx4 v16, s[8:11], s42 offen lds
    s_add_u32 m0, s43, 4096
    s_nop 0
    buffer_load_dwordx4 v17, s[8:11], s42 offen lds
    s_add_u32 m0, s43, 8192
    s_nop 0
    buffer_load_dwordx4 v18, s[12:15], s42 offen lds
    s_add_u32 m0, s43, 12288
    s_nop 0
    buffer_load_dwordx4 v19, s[12:15], s42 offen lds
    s_mov_b32 s42, 128
    s_add_u32 m0, s43, 16384
    s_nop 0
    buffer_load_dwordx4 v16, s[8:11], s42 offen lds
    s_add_u32 m0, s43, 20480
    s_nop 0
    buffer_load_dwordx4 v17, s[8:11], s42 offen lds
    s_add_u32 m0, s43, 24576
    s_nop 0
    buffer_load_dwordx4 v18, s[12:15], s42 offen lds
    s_add_u32 m0, s43, 28672
    s_nop 0
    buffer_load_dwordx4 v19, s[12:15], s42 offen lds
    s_mov_b32 s42, 256
    s_add_u32 m0, s43, 32768
    s_nop 0
    buffer_load_dwordx4 v16, s[8:11], s42 offen lds
    s_add_u32 m0, s43, 36864
    s_nop 0
    buffer_load_dwordx4 v17, s[8:11], s42 offen lds
    s_add_u32 m0, s43, 40960
    s_nop 0
    buffer_load_dwordx4 v18, s[12:15], s42 offen lds
    s_add_u32 m0, s43, 45056
    s_nop 0
    buffer_load_dwordx4 v19, s[12:15], s42 offen lds
    s_mov_b32 s42, 384
    s_add_u32 m0, s43, 49152
    s_nop 0
    buffer_load_dwordx4 v16, s[8:11], s42 offen lds
    s_add_u32 m0, s43, 53248
    s_nop 0
    buffer_load_dwordx4 v17, s[8:11], s42 offen lds
    s_add_u32 m0, s43, 57344
    s_nop 0
    buffer_load_dwordx4 v18, s[12:15], s42 offen lds
    s_add_u32 m0, s43, 61440
    s_nop 0
    buffer_load_dwordx4 v19, s[12:15], s42 offen lds
    s_mov_b32 s42, 512
    s_add_u32 m0, s43, 65536
    s_nop 0
    buffer_load_dwordx4 v16, s[8:11], s42 offen lds
    s_add_u32 m0, s43, 69632
    s_nop 0
    buffer_load_dwordx4 v17, s[8:11], s42 offen lds
    s_add_u32 m0, s43, 73728
    s_nop 0
    buffer_load_dwordx4 v18, s[12:15], s42 offen lds
    s_add_u32 m0, s43, 77824
    s_nop 0
    buffer_load_dwordx4 v19, s[12:15], s42 offen lds
    s_waitcnt vmcnt(16)
    s_barrier
    s_mov_b32 s42, 640
    s_add_u32 m0, s43, 81920
    s_nop 0
    buffer_load_dwordx4 v16, s[8:11], s42 offen lds
    s_add_u32 m0, s43, 86016
    s_nop 0
    buffer_load_dwordx4 v17, s[8:11], s42 offen lds
    s_add_u32 m0, s43, 90112
    s_nop 0
    buffer_load_dwordx4 v18, s[12:15], s42 offen lds
    s_add_u32 m0, s43, 94208
    s_nop 0
    buffer_load_dwordx4 v19, s[12:15], s42 offen lds
    s_waitcnt vmcnt(16)
    s_barrier
    s_mov_b32 s42, 768
    s_add_u32 m0, s43, 0
    s_nop 0
    buffer_load_dwordx4 v16, s[8:11], s42 offen lds
    s_add_u32 m0, s43, 4096
    s_nop 0
    buffer_load_dwordx4 v17, s[8:11], s42 offen lds
    s_add_u32 m0, s43, 8192
    s_nop 0
    buffer_load_dwordx4 v18, s[12:15], s42 offen lds
    s_add_u32 m0, s43, 12288
    s_nop 0
    buffer_load_dwordx4 v19, s[12:15], s42 offen lds
    s_waitcnt vmcnt(16)
    s_barrier
    s_mov_b32 s42, 896
    s_add_u32 m0, s43, 16384
    s_nop 0
    buffer_load_dwordx4 v16, s[8:11], s42 offen lds
    s_add_u32 m0, s43, 20480
    s_nop 0
    buffer_load_dwordx4 v17, s[8:11], s42 offen lds
    s_add_u32 m0, s43, 24576
    s_nop 0
    buffer_load_dwordx4 v18, s[12:15], s42 offen lds
    s_add_u32 m0, s43, 28672
    s_nop 0
    buffer_load_dwordx4 v19, s[12:15], s42 offen lds
    s_waitcnt vmcnt(16)
    s_barrier
    s_mov_b32 s42, 1024
    s_add_u32 m0, s43, 32768
    s_nop 0
    buffer_load_dwordx4 v16, s[8:11], s42 offen lds
    s_add_u32 m0, s43, 36864
    s_nop 0
    buffer_load_dwordx4 v17, s[8:11], s42 offen lds
    s_add_u32 m0, s43, 40960
    s_nop 0
    buffer_load_dwordx4 v18, s[12:15], s42 offen lds
    s_add_u32 m0, s43, 45056
    s_nop 0
    buffer_load_dwordx4 v19, s[12:15], s42 offen lds
    s_waitcnt vmcnt(16)
    s_barrier
    s_mov_b32 s42, 1152
    s_add_u32 m0, s43, 49152
    s_nop 0
    buffer_load_dwordx4 v16, s[8:11], s42 offen lds
    s_add_u32 m0, s43, 53248
    s_nop 0
    buffer_load_dwordx4 v17, s[8:11], s42 offen lds
    s_add_u32 m0, s43, 57344
    s_nop 0
    buffer_load_dwordx4 v18, s[12:15], s42 offen lds
    s_add_u32 m0, s43, 61440
    s_nop 0
    buffer_load_dwordx4 v19, s[12:15], s42 offen lds
    s_waitcnt vmcnt(16)
    s_barrier
    s_mov_b32 s42, 1280
    s_add_u32 m0, s43, 65536
    s_nop 0
    buffer_load_dwordx4 v16, s[8:11], s42 offen lds
    s_add_u32 m0, s43, 69632
    s_nop 0
    buffer_load_dwordx4 v17, s[8:11], s42 offen lds
    s_add_u32 m0, s43, 73728
    s_nop 0
    buffer_load_dwordx4 v18, s[12:15], s42 offen lds
    s_add_u32 m0, s43, 77824
    s_nop 0
    buffer_load_dwordx4 v19, s[12:15], s42 offen lds
    s_waitcnt vmcnt(16)
    s_barrier
    s_mov_b32 s42, 1408
    s_add_u32 m0, s43, 81920
    s_nop 0
    buffer_load_dwordx4 v16, s[8:11], s42 offen lds
    s_add_u32 m0, s43, 86016
    s_nop 0
    buffer_load_dwordx4 v17, s[8:11], s42 offen lds
    s_add_u32 m0, s43, 90112
    s_nop 0
    buffer_load_dwordx4 v18, s[12:15], s42 offen lds
    s_add_u32 m0, s43, 94208
    s_nop 0
    buffer_load_dwordx4 v19, s[12:15], s42 offen lds
    s_waitcnt vmcnt(16)
    s_barrier
    s_mov_b32 s42, 1536
    s_add_u32 m0, s43, 0
    s_nop 0
    buffer_load_dwordx4 v16, s[8:11], s42 offen lds
    s_add_u32 m0, s43, 4096
    s_nop 0
    buffer_load_dwordx4 v17, s[8:11], s42 offen lds
    s_add_u32 m0, s43, 8192
    s_nop 0
    buffer_load_dwordx4 v18, s[12:15], s42 offen lds
    s_add_u32 m0, s43, 12288
    s_nop 0
    buffer_load_dwordx4 v19, s[12:15], s42 offen lds
    s_waitcnt vmcnt(16)
    s_barrier
    s_mov_b32 s42, 1664
    s_add_u32 m0, s43, 16384
    s_nop 0
    buffer_load_dwordx4 v16, s[8:11], s42 offen lds
    s_add_u32 m0, s43, 20480
    s_nop 0
    buffer_load_dwordx4 v17, s[8:11], s42 offen lds
    s_add_u32 m0, s43, 24576
    s_nop 0
    buffer_load_dwordx4 v18, s[12:15], s42 offen lds
    s_add_u32 m0, s43, 28672
    s_nop 0
    buffer_load_dwordx4 v19, s[12:15], s42 offen lds
    s_waitcnt vmcnt(16)
    s_barrier
    s_waitcnt vmcnt(12)
    s_barrier
    s_waitcnt vmcnt(8)
    s_barrier
    s_waitcnt vmcnt(4)
    s_barrier
    s_waitcnt vmcnt(0)
    s_barrier
    s_endpgm
gemm3_comp:
    v_and_b32 v8, 31, v0
    v_bfe_u32 v9, v0, 5, 1
    s_lshr_b32 s29, s28, 1
    s_and_b32 s35, s28, 1
    v_and_b32 v10, 7, v0
    v_lshlrev_b32 v11, 7, v8
    s_mul_i32 s44, s29, 4096
    s_mul_i32 s45, s35, 4096
    s_add_u32 s45, s45, 8192
    v_lshl_add_u32 v12, v9, 2, 0
    v_xor_b32 v12, v12, v10
    v_lshl_add_u32 v12, v12, 4, v11
    v_add_u32 v32, s44, v12
    v_add_u32 v36, s45, v12
    v_add_u32 v40, 32768, v32
    v_add_u32 v44, 32768, v36
    v_add_u32 v48, 65536, v32
    v_add_u32 v52, 65536, v36
    v_lshl_add_u32 v12, v9, 2, 1
    v_xor_b32 v12, v12, v10
    v_lshl_add_u32 v12, v12, 4, v11
    v_add_u32 v33, s44, v12
    v_add_u32 v37, s45, v12
    v_add_u32 v41, 32768, v33
    v_add_u32 v45, 32768, v37
    v_add_u32 v49, 65536, v33
    v_add_u32 v53, 65536, v37
    v_lshl_add_u32 v12, v9, 2, 2
    v_xor_b32 v12, v12, v10
    v_lshl_add_u32 v12, v12, 4, v11
    v_add_u32 v34, s44, v12
    v_add_u32 v38, s45, v12
    v_add_u32 v42, 32768, v34
    v_add_u32 v46, 32768, v38
    v_add_u32 v50, 65536, v34
    v_add_u32 v54, 65536, v38
    v_lshl_add_u32 v12, v9, 2, 3
    v_xor_b32 v12, v12, v10
    v_lshl_add_u32 v12, v12, 4, v11
    v_add_u32 v35, s44, v12
    v_add_u32 v39, s45, v12
    v_add_u32 v43, 32768, v35
    v_add_u32 v47, 32768, v39
    v_add_u32 v51, 65536, v35
    v_add_u32 v55, 65536, v39
    v_mov_b32 v64, 0
    v_mov_b32 v65, 0
    v_mov_b32 v66, 0
    v_mov_b32 v67, 0
    v_mov_b32 v68, 0
    v_mov_b32 v69, 0
    v_mov_b32 v70, 0
    v_mov_b32 v71, 0
    v_mov_b32 v72, 0
    v_mov_b32 v73, 0
    v_mov_b32 v74, 0
    v_mov_b32 v75, 0
    v_mov_b32 v76, 0
    v_mov_b32 v77, 0
    v_mov_b32 v78, 0
    v_mov_b32 v79, 0
    s_barrier
    ds_read_b128 v[128:131], v32 offset:0
    ds_read_b128 v[144:147], v36 offset:0
    ds_read_b128 v[132:135], v33 offset:0
    ds_read_b128 v[148:151], v37 offset:0
    ds_read_b128 v[136:139], v34 offset:0
    ds_read_b128 v[152:155], v38 offset:0
    ds_read_b128 v[140:143], v35 offset:0
    ds_read_b128 v[156:159], v39 offset:0
    s_waitcnt lgkmcnt(6)
    v_mfma_f32_32x32x16_bf16 v[64:79], v[128:131], v[144:147], v[64:79]
    s_waitcnt lgkmcnt(4)
    v_mfma_f32_32x32x16_bf16 v[64:79], v[132:135], v[148:151], v[64:79]
    s_waitcnt lgkmcnt(2)
    v_mfma_f32_32x32x16_bf16 v[64:79], v[136:139], v[152:155], v[64:79]
    s_waitcnt lgkmcnt(0)
    v_mfma_f32_32x32x16_bf16 v[64:79], v[140:143], v[156:159], v[64:79]
    s_barrier
    ds_read_b128 v[128:131], v32 offset:16384
    ds_read_b128 v[144:147], v36 offset:16384
    ds_read_b128 v[132:135], v33 offset:16384
    ds_read_b128 v[148:151], v37 offset:16384
    ds_read_b128 v[136:139], v34 offset:16384
    ds_read_b128 v[152:155], v38 offset:16384
    ds_read_b128 v[140:143], v35 offset:16384
    ds_read_b128 v[156:159], v39 offset:16384
    s_waitcnt lgkmcnt(6)
    v_mfma_f32_32x32x16_bf16 v[64:79], v[128:131], v[144:147], v[64:79]
    s_waitcnt lgkmcnt(4)
    v_mfma_f32_32x32x16_bf16 v[64:79], v[132:135], v[148:151], v[64:79]
    s_waitcnt lgkmcnt(2)
    v_mfma_f32_32x32x16_bf16 v[64:79], v[136:139], v[152:155], v[64:79]
    s_waitcnt lgkmcnt(0)
    v_mfma_f32_32x32x16_bf16 v[64:79], v[140:143], v[156:159], v[64:79]
    s_barrier
    ds_read_b128 v[128:131], v40 offset:0
    ds_read_b128 v[144:147], v44 offset:0
    ds_read_b128 v[132:135], v41 offset:0
    ds_read_b128 v[148:151], v45 offset:0
    ds_read_b128 v[136:139], v42 offset:0
    ds_read_b128 v[152:155], v46 offset:0
    ds_read_b128 v[140:143], v43 offset:0
    ds_read_b128 v[156:159], v47 offset:0
    s_waitcnt lgkmcnt(6)
    v_mfma_f32_32x32x16_bf16 v[64:79], v[128:131], v[144:147], v[64:79]
    s_waitcnt lgkmcnt(4)
    v_mfma_f32_32x32x16_bf16 v[64:79], v[132:135], v[148:151], v[64:79]
    s_waitcnt lgkmcnt(2)
    v_mfma_f32_32x32x16_bf16 v[64:79], v[136:139], v[152:155], v[64:79]
    s_waitcnt lgkmcnt(0)
    v_mfma_f32_32x32x16_bf16 v[64:79], v[140:143], v[156:159], v[64:79]
    s_barrier
    ds_read_b128 v[128:131], v40 offset:16384
    ds_read_b128 v[144:147], v44 offset:16384
    ds_read_b128 v[132:135], v41 offset:16384
    ds_read_b128 v[148:151], v45 offset:16384
    ds_read_b128 v[136:139], v42 offset:16384
    ds_read_b128 v[152:155], v46 offset:16384
    ds_read_b128 v[140:143], v43 offset:16384
    ds_read_b128 v[156:159], v47 offset:16384
    s_waitcnt lgkmcnt(6)
    v_mfma_f32_32x32x16_bf16 v[64:79], v[128:131], v[144:147], v[64:79]
    s_waitcnt lgkmcnt(4)
    v_mfma_f32_32x32x16_bf16 v[64:79], v[132:135], v[148:151], v[64:79]
    s_waitcnt lgkmcnt(2)
    v_mfma_f32_32x32x16_bf16 v[64:79], v[136:139], v[152:155], v[64:79]
    s_waitcnt lgkmcnt(0)
    v_mfma_f32_32x32x16_bf16 v[64:79], v[140:143], v[156:159], v[64:79]
    s_barrier
    ds_read_b128 v[128:131], v48 offset:0
    ds_read_b128 v[144:147], v52 offset:0
    ds_read_b128 v[132:135], v49 offset:0
    ds_read_b128 v[148:151], v53 offset:0
    ds_read_b128 v[136:139], v50 offset:0
    ds_read_b128 v[152:155], v54 offset:0
    ds_read_b128 v[140:143], v51 offset:0
    ds_read_b128 v[156:159], v55 offset:0
    s_waitcnt lgkmcnt(6)
    v_mfma_f32_32x32x16_bf16 v[64:79], v[128:131], v[144:147], v[64:79]
    s_waitcnt lgkmcnt(4)
    v_mfma_f32_32x32x16_bf16 v[64:79], v[132:135], v[148:151], v[64:79]
    s_waitcnt lgkmcnt(2)
    v_mfma_f32_32x32x16_bf16 v[64:79], v[136:139], v[152:155], v[64:79]
    s_waitcnt lgkmcnt(0)
    v_mfma_f32_32x32x16_bf16 v[64:79], v[140:143], v[156:159], v[64:79]
    s_barrier
    ds_read_b128 v[128:131], v48 offset:16384
    ds_read_b128 v[144:147], v52 offset:16384
    ds_read_b128 v[132:135], v49 offset:16384
    ds_read_b128 v[148:151], v53 offset:16384
    ds_read_b128 v[136:139], v50 offset:16384
    ds_read_b128 v[152:155], v54 offset:16384
    ds_read_b128 v[140:143], v51 offset:16384
    ds_read_b128 v[156:159], v55 offset:16384
    s_waitcnt lgkmcnt(6)
    v_mfma_f32_32x32x16_bf16 v[64:79], v[128:131], v[144:147], v[64:79]
    s_waitcnt lgkmcnt(4)
    v_mfma_f32_32x32x16_bf16 v[64:79], v[132:135], v[148:151], v[64:79]
    s_waitcnt lgkmcnt(2)
    v_mfma_f32_32x32x16_bf16 v[64:79], v[136:139], v[152:155], v[64:79]
    s_waitcnt lgkmcnt(0)
    v_mfma_f32_32x32x16_bf16 v[64:79], v[140:143], v[156:159], v[64:79]
    s_barrier
    ds_read_b128 v[128:131], v32 offset:0
    ds_read_b128 v[144:147], v36 offset:0
    ds_read_b128 v[132:135], v33 offset:0
    ds_read_b128 v[148:151], v37 offset:0
    ds_read_b128 v[136:139], v34 offset:0
    ds_read_b128 v[152:155], v38 offset:0
    ds_read_b128 v[140:143], v35 offset:0
    ds_read_b128 v[156:159], v39 offset:0
    s_waitcnt lgkmcnt(6)
    v_mfma_f32_32x32x16_bf16 v[64:79], v[128:131], v[144:147], v[64:79]
    s_waitcnt lgkmcnt(4)
    v_mfma_f32_32x32x16_bf16 v[64:79], v[132:135], v[148:151], v[64:79]
    s_waitcnt lgkmcnt(2)
    v_mfma_f32_32x32x16_bf16 v[64:79], v[136:139], v[152:155], v[64:79]
    s_waitcnt lgkmcnt(0)
    v_mfma_f32_32x32x16_bf16 v[64:79], v[140:143], v[156:159], v[64:79]
    s_barrier
    ds_read_b128 v[128:131], v32 offset:16384
    ds_read_b128 v[144:147], v36 offset:16384
    ds_read_b128 v[132:135], v33 offset:16384
    ds_read_b128 v[148:151], v37 offset:16384
    ds_read_b128 v[136:139], v34 offset:16384
    ds_read_b128 v[152:155], v38 offset:16384
    ds_read_b128 v[140:143], v35 offset:16384
    ds_read_b128 v[156:159], v39 offset:16384
    s_waitcnt lgkmcnt(6)
    v_mfma_f32_32x32x16_bf16 v[64:79], v[128:131], v[144:147], v[64:79]
    s_waitcnt lgkmcnt(4)
    v_mfma_f32_32x32x16_bf16 v[64:79], v[132:135], v[148:151], v[64:79]
    s_waitcnt lgkmcnt(2)
    v_mfma_f32_32x32x16_bf16 v[64:79], v[136:139], v[152:155], v[64:79]
    s_waitcnt lgkmcnt(0)
    v_mfma_f32_32x32x16_bf16 v[64:79], v[140:143], v[156:159], v[64:79]
    s_barrier
    ds_read_b128 v[128:131], v40 offset:0
    ds_read_b128 v[144:147], v44 offset:0
    ds_read_b128 v[132:135], v41 offset:0
    ds_read_b128 v[148:151], v45 offset:0
    ds_read_b128 v[136:139], v42 offset:0
    ds_read_b128 v[152:155], v46 offset:0
    ds_read_b128 v[140:143], v43 offset:0
    ds_read_b128 v[156:159], v47 offset:0
    s_waitcnt lgkmcnt(6)
    v_mfma_f32_32x32x16_bf16 v[64:79], v[128:131], v[144:147], v[64:79]
    s_waitcnt lgkmcnt(4)
    v_mfma_f32_32x32x16_bf16 v[64:79], v[132:135], v[148:151], v[64:79]
    s_waitcnt lgkmcnt(2)
    v_mfma_f32_32x32x16_bf16 v[64:79], v[136:139], v[152:155], v[64:79]
    s_waitcnt lgkmcnt(0)
    v_mfma_f32_32x32x16_bf16 v[64:79], v[140:143], v[156:159], v[64:79]
    s_barrier
    ds_read_b128 v[128:131], v40 offset:16384
    ds_read_b128 v[144:147], v44 offset:16384
    ds_read_b128 v[132:135], v41 offset:16384
    ds_read_b128 v[148:151], v45 offset:16384
    ds_read_b128 v[136:139], v42 offset:16384
    ds_read_b128 v[152:155], v46 offset:16384
    ds_read_b128 v[140:143], v43 offset:16384
    ds_read_b128 v[156:159], v47 offset:16384
    s_waitcnt lgkmcnt(6)
    v_mfma_f32_32x32x16_bf16 v[64:79], v[128:131], v[144:147], v[64:79]
    s_waitcnt lgkmcnt(4)
    v_mfma_f32_32x32x16_bf16 v[64:79], v[132:135], v[148:151], v[64:79]
    s_waitcnt lgkmcnt(2)
    v_mfma_f32_32x32x16_bf16 v[64:79], v[136:139], v[152:155], v[64:79]
    s_waitcnt lgkmcnt(0)
    v_mfma_f32_32x32x16_bf16 v[64:79], v[140:143], v[156:159], v[64:79]
    s_barrier
    ds_read_b128 v[128:131], v48 offset:0
    ds_read_b128 v[144:147], v52 offset:0
    ds_read_b128 v[132:135], v49 offset:0
    ds_read_b128 v[148:151], v53 offset:0
    ds_read_b128 v[136:139], v50 offset:0
    ds_read_b128 v[152:155], v54 offset:0
    ds_read_b128 v[140:143], v51 offset:0
    ds_read_b128 v[156:159], v55 offset:0
    s_waitcnt lgkmcnt(6)
    v_mfma_f32_32x32x16_bf16 v[64:79], v[128:131], v[144:147], v[64:79]
    s_waitcnt lgkmcnt(4)
    v_mfma_f32_32x32x16_bf16 v[64:79], v[132:135], v[148:151], v[64:79]
    s_waitcnt lgkmcnt(2)
    v_mfma_f32_32x32x16_bf16 v[64:79], v[136:139], v[152:155], v[64:79]
    s_waitcnt lgkmcnt(0)
    v_mfma_f32_32x32x16_bf16 v[64:79], v[140:143], v[156:159], v[64:79]
    s_barrier
    ds_read_b128 v[128:131], v48 offset:16384
    ds_read_b128 v[144:147], v52 offset:16384
    ds_read_b128 v[132:135], v49 offset:16384
    ds_read_b128 v[148:151], v53 offset:16384
    ds_read_b128 v[136:139], v50 offset:16384
    ds_read_b128 v[152:155], v54 offset:16384
    ds_read_b128 v[140:143], v51 offset:16384
    ds_read_b128 v[156:159], v55 offset:16384
    s_waitcnt lgkmcnt(6)
    v_mfma_f32_32x32x16_bf16 v[64:79], v[128:131], v[144:147], v[64:79]
    s_waitcnt lgkmcnt(4)
    v_mfma_f32_32x32x16_bf16 v[64:79], v[132:135], v[148:151], v[64:79]
    s_waitcnt lgkmcnt(2)
    v_mfma_f32_32x32x16_bf16 v[64:79], v[136:139], v[152:155], v[64:79]
    s_waitcnt lgkmcnt(0)
    v_mfma_f32_32x32x16_bf16 v[64:79], v[140:143], v[156:159], v[64:79]
    s_barrier
    ds_read_b128 v[128:131], v32 offset:0
    ds_read_b128 v[144:147], v36 offset:0
    ds_read_b128 v[132:135], v33 offset:0
    ds_read_b128 v[148:151], v37 offset:0
    ds_read_b128 v[136:139], v34 offset:0
    ds_read_b128 v[152:155], v38 offset:0
    ds_read_b128 v[140:143], v35 offset:0
    ds_read_b128 v[156:159], v39 offset:0
    s_waitcnt lgkmcnt(6)
    v_mfma_f32_32x32x16_bf16 v[64:79], v[128:131], v[144:147], v[64:79]
    s_waitcnt lgkmcnt(4)
    v_mfma_f32_32x32x16_bf16 v[64:79], v[132:135], v[148:151], v[64:79]
    s_waitcnt lgkmcnt(2)
    v_mfma_f32_32x32x16_bf16 v[64:79], v[136:139], v[152:155], v[64:79]
    s_waitcnt lgkmcnt(0)
    v_mfma_f32_32x32x16_bf16 v[64:79], v[140:143], v[156:159], v[64:79]
    s_barrier
    ds_read_b128 v[128:131], v32 offset:16384
    ds_read_b128 v[144:147], v36 offset:16384
    ds_read_b128 v[132:135], v33 offset:16384
    ds_read_b128 v[148:151], v37 offset:16384
    ds_read_b128 v[136:139], v34 offset:16384
    ds_read_b128 v[152:155], v38 offset:16384
    ds_read_b128 v[140:143], v35 offset:16384
    ds_read_b128 v[156:159], v39 offset:16384
    s_waitcnt lgkmcnt(6)
    v_mfma_f32_32x32x16_bf16 v[64:79], v[128:131], v[144:147], v[64:79]
    s_waitcnt lgkmcnt(4)
    v_mfma_f32_32x32x16_bf16 v[64:79], v[132:135], v[148:151], v[64:79]
    s_waitcnt lgkmcnt(2)
    v_mfma_f32_32x32x16_bf16 v[64:79], v[136:139], v[152:155], v[64:79]
    s_waitcnt lgkmcnt(0)
    v_mfma_f32_32x32x16_bf16 v[64:79], v[140:143], v[156:159], v[64:79]
    s_nop 15
    s_nop 7
    s_add_u32 s16, s36, 0x800000
    s_addc_u32 s17, s37, 0
    s_mov_b32 s18, 0x1c0000
    s_mov_b32 s19, 0x00020000
    s_mov_b32 s20, s38
    s_mov_b32 s21, s39
    s_mov_b32 s22, 0x1c0000
    s_mov_b32 s23, 0x00020000
    s_mul_i32 s40, s35, 32
    s_add_u32 s40, s40, s33
    v_add_u32 v13, s40, v8
    s_mul_i32 s41, s29, 32
    s_add_u32 s41, s41, s32
    s_lshl_b32 s41, s41, 1
    v_mul_u32_u24 v14, 896, v13
    v_lshl_add_u32 v14, v9, 3, v14
    v_add_u32 v14, s41, v14
    v_add_u32 v6, 0, v14
    buffer_load_dwordx2 v[128:129], v6, s[16:19], 0 offen
    v_add_u32 v6, 16, v14
    buffer_load_dwordx2 v[130:131], v6, s[16:19], 0 offen
    v_add_u32 v6, 32, v14
    buffer_load_dwordx2 v[132:133], v6, s[16:19], 0 offen
    v_add_u32 v6, 48, v14
    buffer_load_dwordx2 v[134:135], v6, s[16:19], 0 offen
    s_waitcnt vmcnt(0)
    v_lshlrev_b32 v6, 16, v128
    v_and_b32 v7, 0xffff0000, v128
    v_add_f32 v64, v64, v6
    v_add_f32 v65, v65, v7
    v_cvt_pk_bf16_f32 v128, v64, v65
    v_lshlrev_b32 v6, 16, v129
    v_and_b32 v7, 0xffff0000, v129
    v_add_f32 v66, v66, v6
    v_add_f32 v67, v67, v7
    v_cvt_pk_bf16_f32 v129, v66, v67
    v_add_u32 v6, 0, v14
    buffer_store_dwordx2 v[128:129], v6, s[20:23], 0 offen
    v_lshlrev_b32 v6, 16, v130
    v_and_b32 v7, 0xffff0000, v130
    v_add_f32 v68, v68, v6
    v_add_f32 v69, v69, v7
    v_cvt_pk_bf16_f32 v130, v68, v69
    v_lshlrev_b32 v6, 16, v131
    v_and_b32 v7, 0xffff0000, v131
    v_add_f32 v70, v70, v6
    v_add_f32 v71, v71, v7
    v_cvt_pk_bf16_f32 v131, v70, v71
    v_add_u32 v6, 16, v14
    buffer_store_dwordx2 v[130:131], v6, s[20:23], 0 offen
    v_lshlrev_b32 v6, 16, v132
    v_and_b32 v7, 0xffff0000, v132
    v_add_f32 v72, v72, v6
    v_add_f32 v73, v73, v7
    v_cvt_pk_bf16_f32 v132, v72, v73
    v_lshlrev_b32 v6, 16, v133
    v_and_b32 v7, 0xffff0000, v133
    v_add_f32 v74, v74, v6
    v_add_f32 v75, v75, v7
    v_cvt_pk_bf16_f32 v133, v74, v75
    v_add_u32 v6, 32, v14
    buffer_store_dwordx2 v[132:133], v6, s[20:23], 0 offen
    v_lshlrev_b32 v6, 16, v134
    v_and_b32 v7, 0xffff0000, v134
    v_add_f32 v76, v76, v6
    v_add_f32 v77, v77, v7
    v_cvt_pk_bf16_f32 v134, v76, v77
    v_lshlrev_b32 v6, 16, v135
    v_and_b32 v7, 0xffff0000, v135
    v_add_f32 v78, v78, v6
    v_add_f32 v79, v79, v7
    v_cvt_pk_bf16_f32 v135, v78, v79
    v_add_u32 v6, 48, v14
    buffer_store_dwordx2 v[134:135], v6, s[20:23], 0 offen
gemm3_done:
    s_endpgm
.section .rodata,"a"
.p2align 6
.amdhsa_kernel prep_kernel
  .amdhsa_next_free_vgpr 128
  .amdhsa_next_free_sgpr 48
  .amdhsa_accum_offset 128
  .amdhsa_group_segment_fixed_size 0
  .amdhsa_kernarg_size 112
  .amdhsa_user_sgpr_count 2
  .amdhsa_user_sgpr_kernarg_segment_ptr 1
  .amdhsa_system_sgpr_workgroup_id_x 1
.end_amdhsa_kernel
.p2align 6
.amdhsa_kernel conv_kernel
  .amdhsa_next_free_vgpr 128
  .amdhsa_next_free_sgpr 48
  .amdhsa_accum_offset 128
  .amdhsa_group_segment_fixed_size 0
  .amdhsa_kernarg_size 112
  .amdhsa_user_sgpr_count 2
  .amdhsa_user_sgpr_kernarg_segment_ptr 1
  .amdhsa_system_sgpr_workgroup_id_x 1
.end_amdhsa_kernel
.p2align 6
.amdhsa_kernel lnprep_kernel
  .amdhsa_next_free_vgpr 160
  .amdhsa_next_free_sgpr 64
  .amdhsa_accum_offset 160
  .amdhsa_group_segment_fixed_size 0
  .amdhsa_kernarg_size 112
  .amdhsa_user_sgpr_count 2
  .amdhsa_user_sgpr_kernarg_segment_ptr 1
  .amdhsa_system_sgpr_workgroup_id_x 1
.end_amdhsa_kernel
.p2align 6
.amdhsa_kernel gemm1_kernel
  .amdhsa_next_free_vgpr 256
  .amdhsa_next_free_sgpr 80
  .amdhsa_accum_offset 256
  .amdhsa_group_segment_fixed_size 0
  .amdhsa_kernarg_size 112
  .amdhsa_user_sgpr_count 2
  .amdhsa_user_sgpr_kernarg_segment_ptr 1
  .amdhsa_system_sgpr_workgroup_id_x 1
.end_amdhsa_kernel
.p2align 6
.amdhsa_kernel norm_kernel
  .amdhsa_next_free_vgpr 128
  .amdhsa_next_free_sgpr 48
  .amdhsa_accum_offset 128
  .amdhsa_group_segment_fixed_size 0
  .amdhsa_kernarg_size 112
  .amdhsa_user_sgpr_count 2
  .amdhsa_user_sgpr_kernarg_segment_ptr 1
  .amdhsa_system_sgpr_workgroup_id_x 1
.end_amdhsa_kernel
.p2align 6
.amdhsa_kernel gemm2_kernel
  .amdhsa_next_free_vgpr 256
  .amdhsa_next_free_sgpr 80
  .amdhsa_accum_offset 256
  .amdhsa_group_segment_fixed_size 0
  .amdhsa_kernarg_size 112
  .amdhsa_user_sgpr_count 2
  .amdhsa_user_sgpr_kernarg_segment_ptr 1
  .amdhsa_system_sgpr_workgroup_id_x 1
.end_amdhsa_kernel
.p2align 6
.amdhsa_kernel gemm3_kernel
  .amdhsa_next_free_vgpr 256
  .amdhsa_next_free_sgpr 80
  .amdhsa_accum_offset 256
  .amdhsa_group_segment_fixed_size 0
  .amdhsa_kernarg_size 112
  .amdhsa_user_sgpr_count 2
  .amdhsa_user_sgpr_kernarg_segment_ptr 1
  .amdhsa_system_sgpr_workgroup_id_x 1
.end_amdhsa_kernel
```
